```python
import torch

def _softmax(x, axis=-1):
    return torch.softmax(x, dim=axis)
def _gelu(x):
    return torch.nn.functional.gelu(x, approximate="tanh")
def _silu(x):
    return torch.nn.functional.silu(x)
def _sigmoid(x):
    return torch.sigmoid(x)
def _layernorm(x, axis=-1, eps=1e-5):
    m = x.mean(dim=axis, keepdim=True)
    v = x.var(dim=axis, keepdim=True, unbiased=False)
    return (x - m) / torch.sqrt(v + eps)
def _scatter_add(tgt, idx, src, axis=0):
    return tgt.clone().index_add_(axis, idx, src)
def _segment_sum(src, seg, n):
    out = torch.zeros((n,) + src.shape[1:], dtype=src.dtype)
    return out.index_add_(0, seg, src)
def _pad(x, pw):
    flat = tuple(v for pair in reversed(pw) for v in pair)
    return torch.nn.functional.pad(x, flat)

kernel_name = 'concat_heads__mha_block_cached__gqa_block_cached__near_ridge'

def setup_inputs():

    _w = (lambda a: (lambda t: t.to(torch.bfloat16) if t.is_floating_point() else t)(torch.as_tensor(a)))
    def _A_setup():
        B, Sq, D = 8, 144, 1024
        H, Sk, Dh = 32, 1024, 128
        return {
            "x": _w((lambda *s: torch.randn(*s, dtype=torch.bfloat16) * 0.8)(B, Sq, D)),
            "k_cache": _w((lambda *s: torch.randn(*s, dtype=torch.bfloat16) * 0.8)(B, H, Sk, Dh)),
            "v_cache": _w((lambda *s: torch.randn(*s, dtype=torch.bfloat16) * 0.05)(B, H, Sk, Dh)),
            "wq": _w((lambda *s: torch.randn(*s, dtype=torch.bfloat16) * 0.8)(D, H * Dh) * (D ** -0.5)),
            "wo": _w((lambda *s: torch.randn(*s, dtype=torch.bfloat16) * 0.05)(H * Dh, D) * ((H * Dh) ** -0.5)),
        }
    _A_in = _A_setup()

    def _B_setup():
        B, Sq, D = 8, 144, 1024
        Hq, Hkv, Sk, Dh = 32, 32, 1024, 128
        assert Hq % Hkv == 0, (Hq, Hkv)
        return {
            "x": _w((lambda *s: torch.randn(*s, dtype=torch.bfloat16) * 0.8)(B, Sq, D)),
            "k_cache": _w((lambda *s: torch.randn(*s, dtype=torch.bfloat16) * 0.8)(B, Hkv, Sk, Dh)),
            "v_cache": _w((lambda *s: torch.randn(*s, dtype=torch.bfloat16) * 0.05)(B, Hkv, Sk, Dh)),
            "wq": _w((lambda *s: torch.randn(*s, dtype=torch.bfloat16) * 0.8)(D, Hq * Dh) * (D ** -0.5)),
            "wo": _w((lambda *s: torch.randn(*s, dtype=torch.bfloat16) * 0.05)(Hq * Dh, D) * ((Hq * Dh) ** -0.5)),
        }
    _B_in = _B_setup()

    return {
        "A_x": _A_in["x"],
        "A_k_cache": _A_in["k_cache"],
        "A_v_cache": _A_in["v_cache"],
        "A_wq": _A_in["wq"],
        "A_wo": _A_in["wo"],
        "B_x": _B_in["x"],
        "B_k_cache": _B_in["k_cache"],
        "B_v_cache": _B_in["v_cache"],
        "B_wq": _B_in["wq"],
        "B_wo": _B_in["wo"],
    }

def reference(A_x, A_k_cache, A_v_cache, A_wq, A_wo, B_x, B_k_cache, B_v_cache, B_wq, B_wo):
    def _A_ref(x, k_cache, v_cache, wq, wo):
        B, Sq, D = x.shape
        H, Dh = 32, 128
        q = (lambda x, *d: x.permute(*d))((x @ wq).reshape(B, Sq, H, Dh), 0, 2, 1, 3)
        scores = torch.einsum("bhqd,bhkd->bhqk", q, k_cache) * (Dh ** -0.5)
        p = _softmax(scores, axis=-1)
        o = torch.einsum("bhqk,bhkd->bhqd", p, v_cache)
        return (lambda x, *d: x.permute(*d))(o, 0, 2, 1, 3).reshape(B, Sq, H * Dh) @ wo

    def _B_ref(x, k_cache, v_cache, wq, wo):
        B, Sq, D = x.shape
        Hq, Dh = 32, 128
        Hkv = k_cache.shape[1]
        rep = Hq // Hkv
        q = (lambda x, *d: x.permute(*d))((x @ wq).reshape(B, Sq, Hq, Dh), 0, 2, 1, 3)
        k = (lambda x, n, axis: torch.repeat_interleave(x, n, dim=axis))(k_cache, rep, axis=1)
        v = (lambda x, n, axis: torch.repeat_interleave(x, n, dim=axis))(v_cache, rep, axis=1)
        scores = torch.einsum("bhqd,bhkd->bhqk", q, k) * (Dh ** -0.5)
        p = _softmax(scores, axis=-1)
        o = torch.einsum("bhqk,bhkd->bhqd", p, v)
        return (lambda x, *d: x.permute(*d))(o, 0, 2, 1, 3).reshape(B, Sq, Hq * Dh) @ wo

    a = _A_ref(A_x, A_k_cache, A_v_cache, A_wq, A_wo)
    b = _B_ref(B_x, B_k_cache, B_v_cache, B_wq, B_wo)
    return torch.concatenate([a, b], axis=-1)
```

```asm
; @launch grid=(256,1,1) block=(512,1,1) lds=163840
.amdgcn_target "amdgcn-amd-amdhsa--gfx950"
.text
.globl concat_heads__mha_block_cached__gqa_block_cached__near_ridge_kernel
.p2align 8
.type concat_heads__mha_block_cached__gqa_block_cached__near_ridge_kernel,@function
concat_heads__mha_block_cached__gqa_block_cached__near_ridge_kernel:
    s_cmp_ge_u32 s2, 256
    s_cbranch_scc1 L_k1_done
    v_and_b32 v1, 63, v0
    v_lshrrev_b32 v14, 6, v0
    s_nop 0
    v_readfirstlane_b32 s3, v14
    s_and_b32 s44, s2, 7
    s_lshr_b32 s45, s2, 3
    s_lshr_b32 s24, s44, 2
    s_and_b32 s51, s44, 3
    s_and_b32 s25, s45, 7
    s_lshr_b32 s52, s45, 3
    s_lshl_b32 s26, s51, 3
    s_add_u32 s26, s26, s52
    s_lshl_b32 s31, s25, 1
    s_lshl_b32 s52, s52, 2
    s_add_u32 s31, s31, s52
    s_and_b32 s31, s31, 15
    s_mul_i32 s44, s24, 40
    s_add_u32 s56, s0, s44
    s_addc_u32 s57, s1, 0
    s_load_dwordx8 s[32:39], s[56:57], 0
    s_load_dwordx2 s[40:41], s[0:1], 96
    s_load_dwordx2 s[100:101], s[0:1], 88
    s_load_dwordx2 s[54:55], s[0:1], 80
    s_load_dwordx2 s[96:97], s[56:57], 32
    s_mov_b32 s92, 0x3e0293ee
    s_mov_b32 s93, s92
    s_mov_b32 s27, 0
    s_waitcnt lgkmcnt(0)
    s_cmp_ge_u32 s3, 5
    s_cbranch_scc0 L_k1_compute
    s_setprio 0
    s_sub_u32 s51, s3, 5
    s_mov_b32 s53, s51
    s_mov_b32 s43, s31
    s_cmp_eq_u32 s3, 7
    s_cbranch_scc1 L_k1_lb
    s_lshl_b32 s44, s26, 8
    s_add_u32 s8, s38, s44
    s_addc_u32 s9, s39, 0
    s_sub_u32 s10, 8388608, s44
    s_mov_b32 s11, 0x20000
    v_lshrrev_b32 v14, 4, v1
    v_and_b32 v15, 15, v1
    v_lshlrev_b32 v16, 1, v14
    v_xor_b32 v16, v16, v15
    v_lshlrev_b32 v16, 4, v16
    v_mul_u32_u24 v17, 8192, v14
    v_add_u32 v2, v16, v17
    v_xor_b32 v3, 128, v2
    s_mul_i32 s46, s51, 262144
    s_lshl_b32 s47, s51, 13
    s_mul_i32 s42, s43, 524288
    s_add_u32 s42, s42, s46
    s_add_u32 m0, s47, 18432
    s_add_u32 s44, s42, 0
    buffer_load_dwordx4 v2, s[8:11], s44 offen lds
    s_add_u32 m0, s47, 19456
    s_add_u32 s44, s42, 32768
    buffer_load_dwordx4 v2, s[8:11], s44 offen lds
    s_add_u32 m0, s47, 20480
    s_add_u32 s44, s42, 65536
    buffer_load_dwordx4 v3, s[8:11], s44 offen lds
    s_add_u32 m0, s47, 21504
    s_add_u32 s44, s42, 98304
    buffer_load_dwordx4 v3, s[8:11], s44 offen lds
    s_add_u32 m0, s47, 22528
    s_add_u32 s44, s42, 131072
    buffer_load_dwordx4 v2, s[8:11], s44 offen lds
    s_add_u32 m0, s47, 23552
    s_add_u32 s44, s42, 163840
    buffer_load_dwordx4 v2, s[8:11], s44 offen lds
    s_add_u32 m0, s47, 24576
    s_add_u32 s44, s42, 196608
    buffer_load_dwordx4 v3, s[8:11], s44 offen lds
    s_add_u32 m0, s47, 25600
    s_add_u32 s44, s42, 229376
    buffer_load_dwordx4 v3, s[8:11], s44 offen lds
    s_add_u32 s43, s43, 1
    s_and_b32 s43, s43, 15
    s_mul_i32 s42, s43, 524288
    s_add_u32 s42, s42, s46
    s_add_u32 m0, s47, 53248
    s_add_u32 s44, s42, 0
    buffer_load_dwordx4 v2, s[8:11], s44 offen lds
    s_add_u32 m0, s47, 54272
    s_add_u32 s44, s42, 32768
    buffer_load_dwordx4 v2, s[8:11], s44 offen lds
    s_add_u32 m0, s47, 55296
    s_add_u32 s44, s42, 65536
    buffer_load_dwordx4 v3, s[8:11], s44 offen lds
    s_add_u32 m0, s47, 56320
    s_add_u32 s44, s42, 98304
    buffer_load_dwordx4 v3, s[8:11], s44 offen lds
    s_add_u32 m0, s47, 57344
    s_add_u32 s44, s42, 131072
    buffer_load_dwordx4 v2, s[8:11], s44 offen lds
    s_add_u32 m0, s47, 58368
    s_add_u32 s44, s42, 163840
    buffer_load_dwordx4 v2, s[8:11], s44 offen lds
    s_add_u32 m0, s47, 59392
    s_add_u32 s44, s42, 196608
    buffer_load_dwordx4 v3, s[8:11], s44 offen lds
    s_add_u32 m0, s47, 60416
    s_add_u32 s44, s42, 229376
    buffer_load_dwordx4 v3, s[8:11], s44 offen lds
    s_add_u32 s43, s43, 1
    s_and_b32 s43, s43, 15
    s_waitcnt vmcnt(8)
    s_barrier
    s_mul_i32 s42, s43, 524288
    s_add_u32 s42, s42, s46
    s_add_u32 m0, s47, 88064
    s_add_u32 s44, s42, 0
    buffer_load_dwordx4 v2, s[8:11], s44 offen lds
    s_add_u32 m0, s47, 89088
    s_add_u32 s44, s42, 32768
    buffer_load_dwordx4 v2, s[8:11], s44 offen lds
    s_add_u32 m0, s47, 90112
    s_add_u32 s44, s42, 65536
    buffer_load_dwordx4 v3, s[8:11], s44 offen lds
    s_add_u32 m0, s47, 91136
    s_add_u32 s44, s42, 98304
    buffer_load_dwordx4 v3, s[8:11], s44 offen lds
    s_add_u32 m0, s47, 92160
    s_add_u32 s44, s42, 131072
    buffer_load_dwordx4 v2, s[8:11], s44 offen lds
    s_add_u32 m0, s47, 93184
    s_add_u32 s44, s42, 163840
    buffer_load_dwordx4 v2, s[8:11], s44 offen lds
    s_add_u32 m0, s47, 94208
    s_add_u32 s44, s42, 196608
    buffer_load_dwordx4 v3, s[8:11], s44 offen lds
    s_add_u32 m0, s47, 95232
    s_add_u32 s44, s42, 229376
    buffer_load_dwordx4 v3, s[8:11], s44 offen lds
    s_add_u32 s43, s43, 1
    s_and_b32 s43, s43, 15
    s_waitcnt vmcnt(8)
    s_barrier
    s_mul_i32 s42, s43, 524288
    s_add_u32 s42, s42, s46
    s_add_u32 m0, s47, 18432
    s_add_u32 s44, s42, 0
    buffer_load_dwordx4 v2, s[8:11], s44 offen lds
    s_add_u32 m0, s47, 19456
    s_add_u32 s44, s42, 32768
    buffer_load_dwordx4 v2, s[8:11], s44 offen lds
    s_add_u32 m0, s47, 20480
    s_add_u32 s44, s42, 65536
    buffer_load_dwordx4 v3, s[8:11], s44 offen lds
    s_add_u32 m0, s47, 21504
    s_add_u32 s44, s42, 98304
    buffer_load_dwordx4 v3, s[8:11], s44 offen lds
    s_add_u32 m0, s47, 22528
    s_add_u32 s44, s42, 131072
    buffer_load_dwordx4 v2, s[8:11], s44 offen lds
    s_add_u32 m0, s47, 23552
    s_add_u32 s44, s42, 163840
    buffer_load_dwordx4 v2, s[8:11], s44 offen lds
    s_add_u32 m0, s47, 24576
    s_add_u32 s44, s42, 196608
    buffer_load_dwordx4 v3, s[8:11], s44 offen lds
    s_add_u32 m0, s47, 25600
    s_add_u32 s44, s42, 229376
    buffer_load_dwordx4 v3, s[8:11], s44 offen lds
    s_add_u32 s43, s43, 1
    s_and_b32 s43, s43, 15
    v_lshrrev_b32 v14, 4, v1
    v_and_b32 v15, 15, v1
    v_lshrrev_b32 v16, 1, v15
    v_xor_b32 v16, v16, v14
    v_lshlrev_b32 v16, 4, v16
    v_lshl_add_u32 v16, v15, 7, v16
    s_mul_i32 s44, s53, 6144
    v_add_u32 v212, s44, v16
    v_xor_b32 v213, 64, v212
    v_lshrrev_b32 v16, 2, v15
    v_and_b32 v17, 1, v14
    v_lshl_add_u32 v17, v17, 2, v16
    v_lshlrev_b32 v18, 5, v17
    v_lshl_add_u32 v18, v14, 11, v18
    v_lshl_add_u32 v18, v16, 8, v18
    v_and_b32 v19, 3, v15
    v_lshl_add_u32 v18, v19, 3, v18
    v_add_u32 v214, 18432, v18
    v_xor_b32 v215, 32, v214
    v_xor_b32 v216, 64, v214
    v_xor_b32 v217, 96, v214
    v_xor_b32 v218, 128, v214
    v_xor_b32 v219, 160, v214
    v_xor_b32 v220, 192, v214
    v_xor_b32 v221, 224, v214
    v_mov_b32 v28, 0
    v_mov_b32 v29, 0
    v_mov_b32 v30, 0
    v_mov_b32 v31, 0
    v_mov_b32 v32, 0
    v_mov_b32 v33, 0
    v_mov_b32 v34, 0
    v_mov_b32 v35, 0
    v_mov_b32 v36, 0
    v_mov_b32 v37, 0
    v_mov_b32 v38, 0
    v_mov_b32 v39, 0
    v_mov_b32 v40, 0
    v_mov_b32 v41, 0
    v_mov_b32 v42, 0
    v_mov_b32 v43, 0
    v_mov_b32 v44, 0
    v_mov_b32 v45, 0
    v_mov_b32 v46, 0
    v_mov_b32 v47, 0
    v_mov_b32 v48, 0
    v_mov_b32 v49, 0
    v_mov_b32 v50, 0
    v_mov_b32 v51, 0
    v_mov_b32 v52, 0
    v_mov_b32 v53, 0
    v_mov_b32 v54, 0
    v_mov_b32 v55, 0
    v_mov_b32 v56, 0
    v_mov_b32 v57, 0
    v_mov_b32 v58, 0
    v_mov_b32 v59, 0
    v_mov_b32 v60, 0
    v_mov_b32 v61, 0
    v_mov_b32 v62, 0
    v_mov_b32 v63, 0
    v_mov_b32 v64, 0
    v_mov_b32 v65, 0
    v_mov_b32 v66, 0
    v_mov_b32 v67, 0
    v_mov_b32 v68, 0
    v_mov_b32 v69, 0
    v_mov_b32 v70, 0
    v_mov_b32 v71, 0
    v_mov_b32 v72, 0
    v_mov_b32 v73, 0
    v_mov_b32 v74, 0
    v_mov_b32 v75, 0
    v_mov_b32 v76, 0
    v_mov_b32 v77, 0
    v_mov_b32 v78, 0
    v_mov_b32 v79, 0
    v_mov_b32 v80, 0
    v_mov_b32 v81, 0
    v_mov_b32 v82, 0
    v_mov_b32 v83, 0
    v_mov_b32 v84, 0
    v_mov_b32 v85, 0
    v_mov_b32 v86, 0
    v_mov_b32 v87, 0
    v_mov_b32 v88, 0
    v_mov_b32 v89, 0
    v_mov_b32 v90, 0
    v_mov_b32 v91, 0
    v_mov_b32 v92, 0
    v_mov_b32 v93, 0
    v_mov_b32 v94, 0
    v_mov_b32 v95, 0
    v_mov_b32 v96, 0
    v_mov_b32 v97, 0
    v_mov_b32 v98, 0
    v_mov_b32 v99, 0
    v_mov_b32 v100, 0
    v_mov_b32 v101, 0
    v_mov_b32 v102, 0
    v_mov_b32 v103, 0
    v_mov_b32 v104, 0
    v_mov_b32 v105, 0
    v_mov_b32 v106, 0
    v_mov_b32 v107, 0
    v_mov_b32 v108, 0
    v_mov_b32 v109, 0
    v_mov_b32 v110, 0
    v_mov_b32 v111, 0
    v_mov_b32 v112, 0
    v_mov_b32 v113, 0
    v_mov_b32 v114, 0
    v_mov_b32 v115, 0
    v_mov_b32 v116, 0
    v_mov_b32 v117, 0
    v_mov_b32 v118, 0
    v_mov_b32 v119, 0
    v_mov_b32 v120, 0
    v_mov_b32 v121, 0
    v_mov_b32 v122, 0
    v_mov_b32 v123, 0
    s_waitcnt vmcnt(8)
    s_barrier
    s_mul_i32 s42, s43, 524288
    s_add_u32 s42, s42, s46
    s_add_u32 m0, s47, 53248
    s_add_u32 s44, s42, 0
    buffer_load_dwordx4 v2, s[8:11], s44 offen lds
    s_add_u32 m0, s47, 54272
    s_add_u32 s44, s42, 32768
    buffer_load_dwordx4 v2, s[8:11], s44 offen lds
    s_add_u32 m0, s47, 55296
    s_add_u32 s44, s42, 65536
    buffer_load_dwordx4 v3, s[8:11], s44 offen lds
    s_add_u32 m0, s47, 56320
    s_add_u32 s44, s42, 98304
    buffer_load_dwordx4 v3, s[8:11], s44 offen lds
    s_add_u32 m0, s47, 57344
    s_add_u32 s44, s42, 131072
    buffer_load_dwordx4 v2, s[8:11], s44 offen lds
    s_add_u32 m0, s47, 58368
    s_add_u32 s44, s42, 163840
    buffer_load_dwordx4 v2, s[8:11], s44 offen lds
    s_add_u32 m0, s47, 59392
    s_add_u32 s44, s42, 196608
    buffer_load_dwordx4 v3, s[8:11], s44 offen lds
    s_add_u32 m0, s47, 60416
    s_add_u32 s44, s42, 229376
    buffer_load_dwordx4 v3, s[8:11], s44 offen lds
    s_add_u32 s43, s43, 1
    s_and_b32 s43, s43, 15
    s_cmp_eq_u32 s53, 0
    s_cselect_b32 s74, s34, s36
    s_cselect_b32 s75, s35, s37
    s_lshl_b32 s50, s53, 13
    s_lshl_b32 s44, s25, 5
    s_add_u32 s44, s44, s26
    s_lshl_b32 s44, s44, 18
    s_add_u32 s12, s74, s44
    s_addc_u32 s13, s75, 0
    s_mov_b32 s14, 262144
    s_mov_b32 s15, 0x20000
    v_lshrrev_b32 v14, 4, v1
    v_and_b32 v15, 15, v1
    s_cmp_eq_u32 s53, 0
    s_cselect_b64 vcc, -1, 0
    v_add_u32 v16, 0, v14
    v_and_b32 v17, 7, v16
    v_lshlrev_b32 v17, 1, v17
    v_cndmask_b32 v17, v17, v16, vcc
    v_xor_b32 v17, v17, v15
    v_lshlrev_b32 v17, 4, v17
    v_lshl_add_u32 v4, v14, 8, v17
    v_add_u32 v16, 4, v14
    v_and_b32 v17, 7, v16
    v_lshlrev_b32 v17, 1, v17
    v_cndmask_b32 v17, v17, v16, vcc
    v_xor_b32 v17, v17, v15
    v_lshlrev_b32 v17, 4, v17
    v_lshl_add_u32 v5, v14, 8, v17
    v_add_u32 v16, 8, v14
    v_and_b32 v17, 7, v16
    v_lshlrev_b32 v17, 1, v17
    v_cndmask_b32 v17, v17, v16, vcc
    v_xor_b32 v17, v17, v15
    v_lshlrev_b32 v17, 4, v17
    v_lshl_add_u32 v6, v14, 8, v17
    v_add_u32 v16, 12, v14
    v_and_b32 v17, 7, v16
    v_lshlrev_b32 v17, 1, v17
    v_cndmask_b32 v17, v17, v16, vcc
    v_xor_b32 v17, v17, v15
    v_lshlrev_b32 v17, 4, v17
    v_lshl_add_u32 v7, v14, 8, v17
    s_mov_b32 s90, 0
    s_mov_b32 s48, s90
    s_mov_b32 s82, 114688
    s_waitcnt vmcnt(8)
    s_barrier
    s_mul_i32 s42, s43, 524288
    s_add_u32 s42, s42, s46
    s_add_u32 m0, s47, 88064
    s_add_u32 s44, s42, 0
    buffer_load_dwordx4 v2, s[8:11], s44 offen lds
    s_add_u32 m0, s47, 89088
    s_add_u32 s44, s42, 32768
    buffer_load_dwordx4 v2, s[8:11], s44 offen lds
    s_add_u32 m0, s47, 90112
    s_add_u32 s44, s42, 65536
    buffer_load_dwordx4 v3, s[8:11], s44 offen lds
    s_add_u32 m0, s47, 91136
    s_add_u32 s44, s42, 98304
    buffer_load_dwordx4 v3, s[8:11], s44 offen lds
    s_add_u32 m0, s47, 92160
    s_add_u32 s44, s42, 131072
    buffer_load_dwordx4 v2, s[8:11], s44 offen lds
    s_add_u32 m0, s47, 93184
    s_add_u32 s44, s42, 163840
    buffer_load_dwordx4 v2, s[8:11], s44 offen lds
    s_add_u32 m0, s47, 94208
    s_add_u32 s44, s42, 196608
    buffer_load_dwordx4 v3, s[8:11], s44 offen lds
    s_add_u32 m0, s47, 95232
    s_add_u32 s44, s42, 229376
    buffer_load_dwordx4 v3, s[8:11], s44 offen lds
    s_add_u32 s43, s43, 1
    s_and_b32 s43, s43, 15
    s_waitcnt vmcnt(8)
    s_barrier
    s_mul_i32 s42, s43, 524288
    s_add_u32 s42, s42, s46
    s_add_u32 m0, s47, 18432
    s_add_u32 s44, s42, 0
    buffer_load_dwordx4 v2, s[8:11], s44 offen lds
    s_add_u32 m0, s47, 19456
    s_add_u32 s44, s42, 32768
    buffer_load_dwordx4 v2, s[8:11], s44 offen lds
    s_add_u32 m0, s47, 20480
    s_add_u32 s44, s42, 65536
    buffer_load_dwordx4 v3, s[8:11], s44 offen lds
    s_add_u32 m0, s47, 21504
    s_add_u32 s44, s42, 98304
    buffer_load_dwordx4 v3, s[8:11], s44 offen lds
    s_add_u32 m0, s47, 22528
    s_add_u32 s44, s42, 131072
    buffer_load_dwordx4 v2, s[8:11], s44 offen lds
    s_add_u32 m0, s47, 23552
    s_add_u32 s44, s42, 163840
    buffer_load_dwordx4 v2, s[8:11], s44 offen lds
    s_add_u32 m0, s47, 24576
    s_add_u32 s44, s42, 196608
    buffer_load_dwordx4 v3, s[8:11], s44 offen lds
    s_add_u32 m0, s47, 25600
    s_add_u32 s44, s42, 229376
    buffer_load_dwordx4 v3, s[8:11], s44 offen lds
    s_add_u32 s43, s43, 1
    s_and_b32 s43, s43, 15
    s_waitcnt vmcnt(8)
    s_barrier
    s_mul_i32 s42, s43, 524288
    s_add_u32 s42, s42, s46
    s_add_u32 m0, s47, 53248
    s_add_u32 s44, s42, 0
    buffer_load_dwordx4 v2, s[8:11], s44 offen lds
    s_add_u32 m0, s47, 54272
    s_add_u32 s44, s42, 32768
    buffer_load_dwordx4 v2, s[8:11], s44 offen lds
    s_add_u32 m0, s47, 55296
    s_add_u32 s44, s42, 65536
    buffer_load_dwordx4 v3, s[8:11], s44 offen lds
    s_add_u32 m0, s47, 56320
    s_add_u32 s44, s42, 98304
    buffer_load_dwordx4 v3, s[8:11], s44 offen lds
    s_add_u32 m0, s47, 57344
    s_add_u32 s44, s42, 131072
    buffer_load_dwordx4 v2, s[8:11], s44 offen lds
    s_add_u32 m0, s47, 58368
    s_add_u32 s44, s42, 163840
    buffer_load_dwordx4 v2, s[8:11], s44 offen lds
    s_add_u32 m0, s47, 59392
    s_add_u32 s44, s42, 196608
    buffer_load_dwordx4 v3, s[8:11], s44 offen lds
    s_add_u32 m0, s47, 60416
    s_add_u32 s44, s42, 229376
    buffer_load_dwordx4 v3, s[8:11], s44 offen lds
    s_add_u32 s43, s43, 1
    s_and_b32 s43, s43, 15
    s_waitcnt vmcnt(8)
    s_barrier
    s_mul_i32 s42, s43, 524288
    s_add_u32 s42, s42, s46
    s_add_u32 m0, s47, 88064
    s_add_u32 s44, s42, 0
    buffer_load_dwordx4 v2, s[8:11], s44 offen lds
    s_add_u32 m0, s47, 89088
    s_add_u32 s44, s42, 32768
    buffer_load_dwordx4 v2, s[8:11], s44 offen lds
    s_add_u32 m0, s47, 90112
    s_add_u32 s44, s42, 65536
    buffer_load_dwordx4 v3, s[8:11], s44 offen lds
    s_add_u32 m0, s47, 91136
    s_add_u32 s44, s42, 98304
    buffer_load_dwordx4 v3, s[8:11], s44 offen lds
    s_add_u32 m0, s47, 92160
    s_add_u32 s44, s42, 131072
    buffer_load_dwordx4 v2, s[8:11], s44 offen lds
    s_add_u32 m0, s47, 93184
    s_add_u32 s44, s42, 163840
    buffer_load_dwordx4 v2, s[8:11], s44 offen lds
    s_add_u32 m0, s47, 94208
    s_add_u32 s44, s42, 196608
    buffer_load_dwordx4 v3, s[8:11], s44 offen lds
    s_add_u32 m0, s47, 95232
    s_add_u32 s44, s42, 229376
    buffer_load_dwordx4 v3, s[8:11], s44 offen lds
    s_add_u32 s43, s43, 1
    s_and_b32 s43, s43, 15
    s_add_u32 s45, s50, s82
    s_add_u32 m0, s45, 0
    s_add_u32 s44, s48, 0
    buffer_load_dwordx4 v4, s[12:15], s44 offen nt lds
    s_add_u32 m0, s45, 1024
    s_add_u32 s44, s48, 1024
    buffer_load_dwordx4 v5, s[12:15], s44 offen nt lds
    s_add_u32 m0, s45, 2048
    s_add_u32 s44, s48, 2048
    buffer_load_dwordx4 v6, s[12:15], s44 offen nt lds
    s_add_u32 m0, s45, 3072
    s_add_u32 s44, s48, 3072
    buffer_load_dwordx4 v7, s[12:15], s44 offen nt lds
    s_add_u32 m0, s45, 4096
    s_add_u32 s44, s48, 4096
    buffer_load_dwordx4 v4, s[12:15], s44 offen nt lds
    s_add_u32 m0, s45, 5120
    s_add_u32 s44, s48, 5120
    buffer_load_dwordx4 v5, s[12:15], s44 offen nt lds
    s_add_u32 m0, s45, 6144
    s_add_u32 s44, s48, 6144
    buffer_load_dwordx4 v6, s[12:15], s44 offen nt lds
    s_add_u32 m0, s45, 7168
    s_add_u32 s44, s48, 7168
    buffer_load_dwordx4 v7, s[12:15], s44 offen nt lds
    s_add_u32 s48, s48, 8192
    s_and_b32 s48, s48, 0x3ffff
    s_add_u32 s82, s82, 16384
    s_cmp_eq_u32 s82, 163840
    s_cselect_b32 s82, 81920, s82
    s_waitcnt vmcnt(16)
    s_barrier
    s_mul_i32 s42, s43, 524288
    s_add_u32 s42, s42, s46
    s_add_u32 m0, s47, 18432
    s_add_u32 s44, s42, 0
    buffer_load_dwordx4 v2, s[8:11], s44 offen lds
    s_add_u32 m0, s47, 19456
    s_add_u32 s44, s42, 32768
    buffer_load_dwordx4 v2, s[8:11], s44 offen lds
    s_add_u32 m0, s47, 20480
    s_add_u32 s44, s42, 65536
    buffer_load_dwordx4 v3, s[8:11], s44 offen lds
    s_add_u32 m0, s47, 21504
    s_add_u32 s44, s42, 98304
    buffer_load_dwordx4 v3, s[8:11], s44 offen lds
    s_add_u32 m0, s47, 22528
    s_add_u32 s44, s42, 131072
    buffer_load_dwordx4 v2, s[8:11], s44 offen lds
    s_add_u32 m0, s47, 23552
    s_add_u32 s44, s42, 163840
    buffer_load_dwordx4 v2, s[8:11], s44 offen lds
    s_add_u32 m0, s47, 24576
    s_add_u32 s44, s42, 196608
    buffer_load_dwordx4 v3, s[8:11], s44 offen lds
    s_add_u32 m0, s47, 25600
    s_add_u32 s44, s42, 229376
    buffer_load_dwordx4 v3, s[8:11], s44 offen lds
    s_add_u32 s43, s43, 1
    s_and_b32 s43, s43, 15
    s_waitcnt vmcnt(16)
    s_barrier
    s_mul_i32 s42, s43, 524288
    s_add_u32 s42, s42, s46
    s_add_u32 m0, s47, 53248
    s_add_u32 s44, s42, 0
    buffer_load_dwordx4 v2, s[8:11], s44 offen lds
    s_add_u32 m0, s47, 54272
    s_add_u32 s44, s42, 32768
    buffer_load_dwordx4 v2, s[8:11], s44 offen lds
    s_add_u32 m0, s47, 55296
    s_add_u32 s44, s42, 65536
    buffer_load_dwordx4 v3, s[8:11], s44 offen lds
    s_add_u32 m0, s47, 56320
    s_add_u32 s44, s42, 98304
    buffer_load_dwordx4 v3, s[8:11], s44 offen lds
    s_add_u32 m0, s47, 57344
    s_add_u32 s44, s42, 131072
    buffer_load_dwordx4 v2, s[8:11], s44 offen lds
    s_add_u32 m0, s47, 58368
    s_add_u32 s44, s42, 163840
    buffer_load_dwordx4 v2, s[8:11], s44 offen lds
    s_add_u32 m0, s47, 59392
    s_add_u32 s44, s42, 196608
    buffer_load_dwordx4 v3, s[8:11], s44 offen lds
    s_add_u32 m0, s47, 60416
    s_add_u32 s44, s42, 229376
    buffer_load_dwordx4 v3, s[8:11], s44 offen lds
    s_add_u32 s43, s43, 1
    s_and_b32 s43, s43, 15
    s_waitcnt vmcnt(8)
    s_barrier
    s_mul_i32 s42, s43, 524288
    s_add_u32 s42, s42, s46
    s_add_u32 m0, s47, 88064
    s_add_u32 s44, s42, 0
    buffer_load_dwordx4 v2, s[8:11], s44 offen lds
    s_add_u32 m0, s47, 89088
    s_add_u32 s44, s42, 32768
    buffer_load_dwordx4 v2, s[8:11], s44 offen lds
    s_add_u32 m0, s47, 90112
    s_add_u32 s44, s42, 65536
    buffer_load_dwordx4 v3, s[8:11], s44 offen lds
    s_add_u32 m0, s47, 91136
    s_add_u32 s44, s42, 98304
    buffer_load_dwordx4 v3, s[8:11], s44 offen lds
    s_add_u32 m0, s47, 92160
    s_add_u32 s44, s42, 131072
    buffer_load_dwordx4 v2, s[8:11], s44 offen lds
    s_add_u32 m0, s47, 93184
    s_add_u32 s44, s42, 163840
    buffer_load_dwordx4 v2, s[8:11], s44 offen lds
    s_add_u32 m0, s47, 94208
    s_add_u32 s44, s42, 196608
    buffer_load_dwordx4 v3, s[8:11], s44 offen lds
    s_add_u32 m0, s47, 95232
    s_add_u32 s44, s42, 229376
    buffer_load_dwordx4 v3, s[8:11], s44 offen lds
    s_add_u32 s43, s43, 1
    s_and_b32 s43, s43, 15
    s_add_u32 s45, s50, s82
    s_add_u32 m0, s45, 0
    s_add_u32 s44, s48, 0
    buffer_load_dwordx4 v4, s[12:15], s44 offen nt lds
    s_add_u32 m0, s45, 1024
    s_add_u32 s44, s48, 1024
    buffer_load_dwordx4 v5, s[12:15], s44 offen nt lds
    s_add_u32 m0, s45, 2048
    s_add_u32 s44, s48, 2048
    buffer_load_dwordx4 v6, s[12:15], s44 offen nt lds
    s_add_u32 m0, s45, 3072
    s_add_u32 s44, s48, 3072
    buffer_load_dwordx4 v7, s[12:15], s44 offen nt lds
    s_add_u32 m0, s45, 4096
    s_add_u32 s44, s48, 4096
    buffer_load_dwordx4 v4, s[12:15], s44 offen nt lds
    s_add_u32 m0, s45, 5120
    s_add_u32 s44, s48, 5120
    buffer_load_dwordx4 v5, s[12:15], s44 offen nt lds
    s_add_u32 m0, s45, 6144
    s_add_u32 s44, s48, 6144
    buffer_load_dwordx4 v6, s[12:15], s44 offen nt lds
    s_add_u32 m0, s45, 7168
    s_add_u32 s44, s48, 7168
    buffer_load_dwordx4 v7, s[12:15], s44 offen nt lds
    s_add_u32 s48, s48, 8192
    s_and_b32 s48, s48, 0x3ffff
    s_add_u32 s82, s82, 16384
    s_cmp_eq_u32 s82, 163840
    s_cselect_b32 s82, 81920, s82
    s_waitcnt vmcnt(16)
    s_barrier
    s_mul_i32 s42, s43, 524288
    s_add_u32 s42, s42, s46
    s_add_u32 m0, s47, 18432
    s_add_u32 s44, s42, 0
    buffer_load_dwordx4 v2, s[8:11], s44 offen lds
    s_add_u32 m0, s47, 19456
    s_add_u32 s44, s42, 32768
    buffer_load_dwordx4 v2, s[8:11], s44 offen lds
    s_add_u32 m0, s47, 20480
    s_add_u32 s44, s42, 65536
    buffer_load_dwordx4 v3, s[8:11], s44 offen lds
    s_add_u32 m0, s47, 21504
    s_add_u32 s44, s42, 98304
    buffer_load_dwordx4 v3, s[8:11], s44 offen lds
    s_add_u32 m0, s47, 22528
    s_add_u32 s44, s42, 131072
    buffer_load_dwordx4 v2, s[8:11], s44 offen lds
    s_add_u32 m0, s47, 23552
    s_add_u32 s44, s42, 163840
    buffer_load_dwordx4 v2, s[8:11], s44 offen lds
    s_add_u32 m0, s47, 24576
    s_add_u32 s44, s42, 196608
    buffer_load_dwordx4 v3, s[8:11], s44 offen lds
    s_add_u32 m0, s47, 25600
    s_add_u32 s44, s42, 229376
    buffer_load_dwordx4 v3, s[8:11], s44 offen lds
    s_add_u32 s43, s43, 1
    s_and_b32 s43, s43, 15
    s_waitcnt vmcnt(16)
    s_barrier
    s_mul_i32 s42, s43, 524288
    s_add_u32 s42, s42, s46
    s_add_u32 m0, s47, 53248
    s_add_u32 s44, s42, 0
    buffer_load_dwordx4 v2, s[8:11], s44 offen lds
    s_add_u32 m0, s47, 54272
    s_add_u32 s44, s42, 32768
    buffer_load_dwordx4 v2, s[8:11], s44 offen lds
    s_add_u32 m0, s47, 55296
    s_add_u32 s44, s42, 65536
    buffer_load_dwordx4 v3, s[8:11], s44 offen lds
    s_add_u32 m0, s47, 56320
    s_add_u32 s44, s42, 98304
    buffer_load_dwordx4 v3, s[8:11], s44 offen lds
    s_add_u32 m0, s47, 57344
    s_add_u32 s44, s42, 131072
    buffer_load_dwordx4 v2, s[8:11], s44 offen lds
    s_add_u32 m0, s47, 58368
    s_add_u32 s44, s42, 163840
    buffer_load_dwordx4 v2, s[8:11], s44 offen lds
    s_add_u32 m0, s47, 59392
    s_add_u32 s44, s42, 196608
    buffer_load_dwordx4 v3, s[8:11], s44 offen lds
    s_add_u32 m0, s47, 60416
    s_add_u32 s44, s42, 229376
    buffer_load_dwordx4 v3, s[8:11], s44 offen lds
    s_add_u32 s43, s43, 1
    s_and_b32 s43, s43, 15
    s_waitcnt vmcnt(8)
    s_barrier
    s_mul_i32 s42, s43, 524288
    s_add_u32 s42, s42, s46
    s_add_u32 m0, s47, 88064
    s_add_u32 s44, s42, 0
    buffer_load_dwordx4 v2, s[8:11], s44 offen lds
    s_add_u32 m0, s47, 89088
    s_add_u32 s44, s42, 32768
    buffer_load_dwordx4 v2, s[8:11], s44 offen lds
    s_add_u32 m0, s47, 90112
    s_add_u32 s44, s42, 65536
    buffer_load_dwordx4 v3, s[8:11], s44 offen lds
    s_add_u32 m0, s47, 91136
    s_add_u32 s44, s42, 98304
    buffer_load_dwordx4 v3, s[8:11], s44 offen lds
    s_add_u32 m0, s47, 92160
    s_add_u32 s44, s42, 131072
    buffer_load_dwordx4 v2, s[8:11], s44 offen lds
    s_add_u32 m0, s47, 93184
    s_add_u32 s44, s42, 163840
    buffer_load_dwordx4 v2, s[8:11], s44 offen lds
    s_add_u32 m0, s47, 94208
    s_add_u32 s44, s42, 196608
    buffer_load_dwordx4 v3, s[8:11], s44 offen lds
    s_add_u32 m0, s47, 95232
    s_add_u32 s44, s42, 229376
    buffer_load_dwordx4 v3, s[8:11], s44 offen lds
    s_add_u32 s43, s43, 1
    s_and_b32 s43, s43, 15
    s_add_u32 s45, s50, s82
    s_add_u32 m0, s45, 0
    s_add_u32 s44, s48, 0
    buffer_load_dwordx4 v4, s[12:15], s44 offen nt lds
    s_add_u32 m0, s45, 1024
    s_add_u32 s44, s48, 1024
    buffer_load_dwordx4 v5, s[12:15], s44 offen nt lds
    s_add_u32 m0, s45, 2048
    s_add_u32 s44, s48, 2048
    buffer_load_dwordx4 v6, s[12:15], s44 offen nt lds
    s_add_u32 m0, s45, 3072
    s_add_u32 s44, s48, 3072
    buffer_load_dwordx4 v7, s[12:15], s44 offen nt lds
    s_add_u32 m0, s45, 4096
    s_add_u32 s44, s48, 4096
    buffer_load_dwordx4 v4, s[12:15], s44 offen nt lds
    s_add_u32 m0, s45, 5120
    s_add_u32 s44, s48, 5120
    buffer_load_dwordx4 v5, s[12:15], s44 offen nt lds
    s_add_u32 m0, s45, 6144
    s_add_u32 s44, s48, 6144
    buffer_load_dwordx4 v6, s[12:15], s44 offen nt lds
    s_add_u32 m0, s45, 7168
    s_add_u32 s44, s48, 7168
    buffer_load_dwordx4 v7, s[12:15], s44 offen nt lds
    s_add_u32 s48, s48, 8192
    s_and_b32 s48, s48, 0x3ffff
    s_add_u32 s82, s82, 16384
    s_cmp_eq_u32 s82, 163840
    s_cselect_b32 s82, 81920, s82
    s_waitcnt vmcnt(16)
    s_barrier
    s_mul_i32 s42, s43, 524288
    s_add_u32 s42, s42, s46
    s_add_u32 m0, s47, 18432
    s_add_u32 s44, s42, 0
    buffer_load_dwordx4 v2, s[8:11], s44 offen lds
    s_add_u32 m0, s47, 19456
    s_add_u32 s44, s42, 32768
    buffer_load_dwordx4 v2, s[8:11], s44 offen lds
    s_add_u32 m0, s47, 20480
    s_add_u32 s44, s42, 65536
    buffer_load_dwordx4 v3, s[8:11], s44 offen lds
    s_add_u32 m0, s47, 21504
    s_add_u32 s44, s42, 98304
    buffer_load_dwordx4 v3, s[8:11], s44 offen lds
    s_add_u32 m0, s47, 22528
    s_add_u32 s44, s42, 131072
    buffer_load_dwordx4 v2, s[8:11], s44 offen lds
    s_add_u32 m0, s47, 23552
    s_add_u32 s44, s42, 163840
    buffer_load_dwordx4 v2, s[8:11], s44 offen lds
    s_add_u32 m0, s47, 24576
    s_add_u32 s44, s42, 196608
    buffer_load_dwordx4 v3, s[8:11], s44 offen lds
    s_add_u32 m0, s47, 25600
    s_add_u32 s44, s42, 229376
    buffer_load_dwordx4 v3, s[8:11], s44 offen lds
    s_add_u32 s43, s43, 1
    s_and_b32 s43, s43, 15
    s_waitcnt vmcnt(16)
    s_barrier
    s_waitcnt vmcnt(0)
    s_barrier
    s_waitcnt vmcnt(40)
    s_barrier
    s_barrier
    s_add_u32 s45, s50, s82
    s_add_u32 m0, s45, 0
    s_add_u32 s44, s48, 0
    buffer_load_dwordx4 v4, s[12:15], s44 offen nt lds
    s_add_u32 m0, s45, 1024
    s_add_u32 s44, s48, 1024
    buffer_load_dwordx4 v5, s[12:15], s44 offen nt lds
    s_add_u32 m0, s45, 2048
    s_add_u32 s44, s48, 2048
    buffer_load_dwordx4 v6, s[12:15], s44 offen nt lds
    s_add_u32 m0, s45, 3072
    s_add_u32 s44, s48, 3072
    buffer_load_dwordx4 v7, s[12:15], s44 offen nt lds
    s_add_u32 m0, s45, 4096
    s_add_u32 s44, s48, 4096
    buffer_load_dwordx4 v4, s[12:15], s44 offen nt lds
    s_add_u32 m0, s45, 5120
    s_add_u32 s44, s48, 5120
    buffer_load_dwordx4 v5, s[12:15], s44 offen nt lds
    s_add_u32 m0, s45, 6144
    s_add_u32 s44, s48, 6144
    buffer_load_dwordx4 v6, s[12:15], s44 offen nt lds
    s_add_u32 m0, s45, 7168
    s_add_u32 s44, s48, 7168
    buffer_load_dwordx4 v7, s[12:15], s44 offen nt lds
    s_add_u32 s48, s48, 8192
    s_and_b32 s48, s48, 0x3ffff
    s_add_u32 s82, s82, 16384
    s_cmp_eq_u32 s82, 163840
    s_cselect_b32 s82, 81920, s82
    s_add_u32 s45, s50, s82
    s_add_u32 m0, s45, 0
    s_add_u32 s44, s48, 0
    buffer_load_dwordx4 v4, s[12:15], s44 offen nt lds
    s_add_u32 m0, s45, 1024
    s_add_u32 s44, s48, 1024
    buffer_load_dwordx4 v5, s[12:15], s44 offen nt lds
    s_add_u32 m0, s45, 2048
    s_add_u32 s44, s48, 2048
    buffer_load_dwordx4 v6, s[12:15], s44 offen nt lds
    s_add_u32 m0, s45, 3072
    s_add_u32 s44, s48, 3072
    buffer_load_dwordx4 v7, s[12:15], s44 offen nt lds
    s_add_u32 m0, s45, 4096
    s_add_u32 s44, s48, 4096
    buffer_load_dwordx4 v4, s[12:15], s44 offen nt lds
    s_add_u32 m0, s45, 5120
    s_add_u32 s44, s48, 5120
    buffer_load_dwordx4 v5, s[12:15], s44 offen nt lds
    s_add_u32 m0, s45, 6144
    s_add_u32 s44, s48, 6144
    buffer_load_dwordx4 v6, s[12:15], s44 offen nt lds
    s_add_u32 m0, s45, 7168
    s_add_u32 s44, s48, 7168
    buffer_load_dwordx4 v7, s[12:15], s44 offen nt lds
    s_add_u32 s48, s48, 8192
    s_and_b32 s48, s48, 0x3ffff
    s_add_u32 s82, s82, 16384
    s_cmp_eq_u32 s82, 163840
    s_cselect_b32 s82, 81920, s82
    s_mov_b32 s49, 0
L_h1loop_1:
    ds_read_b128 v[124:127], v212 offset:34816
    ds_read_b128 v[128:131], v212 offset:36864
    ds_read_b128 v[132:135], v212 offset:38912
    ds_read_b64_tr_b16 v[148:149], v214 offset:34816
    ds_read_b64_tr_b16 v[150:151], v214 offset:35840
    ds_read_b64_tr_b16 v[152:153], v215 offset:34816
    ds_read_b64_tr_b16 v[154:155], v215 offset:35840
    ds_read_b64_tr_b16 v[156:157], v216 offset:34816
    ds_read_b64_tr_b16 v[158:159], v216 offset:35840
    ds_read_b64_tr_b16 v[160:161], v217 offset:34816
    ds_read_b64_tr_b16 v[162:163], v217 offset:35840
    ds_read_b64_tr_b16 v[164:165], v218 offset:34816
    ds_read_b64_tr_b16 v[166:167], v218 offset:35840
    ds_read_b64_tr_b16 v[168:169], v219 offset:34816
    ds_read_b64_tr_b16 v[170:171], v219 offset:35840
    ds_read_b64_tr_b16 v[172:173], v220 offset:34816
    ds_read_b64_tr_b16 v[174:175], v220 offset:35840
    ds_read_b64_tr_b16 v[176:177], v221 offset:34816
    ds_read_b64_tr_b16 v[178:179], v221 offset:35840
    ds_read_b128 v[136:139], v213 offset:34816
    ds_read_b128 v[140:143], v213 offset:36864
    ds_read_b128 v[144:147], v213 offset:38912
    ds_read_b64_tr_b16 v[180:181], v214 offset:43008
    ds_read_b64_tr_b16 v[182:183], v214 offset:44032
    ds_read_b64_tr_b16 v[184:185], v215 offset:43008
    ds_read_b64_tr_b16 v[186:187], v215 offset:44032
    ds_read_b64_tr_b16 v[188:189], v216 offset:43008
    ds_read_b64_tr_b16 v[190:191], v216 offset:44032
    ds_read_b64_tr_b16 v[192:193], v217 offset:43008
    ds_read_b64_tr_b16 v[194:195], v217 offset:44032
    ds_read_b64_tr_b16 v[196:197], v218 offset:43008
    ds_read_b64_tr_b16 v[198:199], v218 offset:44032
    ds_read_b64_tr_b16 v[200:201], v219 offset:43008
    ds_read_b64_tr_b16 v[202:203], v219 offset:44032
    ds_read_b64_tr_b16 v[204:205], v220 offset:43008
    ds_read_b64_tr_b16 v[206:207], v220 offset:44032
    ds_read_b64_tr_b16 v[208:209], v221 offset:43008
    ds_read_b64_tr_b16 v[210:211], v221 offset:44032
    s_waitcnt lgkmcnt(15)
    v_mfma_f32_16x16x32_bf16 v[28:31], v[148:151], v[124:127], v[28:31]
    v_mfma_f32_16x16x32_bf16 v[60:63], v[148:151], v[128:131], v[60:63]
    v_mfma_f32_16x16x32_bf16 v[92:95], v[148:151], v[132:135], v[92:95]
    v_mfma_f32_16x16x32_bf16 v[32:35], v[152:155], v[124:127], v[32:35]
    v_mfma_f32_16x16x32_bf16 v[64:67], v[152:155], v[128:131], v[64:67]
    v_mfma_f32_16x16x32_bf16 v[96:99], v[152:155], v[132:135], v[96:99]
    v_mfma_f32_16x16x32_bf16 v[36:39], v[156:159], v[124:127], v[36:39]
    v_mfma_f32_16x16x32_bf16 v[68:71], v[156:159], v[128:131], v[68:71]
    v_mfma_f32_16x16x32_bf16 v[100:103], v[156:159], v[132:135], v[100:103]
    v_mfma_f32_16x16x32_bf16 v[40:43], v[160:163], v[124:127], v[40:43]
    v_mfma_f32_16x16x32_bf16 v[72:75], v[160:163], v[128:131], v[72:75]
    v_mfma_f32_16x16x32_bf16 v[104:107], v[160:163], v[132:135], v[104:107]
    v_mfma_f32_16x16x32_bf16 v[44:47], v[164:167], v[124:127], v[44:47]
    v_mfma_f32_16x16x32_bf16 v[76:79], v[164:167], v[128:131], v[76:79]
    v_mfma_f32_16x16x32_bf16 v[108:111], v[164:167], v[132:135], v[108:111]
    v_mfma_f32_16x16x32_bf16 v[48:51], v[168:171], v[124:127], v[48:51]
    v_mfma_f32_16x16x32_bf16 v[80:83], v[168:171], v[128:131], v[80:83]
    v_mfma_f32_16x16x32_bf16 v[112:115], v[168:171], v[132:135], v[112:115]
    v_mfma_f32_16x16x32_bf16 v[52:55], v[172:175], v[124:127], v[52:55]
    v_mfma_f32_16x16x32_bf16 v[84:87], v[172:175], v[128:131], v[84:87]
    v_mfma_f32_16x16x32_bf16 v[116:119], v[172:175], v[132:135], v[116:119]
    v_mfma_f32_16x16x32_bf16 v[56:59], v[176:179], v[124:127], v[56:59]
    v_mfma_f32_16x16x32_bf16 v[88:91], v[176:179], v[128:131], v[88:91]
    v_mfma_f32_16x16x32_bf16 v[120:123], v[176:179], v[132:135], v[120:123]
    s_waitcnt lgkmcnt(0)
    s_waitcnt vmcnt(16)
    s_barrier
    s_add_u32 s45, s50, s82
    s_add_u32 m0, s45, 0
    s_add_u32 s44, s48, 0
    buffer_load_dwordx4 v4, s[12:15], s44 offen nt lds
    s_add_u32 m0, s45, 1024
    s_add_u32 s44, s48, 1024
    buffer_load_dwordx4 v5, s[12:15], s44 offen nt lds
    s_add_u32 m0, s45, 2048
    s_add_u32 s44, s48, 2048
    buffer_load_dwordx4 v6, s[12:15], s44 offen nt lds
    s_add_u32 m0, s45, 3072
    s_add_u32 s44, s48, 3072
    buffer_load_dwordx4 v7, s[12:15], s44 offen nt lds
    s_add_u32 m0, s45, 4096
    s_add_u32 s44, s48, 4096
    buffer_load_dwordx4 v4, s[12:15], s44 offen nt lds
    s_add_u32 m0, s45, 5120
    s_add_u32 s44, s48, 5120
    buffer_load_dwordx4 v5, s[12:15], s44 offen nt lds
    s_add_u32 m0, s45, 6144
    s_add_u32 s44, s48, 6144
    buffer_load_dwordx4 v6, s[12:15], s44 offen nt lds
    s_add_u32 m0, s45, 7168
    s_add_u32 s44, s48, 7168
    buffer_load_dwordx4 v7, s[12:15], s44 offen nt lds
    s_add_u32 s48, s48, 8192
    s_and_b32 s48, s48, 0x3ffff
    s_add_u32 s82, s82, 16384
    s_cmp_eq_u32 s82, 163840
    s_cselect_b32 s82, 81920, s82
    v_mfma_f32_16x16x32_bf16 v[28:31], v[180:183], v[136:139], v[28:31]
    v_mfma_f32_16x16x32_bf16 v[60:63], v[180:183], v[140:143], v[60:63]
    v_mfma_f32_16x16x32_bf16 v[92:95], v[180:183], v[144:147], v[92:95]
    v_mfma_f32_16x16x32_bf16 v[32:35], v[184:187], v[136:139], v[32:35]
    v_mfma_f32_16x16x32_bf16 v[64:67], v[184:187], v[140:143], v[64:67]
    v_mfma_f32_16x16x32_bf16 v[96:99], v[184:187], v[144:147], v[96:99]
    v_mfma_f32_16x16x32_bf16 v[36:39], v[188:191], v[136:139], v[36:39]
    v_mfma_f32_16x16x32_bf16 v[68:71], v[188:191], v[140:143], v[68:71]
    v_mfma_f32_16x16x32_bf16 v[100:103], v[188:191], v[144:147], v[100:103]
    v_mfma_f32_16x16x32_bf16 v[40:43], v[192:195], v[136:139], v[40:43]
    v_mfma_f32_16x16x32_bf16 v[72:75], v[192:195], v[140:143], v[72:75]
    v_mfma_f32_16x16x32_bf16 v[104:107], v[192:195], v[144:147], v[104:107]
    v_mfma_f32_16x16x32_bf16 v[44:47], v[196:199], v[136:139], v[44:47]
    v_mfma_f32_16x16x32_bf16 v[76:79], v[196:199], v[140:143], v[76:79]
    v_mfma_f32_16x16x32_bf16 v[108:111], v[196:199], v[144:147], v[108:111]
    v_mfma_f32_16x16x32_bf16 v[48:51], v[200:203], v[136:139], v[48:51]
    v_mfma_f32_16x16x32_bf16 v[80:83], v[200:203], v[140:143], v[80:83]
    v_mfma_f32_16x16x32_bf16 v[112:115], v[200:203], v[144:147], v[112:115]
    v_mfma_f32_16x16x32_bf16 v[52:55], v[204:207], v[136:139], v[52:55]
    v_mfma_f32_16x16x32_bf16 v[84:87], v[204:207], v[140:143], v[84:87]
    v_mfma_f32_16x16x32_bf16 v[116:119], v[204:207], v[144:147], v[116:119]
    v_mfma_f32_16x16x32_bf16 v[56:59], v[208:211], v[136:139], v[56:59]
    v_mfma_f32_16x16x32_bf16 v[88:91], v[208:211], v[140:143], v[88:91]
    v_mfma_f32_16x16x32_bf16 v[120:123], v[208:211], v[144:147], v[120:123]
    s_waitcnt vmcnt(16)
    s_barrier
    s_add_u32 s45, s50, s82
    s_add_u32 m0, s45, 0
    s_add_u32 s44, s48, 0
    buffer_load_dwordx4 v4, s[12:15], s44 offen nt lds
    s_add_u32 m0, s45, 1024
    s_add_u32 s44, s48, 1024
    buffer_load_dwordx4 v5, s[12:15], s44 offen nt lds
    s_add_u32 m0, s45, 2048
    s_add_u32 s44, s48, 2048
    buffer_load_dwordx4 v6, s[12:15], s44 offen nt lds
    s_add_u32 m0, s45, 3072
    s_add_u32 s44, s48, 3072
    buffer_load_dwordx4 v7, s[12:15], s44 offen nt lds
    s_add_u32 m0, s45, 4096
    s_add_u32 s44, s48, 4096
    buffer_load_dwordx4 v4, s[12:15], s44 offen nt lds
    s_add_u32 m0, s45, 5120
    s_add_u32 s44, s48, 5120
    buffer_load_dwordx4 v5, s[12:15], s44 offen nt lds
    s_add_u32 m0, s45, 6144
    s_add_u32 s44, s48, 6144
    buffer_load_dwordx4 v6, s[12:15], s44 offen nt lds
    s_add_u32 m0, s45, 7168
    s_add_u32 s44, s48, 7168
    buffer_load_dwordx4 v7, s[12:15], s44 offen nt lds
    s_add_u32 s48, s48, 8192
    s_and_b32 s48, s48, 0x3ffff
    s_add_u32 s82, s82, 16384
    s_cmp_eq_u32 s82, 163840
    s_cselect_b32 s82, 81920, s82
    ds_read_b128 v[124:127], v212 offset:0
    ds_read_b128 v[128:131], v212 offset:2048
    ds_read_b128 v[132:135], v212 offset:4096
    ds_read_b64_tr_b16 v[148:149], v214 offset:0
    ds_read_b64_tr_b16 v[150:151], v214 offset:1024
    ds_read_b64_tr_b16 v[152:153], v215 offset:0
    ds_read_b64_tr_b16 v[154:155], v215 offset:1024
    ds_read_b64_tr_b16 v[156:157], v216 offset:0
    ds_read_b64_tr_b16 v[158:159], v216 offset:1024
    ds_read_b64_tr_b16 v[160:161], v217 offset:0
    ds_read_b64_tr_b16 v[162:163], v217 offset:1024
    ds_read_b64_tr_b16 v[164:165], v218 offset:0
    ds_read_b64_tr_b16 v[166:167], v218 offset:1024
    ds_read_b64_tr_b16 v[168:169], v219 offset:0
    ds_read_b64_tr_b16 v[170:171], v219 offset:1024
    ds_read_b64_tr_b16 v[172:173], v220 offset:0
    ds_read_b64_tr_b16 v[174:175], v220 offset:1024
    ds_read_b64_tr_b16 v[176:177], v221 offset:0
    ds_read_b64_tr_b16 v[178:179], v221 offset:1024
    ds_read_b128 v[136:139], v213 offset:0
    ds_read_b128 v[140:143], v213 offset:2048
    ds_read_b128 v[144:147], v213 offset:4096
    ds_read_b64_tr_b16 v[180:181], v214 offset:8192
    ds_read_b64_tr_b16 v[182:183], v214 offset:9216
    ds_read_b64_tr_b16 v[184:185], v215 offset:8192
    ds_read_b64_tr_b16 v[186:187], v215 offset:9216
    ds_read_b64_tr_b16 v[188:189], v216 offset:8192
    ds_read_b64_tr_b16 v[190:191], v216 offset:9216
    ds_read_b64_tr_b16 v[192:193], v217 offset:8192
    ds_read_b64_tr_b16 v[194:195], v217 offset:9216
    ds_read_b64_tr_b16 v[196:197], v218 offset:8192
    ds_read_b64_tr_b16 v[198:199], v218 offset:9216
    ds_read_b64_tr_b16 v[200:201], v219 offset:8192
    ds_read_b64_tr_b16 v[202:203], v219 offset:9216
    ds_read_b64_tr_b16 v[204:205], v220 offset:8192
    ds_read_b64_tr_b16 v[206:207], v220 offset:9216
    ds_read_b64_tr_b16 v[208:209], v221 offset:8192
    ds_read_b64_tr_b16 v[210:211], v221 offset:9216
    s_waitcnt lgkmcnt(15)
    v_mfma_f32_16x16x32_bf16 v[28:31], v[148:151], v[124:127], v[28:31]
    v_mfma_f32_16x16x32_bf16 v[60:63], v[148:151], v[128:131], v[60:63]
    v_mfma_f32_16x16x32_bf16 v[92:95], v[148:151], v[132:135], v[92:95]
    v_mfma_f32_16x16x32_bf16 v[32:35], v[152:155], v[124:127], v[32:35]
    v_mfma_f32_16x16x32_bf16 v[64:67], v[152:155], v[128:131], v[64:67]
    v_mfma_f32_16x16x32_bf16 v[96:99], v[152:155], v[132:135], v[96:99]
    v_mfma_f32_16x16x32_bf16 v[36:39], v[156:159], v[124:127], v[36:39]
    v_mfma_f32_16x16x32_bf16 v[68:71], v[156:159], v[128:131], v[68:71]
    v_mfma_f32_16x16x32_bf16 v[100:103], v[156:159], v[132:135], v[100:103]
    v_mfma_f32_16x16x32_bf16 v[40:43], v[160:163], v[124:127], v[40:43]
    v_mfma_f32_16x16x32_bf16 v[72:75], v[160:163], v[128:131], v[72:75]
    v_mfma_f32_16x16x32_bf16 v[104:107], v[160:163], v[132:135], v[104:107]
    v_mfma_f32_16x16x32_bf16 v[44:47], v[164:167], v[124:127], v[44:47]
    v_mfma_f32_16x16x32_bf16 v[76:79], v[164:167], v[128:131], v[76:79]
    v_mfma_f32_16x16x32_bf16 v[108:111], v[164:167], v[132:135], v[108:111]
    v_mfma_f32_16x16x32_bf16 v[48:51], v[168:171], v[124:127], v[48:51]
    v_mfma_f32_16x16x32_bf16 v[80:83], v[168:171], v[128:131], v[80:83]
    v_mfma_f32_16x16x32_bf16 v[112:115], v[168:171], v[132:135], v[112:115]
    v_mfma_f32_16x16x32_bf16 v[52:55], v[172:175], v[124:127], v[52:55]
    v_mfma_f32_16x16x32_bf16 v[84:87], v[172:175], v[128:131], v[84:87]
    v_mfma_f32_16x16x32_bf16 v[116:119], v[172:175], v[132:135], v[116:119]
    v_mfma_f32_16x16x32_bf16 v[56:59], v[176:179], v[124:127], v[56:59]
    v_mfma_f32_16x16x32_bf16 v[88:91], v[176:179], v[128:131], v[88:91]
    v_mfma_f32_16x16x32_bf16 v[120:123], v[176:179], v[132:135], v[120:123]
    s_waitcnt lgkmcnt(0)
    s_waitcnt vmcnt(16)
    s_barrier
    s_add_u32 s45, s50, s82
    s_add_u32 m0, s45, 0
    s_add_u32 s44, s48, 0
    buffer_load_dwordx4 v4, s[12:15], s44 offen nt lds
    s_add_u32 m0, s45, 1024
    s_add_u32 s44, s48, 1024
    buffer_load_dwordx4 v5, s[12:15], s44 offen nt lds
    s_add_u32 m0, s45, 2048
    s_add_u32 s44, s48, 2048
    buffer_load_dwordx4 v6, s[12:15], s44 offen nt lds
    s_add_u32 m0, s45, 3072
    s_add_u32 s44, s48, 3072
    buffer_load_dwordx4 v7, s[12:15], s44 offen nt lds
    s_add_u32 m0, s45, 4096
    s_add_u32 s44, s48, 4096
    buffer_load_dwordx4 v4, s[12:15], s44 offen nt lds
    s_add_u32 m0, s45, 5120
    s_add_u32 s44, s48, 5120
    buffer_load_dwordx4 v5, s[12:15], s44 offen nt lds
    s_add_u32 m0, s45, 6144
    s_add_u32 s44, s48, 6144
    buffer_load_dwordx4 v6, s[12:15], s44 offen nt lds
    s_add_u32 m0, s45, 7168
    s_add_u32 s44, s48, 7168
    buffer_load_dwordx4 v7, s[12:15], s44 offen nt lds
    s_add_u32 s48, s48, 8192
    s_and_b32 s48, s48, 0x3ffff
    s_add_u32 s82, s82, 16384
    s_cmp_eq_u32 s82, 163840
    s_cselect_b32 s82, 81920, s82
    v_mfma_f32_16x16x32_bf16 v[28:31], v[180:183], v[136:139], v[28:31]
    v_mfma_f32_16x16x32_bf16 v[60:63], v[180:183], v[140:143], v[60:63]
    v_mfma_f32_16x16x32_bf16 v[92:95], v[180:183], v[144:147], v[92:95]
    v_mfma_f32_16x16x32_bf16 v[32:35], v[184:187], v[136:139], v[32:35]
    v_mfma_f32_16x16x32_bf16 v[64:67], v[184:187], v[140:143], v[64:67]
    v_mfma_f32_16x16x32_bf16 v[96:99], v[184:187], v[144:147], v[96:99]
    v_mfma_f32_16x16x32_bf16 v[36:39], v[188:191], v[136:139], v[36:39]
    v_mfma_f32_16x16x32_bf16 v[68:71], v[188:191], v[140:143], v[68:71]
    v_mfma_f32_16x16x32_bf16 v[100:103], v[188:191], v[144:147], v[100:103]
    v_mfma_f32_16x16x32_bf16 v[40:43], v[192:195], v[136:139], v[40:43]
    v_mfma_f32_16x16x32_bf16 v[72:75], v[192:195], v[140:143], v[72:75]
    v_mfma_f32_16x16x32_bf16 v[104:107], v[192:195], v[144:147], v[104:107]
    v_mfma_f32_16x16x32_bf16 v[44:47], v[196:199], v[136:139], v[44:47]
    v_mfma_f32_16x16x32_bf16 v[76:79], v[196:199], v[140:143], v[76:79]
    v_mfma_f32_16x16x32_bf16 v[108:111], v[196:199], v[144:147], v[108:111]
    v_mfma_f32_16x16x32_bf16 v[48:51], v[200:203], v[136:139], v[48:51]
    v_mfma_f32_16x16x32_bf16 v[80:83], v[200:203], v[140:143], v[80:83]
    v_mfma_f32_16x16x32_bf16 v[112:115], v[200:203], v[144:147], v[112:115]
    v_mfma_f32_16x16x32_bf16 v[52:55], v[204:207], v[136:139], v[52:55]
    v_mfma_f32_16x16x32_bf16 v[84:87], v[204:207], v[140:143], v[84:87]
    v_mfma_f32_16x16x32_bf16 v[116:119], v[204:207], v[144:147], v[116:119]
    v_mfma_f32_16x16x32_bf16 v[56:59], v[208:211], v[136:139], v[56:59]
    v_mfma_f32_16x16x32_bf16 v[88:91], v[208:211], v[140:143], v[88:91]
    v_mfma_f32_16x16x32_bf16 v[120:123], v[208:211], v[144:147], v[120:123]
    s_waitcnt vmcnt(16)
    s_barrier
    s_cmp_eq_u32 s49, 6
    s_cbranch_scc0 L_sk_2
    s_add_u32 s26, s26, 4
    s_lshl_b32 s44, s25, 5
    s_add_u32 s44, s44, s26
    s_lshl_b32 s44, s44, 18
    s_add_u32 s12, s74, s44
    s_addc_u32 s13, s75, 0
    s_mov_b32 s14, 262144
    s_mov_b32 s15, 0x20000
    s_mov_b32 s48, s90
L_sk_2:
    s_add_u32 s45, s50, s82
    s_add_u32 m0, s45, 0
    s_add_u32 s44, s48, 0
    buffer_load_dwordx4 v4, s[12:15], s44 offen nt lds
    s_add_u32 m0, s45, 1024
    s_add_u32 s44, s48, 1024
    buffer_load_dwordx4 v5, s[12:15], s44 offen nt lds
    s_add_u32 m0, s45, 2048
    s_add_u32 s44, s48, 2048
    buffer_load_dwordx4 v6, s[12:15], s44 offen nt lds
    s_add_u32 m0, s45, 3072
    s_add_u32 s44, s48, 3072
    buffer_load_dwordx4 v7, s[12:15], s44 offen nt lds
    s_add_u32 m0, s45, 4096
    s_add_u32 s44, s48, 4096
    buffer_load_dwordx4 v4, s[12:15], s44 offen nt lds
    s_add_u32 m0, s45, 5120
    s_add_u32 s44, s48, 5120
    buffer_load_dwordx4 v5, s[12:15], s44 offen nt lds
    s_add_u32 m0, s45, 6144
    s_add_u32 s44, s48, 6144
    buffer_load_dwordx4 v6, s[12:15], s44 offen nt lds
    s_add_u32 m0, s45, 7168
    s_add_u32 s44, s48, 7168
    buffer_load_dwordx4 v7, s[12:15], s44 offen nt lds
    s_add_u32 s48, s48, 8192
    s_and_b32 s48, s48, 0x3ffff
    s_add_u32 s82, s82, 16384
    s_cmp_eq_u32 s82, 163840
    s_cselect_b32 s82, 81920, s82
    s_add_u32 s49, s49, 1
    s_cmp_lt_u32 s49, 7
    s_cbranch_scc1 L_h1loop_1
    ds_read_b128 v[124:127], v212 offset:34816
    ds_read_b128 v[128:131], v212 offset:36864
    ds_read_b128 v[132:135], v212 offset:38912
    ds_read_b64_tr_b16 v[148:149], v214 offset:34816
    ds_read_b64_tr_b16 v[150:151], v214 offset:35840
    ds_read_b64_tr_b16 v[152:153], v215 offset:34816
    ds_read_b64_tr_b16 v[154:155], v215 offset:35840
    ds_read_b64_tr_b16 v[156:157], v216 offset:34816
    ds_read_b64_tr_b16 v[158:159], v216 offset:35840
    ds_read_b64_tr_b16 v[160:161], v217 offset:34816
    ds_read_b64_tr_b16 v[162:163], v217 offset:35840
    ds_read_b64_tr_b16 v[164:165], v218 offset:34816
    ds_read_b64_tr_b16 v[166:167], v218 offset:35840
    ds_read_b64_tr_b16 v[168:169], v219 offset:34816
    ds_read_b64_tr_b16 v[170:171], v219 offset:35840
    ds_read_b64_tr_b16 v[172:173], v220 offset:34816
    ds_read_b64_tr_b16 v[174:175], v220 offset:35840
    ds_read_b64_tr_b16 v[176:177], v221 offset:34816
    ds_read_b64_tr_b16 v[178:179], v221 offset:35840
    ds_read_b128 v[136:139], v213 offset:34816
    ds_read_b128 v[140:143], v213 offset:36864
    ds_read_b128 v[144:147], v213 offset:38912
    ds_read_b64_tr_b16 v[180:181], v214 offset:43008
    ds_read_b64_tr_b16 v[182:183], v214 offset:44032
    ds_read_b64_tr_b16 v[184:185], v215 offset:43008
    ds_read_b64_tr_b16 v[186:187], v215 offset:44032
    ds_read_b64_tr_b16 v[188:189], v216 offset:43008
    ds_read_b64_tr_b16 v[190:191], v216 offset:44032
    ds_read_b64_tr_b16 v[192:193], v217 offset:43008
    ds_read_b64_tr_b16 v[194:195], v217 offset:44032
    ds_read_b64_tr_b16 v[196:197], v218 offset:43008
    ds_read_b64_tr_b16 v[198:199], v218 offset:44032
    ds_read_b64_tr_b16 v[200:201], v219 offset:43008
    ds_read_b64_tr_b16 v[202:203], v219 offset:44032
    ds_read_b64_tr_b16 v[204:205], v220 offset:43008
    ds_read_b64_tr_b16 v[206:207], v220 offset:44032
    ds_read_b64_tr_b16 v[208:209], v221 offset:43008
    ds_read_b64_tr_b16 v[210:211], v221 offset:44032
    s_waitcnt lgkmcnt(15)
    v_mfma_f32_16x16x32_bf16 v[28:31], v[148:151], v[124:127], v[28:31]
    v_mfma_f32_16x16x32_bf16 v[60:63], v[148:151], v[128:131], v[60:63]
    v_mfma_f32_16x16x32_bf16 v[92:95], v[148:151], v[132:135], v[92:95]
    v_mfma_f32_16x16x32_bf16 v[32:35], v[152:155], v[124:127], v[32:35]
    v_mfma_f32_16x16x32_bf16 v[64:67], v[152:155], v[128:131], v[64:67]
    v_mfma_f32_16x16x32_bf16 v[96:99], v[152:155], v[132:135], v[96:99]
    v_mfma_f32_16x16x32_bf16 v[36:39], v[156:159], v[124:127], v[36:39]
    v_mfma_f32_16x16x32_bf16 v[68:71], v[156:159], v[128:131], v[68:71]
    v_mfma_f32_16x16x32_bf16 v[100:103], v[156:159], v[132:135], v[100:103]
    v_mfma_f32_16x16x32_bf16 v[40:43], v[160:163], v[124:127], v[40:43]
    v_mfma_f32_16x16x32_bf16 v[72:75], v[160:163], v[128:131], v[72:75]
    v_mfma_f32_16x16x32_bf16 v[104:107], v[160:163], v[132:135], v[104:107]
    v_mfma_f32_16x16x32_bf16 v[44:47], v[164:167], v[124:127], v[44:47]
    v_mfma_f32_16x16x32_bf16 v[76:79], v[164:167], v[128:131], v[76:79]
    v_mfma_f32_16x16x32_bf16 v[108:111], v[164:167], v[132:135], v[108:111]
    v_mfma_f32_16x16x32_bf16 v[48:51], v[168:171], v[124:127], v[48:51]
    v_mfma_f32_16x16x32_bf16 v[80:83], v[168:171], v[128:131], v[80:83]
    v_mfma_f32_16x16x32_bf16 v[112:115], v[168:171], v[132:135], v[112:115]
    v_mfma_f32_16x16x32_bf16 v[52:55], v[172:175], v[124:127], v[52:55]
    v_mfma_f32_16x16x32_bf16 v[84:87], v[172:175], v[128:131], v[84:87]
    v_mfma_f32_16x16x32_bf16 v[116:119], v[172:175], v[132:135], v[116:119]
    v_mfma_f32_16x16x32_bf16 v[56:59], v[176:179], v[124:127], v[56:59]
    v_mfma_f32_16x16x32_bf16 v[88:91], v[176:179], v[128:131], v[88:91]
    v_mfma_f32_16x16x32_bf16 v[120:123], v[176:179], v[132:135], v[120:123]
    s_waitcnt lgkmcnt(0)
    s_waitcnt vmcnt(16)
    s_barrier
    s_add_u32 s45, s50, s82
    s_add_u32 m0, s45, 0
    s_add_u32 s44, s48, 0
    buffer_load_dwordx4 v4, s[12:15], s44 offen nt lds
    s_add_u32 m0, s45, 1024
    s_add_u32 s44, s48, 1024
    buffer_load_dwordx4 v5, s[12:15], s44 offen nt lds
    s_add_u32 m0, s45, 2048
    s_add_u32 s44, s48, 2048
    buffer_load_dwordx4 v6, s[12:15], s44 offen nt lds
    s_add_u32 m0, s45, 3072
    s_add_u32 s44, s48, 3072
    buffer_load_dwordx4 v7, s[12:15], s44 offen nt lds
    s_add_u32 m0, s45, 4096
    s_add_u32 s44, s48, 4096
    buffer_load_dwordx4 v4, s[12:15], s44 offen nt lds
    s_add_u32 m0, s45, 5120
    s_add_u32 s44, s48, 5120
    buffer_load_dwordx4 v5, s[12:15], s44 offen nt lds
    s_add_u32 m0, s45, 6144
    s_add_u32 s44, s48, 6144
    buffer_load_dwordx4 v6, s[12:15], s44 offen nt lds
    s_add_u32 m0, s45, 7168
    s_add_u32 s44, s48, 7168
    buffer_load_dwordx4 v7, s[12:15], s44 offen nt lds
    s_add_u32 s48, s48, 8192
    s_and_b32 s48, s48, 0x3ffff
    s_add_u32 s82, s82, 16384
    s_cmp_eq_u32 s82, 163840
    s_cselect_b32 s82, 81920, s82
    v_mfma_f32_16x16x32_bf16 v[28:31], v[180:183], v[136:139], v[28:31]
    v_mfma_f32_16x16x32_bf16 v[60:63], v[180:183], v[140:143], v[60:63]
    v_mfma_f32_16x16x32_bf16 v[92:95], v[180:183], v[144:147], v[92:95]
    v_mfma_f32_16x16x32_bf16 v[32:35], v[184:187], v[136:139], v[32:35]
    v_mfma_f32_16x16x32_bf16 v[64:67], v[184:187], v[140:143], v[64:67]
    v_mfma_f32_16x16x32_bf16 v[96:99], v[184:187], v[144:147], v[96:99]
    v_mfma_f32_16x16x32_bf16 v[36:39], v[188:191], v[136:139], v[36:39]
    v_mfma_f32_16x16x32_bf16 v[68:71], v[188:191], v[140:143], v[68:71]
    v_mfma_f32_16x16x32_bf16 v[100:103], v[188:191], v[144:147], v[100:103]
    v_mfma_f32_16x16x32_bf16 v[40:43], v[192:195], v[136:139], v[40:43]
    v_mfma_f32_16x16x32_bf16 v[72:75], v[192:195], v[140:143], v[72:75]
    v_mfma_f32_16x16x32_bf16 v[104:107], v[192:195], v[144:147], v[104:107]
    v_mfma_f32_16x16x32_bf16 v[44:47], v[196:199], v[136:139], v[44:47]
    v_mfma_f32_16x16x32_bf16 v[76:79], v[196:199], v[140:143], v[76:79]
    v_mfma_f32_16x16x32_bf16 v[108:111], v[196:199], v[144:147], v[108:111]
    v_mfma_f32_16x16x32_bf16 v[48:51], v[200:203], v[136:139], v[48:51]
    v_mfma_f32_16x16x32_bf16 v[80:83], v[200:203], v[140:143], v[80:83]
    v_mfma_f32_16x16x32_bf16 v[112:115], v[200:203], v[144:147], v[112:115]
    v_mfma_f32_16x16x32_bf16 v[52:55], v[204:207], v[136:139], v[52:55]
    v_mfma_f32_16x16x32_bf16 v[84:87], v[204:207], v[140:143], v[84:87]
    v_mfma_f32_16x16x32_bf16 v[116:119], v[204:207], v[144:147], v[116:119]
    v_mfma_f32_16x16x32_bf16 v[56:59], v[208:211], v[136:139], v[56:59]
    v_mfma_f32_16x16x32_bf16 v[88:91], v[208:211], v[140:143], v[88:91]
    v_mfma_f32_16x16x32_bf16 v[120:123], v[208:211], v[144:147], v[120:123]
    s_waitcnt vmcnt(16)
    s_barrier
    s_add_u32 s45, s50, s82
    s_add_u32 m0, s45, 0
    s_add_u32 s44, s48, 0
    buffer_load_dwordx4 v4, s[12:15], s44 offen nt lds
    s_add_u32 m0, s45, 1024
    s_add_u32 s44, s48, 1024
    buffer_load_dwordx4 v5, s[12:15], s44 offen nt lds
    s_add_u32 m0, s45, 2048
    s_add_u32 s44, s48, 2048
    buffer_load_dwordx4 v6, s[12:15], s44 offen nt lds
    s_add_u32 m0, s45, 3072
    s_add_u32 s44, s48, 3072
    buffer_load_dwordx4 v7, s[12:15], s44 offen nt lds
    s_add_u32 m0, s45, 4096
    s_add_u32 s44, s48, 4096
    buffer_load_dwordx4 v4, s[12:15], s44 offen nt lds
    s_add_u32 m0, s45, 5120
    s_add_u32 s44, s48, 5120
    buffer_load_dwordx4 v5, s[12:15], s44 offen nt lds
    s_add_u32 m0, s45, 6144
    s_add_u32 s44, s48, 6144
    buffer_load_dwordx4 v6, s[12:15], s44 offen nt lds
    s_add_u32 m0, s45, 7168
    s_add_u32 s44, s48, 7168
    buffer_load_dwordx4 v7, s[12:15], s44 offen nt lds
    s_add_u32 s48, s48, 8192
    s_and_b32 s48, s48, 0x3ffff
    s_add_u32 s82, s82, 16384
    s_cmp_eq_u32 s82, 163840
    s_cselect_b32 s82, 81920, s82
    ds_read_b128 v[124:127], v212 offset:0
    ds_read_b128 v[128:131], v212 offset:2048
    ds_read_b128 v[132:135], v212 offset:4096
    ds_read_b64_tr_b16 v[148:149], v214 offset:0
    ds_read_b64_tr_b16 v[150:151], v214 offset:1024
    ds_read_b64_tr_b16 v[152:153], v215 offset:0
    ds_read_b64_tr_b16 v[154:155], v215 offset:1024
    ds_read_b64_tr_b16 v[156:157], v216 offset:0
    ds_read_b64_tr_b16 v[158:159], v216 offset:1024
    ds_read_b64_tr_b16 v[160:161], v217 offset:0
    ds_read_b64_tr_b16 v[162:163], v217 offset:1024
    ds_read_b64_tr_b16 v[164:165], v218 offset:0
    ds_read_b64_tr_b16 v[166:167], v218 offset:1024
    ds_read_b64_tr_b16 v[168:169], v219 offset:0
    ds_read_b64_tr_b16 v[170:171], v219 offset:1024
    ds_read_b64_tr_b16 v[172:173], v220 offset:0
    ds_read_b64_tr_b16 v[174:175], v220 offset:1024
    ds_read_b64_tr_b16 v[176:177], v221 offset:0
    ds_read_b64_tr_b16 v[178:179], v221 offset:1024
    ds_read_b128 v[136:139], v213 offset:0
    ds_read_b128 v[140:143], v213 offset:2048
    ds_read_b128 v[144:147], v213 offset:4096
    ds_read_b64_tr_b16 v[180:181], v214 offset:8192
    ds_read_b64_tr_b16 v[182:183], v214 offset:9216
    ds_read_b64_tr_b16 v[184:185], v215 offset:8192
    ds_read_b64_tr_b16 v[186:187], v215 offset:9216
    ds_read_b64_tr_b16 v[188:189], v216 offset:8192
    ds_read_b64_tr_b16 v[190:191], v216 offset:9216
    ds_read_b64_tr_b16 v[192:193], v217 offset:8192
    ds_read_b64_tr_b16 v[194:195], v217 offset:9216
    ds_read_b64_tr_b16 v[196:197], v218 offset:8192
    ds_read_b64_tr_b16 v[198:199], v218 offset:9216
    ds_read_b64_tr_b16 v[200:201], v219 offset:8192
    ds_read_b64_tr_b16 v[202:203], v219 offset:9216
    ds_read_b64_tr_b16 v[204:205], v220 offset:8192
    ds_read_b64_tr_b16 v[206:207], v220 offset:9216
    ds_read_b64_tr_b16 v[208:209], v221 offset:8192
    ds_read_b64_tr_b16 v[210:211], v221 offset:9216
    s_waitcnt lgkmcnt(15)
    v_mfma_f32_16x16x32_bf16 v[28:31], v[148:151], v[124:127], v[28:31]
    v_mfma_f32_16x16x32_bf16 v[60:63], v[148:151], v[128:131], v[60:63]
    v_mfma_f32_16x16x32_bf16 v[92:95], v[148:151], v[132:135], v[92:95]
    v_mfma_f32_16x16x32_bf16 v[32:35], v[152:155], v[124:127], v[32:35]
    v_mfma_f32_16x16x32_bf16 v[64:67], v[152:155], v[128:131], v[64:67]
    v_mfma_f32_16x16x32_bf16 v[96:99], v[152:155], v[132:135], v[96:99]
    v_mfma_f32_16x16x32_bf16 v[36:39], v[156:159], v[124:127], v[36:39]
    v_mfma_f32_16x16x32_bf16 v[68:71], v[156:159], v[128:131], v[68:71]
    v_mfma_f32_16x16x32_bf16 v[100:103], v[156:159], v[132:135], v[100:103]
    v_mfma_f32_16x16x32_bf16 v[40:43], v[160:163], v[124:127], v[40:43]
    v_mfma_f32_16x16x32_bf16 v[72:75], v[160:163], v[128:131], v[72:75]
    v_mfma_f32_16x16x32_bf16 v[104:107], v[160:163], v[132:135], v[104:107]
    v_mfma_f32_16x16x32_bf16 v[44:47], v[164:167], v[124:127], v[44:47]
    v_mfma_f32_16x16x32_bf16 v[76:79], v[164:167], v[128:131], v[76:79]
    v_mfma_f32_16x16x32_bf16 v[108:111], v[164:167], v[132:135], v[108:111]
    v_mfma_f32_16x16x32_bf16 v[48:51], v[168:171], v[124:127], v[48:51]
    v_mfma_f32_16x16x32_bf16 v[80:83], v[168:171], v[128:131], v[80:83]
    v_mfma_f32_16x16x32_bf16 v[112:115], v[168:171], v[132:135], v[112:115]
    v_mfma_f32_16x16x32_bf16 v[52:55], v[172:175], v[124:127], v[52:55]
    v_mfma_f32_16x16x32_bf16 v[84:87], v[172:175], v[128:131], v[84:87]
    v_mfma_f32_16x16x32_bf16 v[116:119], v[172:175], v[132:135], v[116:119]
    v_mfma_f32_16x16x32_bf16 v[56:59], v[176:179], v[124:127], v[56:59]
    v_mfma_f32_16x16x32_bf16 v[88:91], v[176:179], v[128:131], v[88:91]
    v_mfma_f32_16x16x32_bf16 v[120:123], v[176:179], v[132:135], v[120:123]
    s_waitcnt lgkmcnt(0)
    s_waitcnt vmcnt(16)
    s_barrier
    s_add_u32 s45, s50, s82
    s_add_u32 m0, s45, 0
    s_add_u32 s44, s48, 0
    buffer_load_dwordx4 v4, s[12:15], s44 offen nt lds
    s_add_u32 m0, s45, 1024
    s_add_u32 s44, s48, 1024
    buffer_load_dwordx4 v5, s[12:15], s44 offen nt lds
    s_add_u32 m0, s45, 2048
    s_add_u32 s44, s48, 2048
    buffer_load_dwordx4 v6, s[12:15], s44 offen nt lds
    s_add_u32 m0, s45, 3072
    s_add_u32 s44, s48, 3072
    buffer_load_dwordx4 v7, s[12:15], s44 offen nt lds
    s_add_u32 m0, s45, 4096
    s_add_u32 s44, s48, 4096
    buffer_load_dwordx4 v4, s[12:15], s44 offen nt lds
    s_add_u32 m0, s45, 5120
    s_add_u32 s44, s48, 5120
    buffer_load_dwordx4 v5, s[12:15], s44 offen nt lds
    s_add_u32 m0, s45, 6144
    s_add_u32 s44, s48, 6144
    buffer_load_dwordx4 v6, s[12:15], s44 offen nt lds
    s_add_u32 m0, s45, 7168
    s_add_u32 s44, s48, 7168
    buffer_load_dwordx4 v7, s[12:15], s44 offen nt lds
    s_add_u32 s48, s48, 8192
    s_and_b32 s48, s48, 0x3ffff
    s_add_u32 s82, s82, 16384
    s_cmp_eq_u32 s82, 163840
    s_cselect_b32 s82, 81920, s82
    v_mfma_f32_16x16x32_bf16 v[28:31], v[180:183], v[136:139], v[28:31]
    v_mfma_f32_16x16x32_bf16 v[60:63], v[180:183], v[140:143], v[60:63]
    v_mfma_f32_16x16x32_bf16 v[92:95], v[180:183], v[144:147], v[92:95]
    v_mfma_f32_16x16x32_bf16 v[32:35], v[184:187], v[136:139], v[32:35]
    v_mfma_f32_16x16x32_bf16 v[64:67], v[184:187], v[140:143], v[64:67]
    v_mfma_f32_16x16x32_bf16 v[96:99], v[184:187], v[144:147], v[96:99]
    v_mfma_f32_16x16x32_bf16 v[36:39], v[188:191], v[136:139], v[36:39]
    v_mfma_f32_16x16x32_bf16 v[68:71], v[188:191], v[140:143], v[68:71]
    v_mfma_f32_16x16x32_bf16 v[100:103], v[188:191], v[144:147], v[100:103]
    v_mfma_f32_16x16x32_bf16 v[40:43], v[192:195], v[136:139], v[40:43]
    v_mfma_f32_16x16x32_bf16 v[72:75], v[192:195], v[140:143], v[72:75]
    v_mfma_f32_16x16x32_bf16 v[104:107], v[192:195], v[144:147], v[104:107]
    v_mfma_f32_16x16x32_bf16 v[44:47], v[196:199], v[136:139], v[44:47]
    v_mfma_f32_16x16x32_bf16 v[76:79], v[196:199], v[140:143], v[76:79]
    v_mfma_f32_16x16x32_bf16 v[108:111], v[196:199], v[144:147], v[108:111]
    v_mfma_f32_16x16x32_bf16 v[48:51], v[200:203], v[136:139], v[48:51]
    v_mfma_f32_16x16x32_bf16 v[80:83], v[200:203], v[140:143], v[80:83]
    v_mfma_f32_16x16x32_bf16 v[112:115], v[200:203], v[144:147], v[112:115]
    v_mfma_f32_16x16x32_bf16 v[52:55], v[204:207], v[136:139], v[52:55]
    v_mfma_f32_16x16x32_bf16 v[84:87], v[204:207], v[140:143], v[84:87]
    v_mfma_f32_16x16x32_bf16 v[116:119], v[204:207], v[144:147], v[116:119]
    v_mfma_f32_16x16x32_bf16 v[56:59], v[208:211], v[136:139], v[56:59]
    v_mfma_f32_16x16x32_bf16 v[88:91], v[208:211], v[140:143], v[88:91]
    v_mfma_f32_16x16x32_bf16 v[120:123], v[208:211], v[144:147], v[120:123]
    s_waitcnt vmcnt(16)
    s_barrier
    s_add_u32 s45, s50, s82
    s_add_u32 m0, s45, 0
    s_add_u32 s44, s48, 0
    buffer_load_dwordx4 v4, s[12:15], s44 offen nt lds
    s_add_u32 m0, s45, 1024
    s_add_u32 s44, s48, 1024
    buffer_load_dwordx4 v5, s[12:15], s44 offen nt lds
    s_add_u32 m0, s45, 2048
    s_add_u32 s44, s48, 2048
    buffer_load_dwordx4 v6, s[12:15], s44 offen nt lds
    s_add_u32 m0, s45, 3072
    s_add_u32 s44, s48, 3072
    buffer_load_dwordx4 v7, s[12:15], s44 offen nt lds
    s_add_u32 m0, s45, 4096
    s_add_u32 s44, s48, 4096
    buffer_load_dwordx4 v4, s[12:15], s44 offen nt lds
    s_add_u32 m0, s45, 5120
    s_add_u32 s44, s48, 5120
    buffer_load_dwordx4 v5, s[12:15], s44 offen nt lds
    s_add_u32 m0, s45, 6144
    s_add_u32 s44, s48, 6144
    buffer_load_dwordx4 v6, s[12:15], s44 offen nt lds
    s_add_u32 m0, s45, 7168
    s_add_u32 s44, s48, 7168
    buffer_load_dwordx4 v7, s[12:15], s44 offen nt lds
    s_add_u32 s48, s48, 8192
    s_and_b32 s48, s48, 0x3ffff
    s_add_u32 s82, s82, 16384
    s_cmp_eq_u32 s82, 163840
    s_cselect_b32 s82, 81920, s82
    s_nop 7
    v_lshrrev_b32 v14, 4, v1
    v_and_b32 v15, 15, v1
    v_lshrrev_b32 v16, 1, v14
    v_xor_b32 v16, v16, v15
    v_lshlrev_b32 v16, 4, v16
    v_lshl_add_u32 v16, v15, 8, v16
    v_and_b32 v17, 1, v14
    v_lshl_add_u32 v16, v17, 3, v16
    s_mul_i32 s44, s53, 12288
    s_add_u32 s44, s44, 0
    v_add_u32 v16, s44, v16
    v_xor_b32 v17, 0, v16
    v_pk_mul_f32 v[28:29], v[28:29], s[92:93]
    v_pk_mul_f32 v[30:31], v[30:31], s[92:93]
    v_cvt_pk_bf16_f32 v28, v28, v29
    v_cvt_pk_bf16_f32 v29, v30, v31
    ds_write_b64 v17, v[28:29] offset:0
    v_pk_mul_f32 v[60:61], v[60:61], s[92:93]
    v_pk_mul_f32 v[62:63], v[62:63], s[92:93]
    v_cvt_pk_bf16_f32 v60, v60, v61
    v_cvt_pk_bf16_f32 v61, v62, v63
    ds_write_b64 v17, v[60:61] offset:4096
    v_pk_mul_f32 v[92:93], v[92:93], s[92:93]
    v_pk_mul_f32 v[94:95], v[94:95], s[92:93]
    v_cvt_pk_bf16_f32 v92, v92, v93
    v_cvt_pk_bf16_f32 v93, v94, v95
    ds_write_b64 v17, v[92:93] offset:8192
    v_xor_b32 v17, 32, v16
    v_pk_mul_f32 v[32:33], v[32:33], s[92:93]
    v_pk_mul_f32 v[34:35], v[34:35], s[92:93]
    v_cvt_pk_bf16_f32 v32, v32, v33
    v_cvt_pk_bf16_f32 v33, v34, v35
    ds_write_b64 v17, v[32:33] offset:0
    v_pk_mul_f32 v[64:65], v[64:65], s[92:93]
    v_pk_mul_f32 v[66:67], v[66:67], s[92:93]
    v_cvt_pk_bf16_f32 v64, v64, v65
    v_cvt_pk_bf16_f32 v65, v66, v67
    ds_write_b64 v17, v[64:65] offset:4096
    v_pk_mul_f32 v[96:97], v[96:97], s[92:93]
    v_pk_mul_f32 v[98:99], v[98:99], s[92:93]
    v_cvt_pk_bf16_f32 v96, v96, v97
    v_cvt_pk_bf16_f32 v97, v98, v99
    ds_write_b64 v17, v[96:97] offset:8192
    v_xor_b32 v17, 64, v16
    v_pk_mul_f32 v[36:37], v[36:37], s[92:93]
    v_pk_mul_f32 v[38:39], v[38:39], s[92:93]
    v_cvt_pk_bf16_f32 v36, v36, v37
    v_cvt_pk_bf16_f32 v37, v38, v39
    ds_write_b64 v17, v[36:37] offset:0
    v_pk_mul_f32 v[68:69], v[68:69], s[92:93]
    v_pk_mul_f32 v[70:71], v[70:71], s[92:93]
    v_cvt_pk_bf16_f32 v68, v68, v69
    v_cvt_pk_bf16_f32 v69, v70, v71
    ds_write_b64 v17, v[68:69] offset:4096
    v_pk_mul_f32 v[100:101], v[100:101], s[92:93]
    v_pk_mul_f32 v[102:103], v[102:103], s[92:93]
    v_cvt_pk_bf16_f32 v100, v100, v101
    v_cvt_pk_bf16_f32 v101, v102, v103
    ds_write_b64 v17, v[100:101] offset:8192
    v_xor_b32 v17, 96, v16
    v_pk_mul_f32 v[40:41], v[40:41], s[92:93]
    v_pk_mul_f32 v[42:43], v[42:43], s[92:93]
    v_cvt_pk_bf16_f32 v40, v40, v41
    v_cvt_pk_bf16_f32 v41, v42, v43
    ds_write_b64 v17, v[40:41] offset:0
    v_pk_mul_f32 v[72:73], v[72:73], s[92:93]
    v_pk_mul_f32 v[74:75], v[74:75], s[92:93]
    v_cvt_pk_bf16_f32 v72, v72, v73
    v_cvt_pk_bf16_f32 v73, v74, v75
    ds_write_b64 v17, v[72:73] offset:4096
    v_pk_mul_f32 v[104:105], v[104:105], s[92:93]
    v_pk_mul_f32 v[106:107], v[106:107], s[92:93]
    v_cvt_pk_bf16_f32 v104, v104, v105
    v_cvt_pk_bf16_f32 v105, v106, v107
    ds_write_b64 v17, v[104:105] offset:8192
    v_xor_b32 v17, 128, v16
    v_pk_mul_f32 v[44:45], v[44:45], s[92:93]
    v_pk_mul_f32 v[46:47], v[46:47], s[92:93]
    v_cvt_pk_bf16_f32 v44, v44, v45
    v_cvt_pk_bf16_f32 v45, v46, v47
    ds_write_b64 v17, v[44:45] offset:0
    v_pk_mul_f32 v[76:77], v[76:77], s[92:93]
    v_pk_mul_f32 v[78:79], v[78:79], s[92:93]
    v_cvt_pk_bf16_f32 v76, v76, v77
    v_cvt_pk_bf16_f32 v77, v78, v79
    ds_write_b64 v17, v[76:77] offset:4096
    v_pk_mul_f32 v[108:109], v[108:109], s[92:93]
    v_pk_mul_f32 v[110:111], v[110:111], s[92:93]
    v_cvt_pk_bf16_f32 v108, v108, v109
    v_cvt_pk_bf16_f32 v109, v110, v111
    ds_write_b64 v17, v[108:109] offset:8192
    v_xor_b32 v17, 160, v16
    v_pk_mul_f32 v[48:49], v[48:49], s[92:93]
    v_pk_mul_f32 v[50:51], v[50:51], s[92:93]
    v_cvt_pk_bf16_f32 v48, v48, v49
    v_cvt_pk_bf16_f32 v49, v50, v51
    ds_write_b64 v17, v[48:49] offset:0
    v_pk_mul_f32 v[80:81], v[80:81], s[92:93]
    v_pk_mul_f32 v[82:83], v[82:83], s[92:93]
    v_cvt_pk_bf16_f32 v80, v80, v81
    v_cvt_pk_bf16_f32 v81, v82, v83
    ds_write_b64 v17, v[80:81] offset:4096
    v_pk_mul_f32 v[112:113], v[112:113], s[92:93]
    v_pk_mul_f32 v[114:115], v[114:115], s[92:93]
    v_cvt_pk_bf16_f32 v112, v112, v113
    v_cvt_pk_bf16_f32 v113, v114, v115
    ds_write_b64 v17, v[112:113] offset:8192
    v_xor_b32 v17, 192, v16
    v_pk_mul_f32 v[52:53], v[52:53], s[92:93]
    v_pk_mul_f32 v[54:55], v[54:55], s[92:93]
    v_cvt_pk_bf16_f32 v52, v52, v53
    v_cvt_pk_bf16_f32 v53, v54, v55
    ds_write_b64 v17, v[52:53] offset:0
    v_pk_mul_f32 v[84:85], v[84:85], s[92:93]
    v_pk_mul_f32 v[86:87], v[86:87], s[92:93]
    v_cvt_pk_bf16_f32 v84, v84, v85
    v_cvt_pk_bf16_f32 v85, v86, v87
    ds_write_b64 v17, v[84:85] offset:4096
    v_pk_mul_f32 v[116:117], v[116:117], s[92:93]
    v_pk_mul_f32 v[118:119], v[118:119], s[92:93]
    v_cvt_pk_bf16_f32 v116, v116, v117
    v_cvt_pk_bf16_f32 v117, v118, v119
    ds_write_b64 v17, v[116:117] offset:8192
    v_xor_b32 v17, 224, v16
    v_pk_mul_f32 v[56:57], v[56:57], s[92:93]
    v_pk_mul_f32 v[58:59], v[58:59], s[92:93]
    v_cvt_pk_bf16_f32 v56, v56, v57
    v_cvt_pk_bf16_f32 v57, v58, v59
    ds_write_b64 v17, v[56:57] offset:0
    v_pk_mul_f32 v[88:89], v[88:89], s[92:93]
    v_pk_mul_f32 v[90:91], v[90:91], s[92:93]
    v_cvt_pk_bf16_f32 v88, v88, v89
    v_cvt_pk_bf16_f32 v89, v90, v91
    ds_write_b64 v17, v[88:89] offset:4096
    v_pk_mul_f32 v[120:121], v[120:121], s[92:93]
    v_pk_mul_f32 v[122:123], v[122:123], s[92:93]
    v_cvt_pk_bf16_f32 v120, v120, v121
    v_cvt_pk_bf16_f32 v121, v122, v123
    ds_write_b64 v17, v[120:121] offset:8192
    s_waitcnt lgkmcnt(0)
    s_barrier
    s_mov_b32 s49, 0
L_h2loop_3:
    s_waitcnt vmcnt(16)
    s_barrier
    s_add_u32 s45, s50, s82
    s_add_u32 m0, s45, 0
    s_add_u32 s44, s48, 0
    buffer_load_dwordx4 v4, s[12:15], s44 offen nt lds
    s_add_u32 m0, s45, 1024
    s_add_u32 s44, s48, 1024
    buffer_load_dwordx4 v5, s[12:15], s44 offen nt lds
    s_add_u32 m0, s45, 2048
    s_add_u32 s44, s48, 2048
    buffer_load_dwordx4 v6, s[12:15], s44 offen nt lds
    s_add_u32 m0, s45, 3072
    s_add_u32 s44, s48, 3072
    buffer_load_dwordx4 v7, s[12:15], s44 offen nt lds
    s_add_u32 m0, s45, 4096
    s_add_u32 s44, s48, 4096
    buffer_load_dwordx4 v4, s[12:15], s44 offen nt lds
    s_add_u32 m0, s45, 5120
    s_add_u32 s44, s48, 5120
    buffer_load_dwordx4 v5, s[12:15], s44 offen nt lds
    s_add_u32 m0, s45, 6144
    s_add_u32 s44, s48, 6144
    buffer_load_dwordx4 v6, s[12:15], s44 offen nt lds
    s_add_u32 m0, s45, 7168
    s_add_u32 s44, s48, 7168
    buffer_load_dwordx4 v7, s[12:15], s44 offen nt lds
    s_add_u32 s48, s48, 8192
    s_and_b32 s48, s48, 0x3ffff
    s_add_u32 s82, s82, 16384
    s_cmp_eq_u32 s82, 163840
    s_cselect_b32 s82, 81920, s82
    s_add_u32 s49, s49, 1
    s_cmp_lt_u32 s49, 27
    s_cbranch_scc1 L_h2loop_3
    s_waitcnt vmcnt(16)
    s_barrier
    s_mov_b32 s30, s53
    s_and_b32 s44, s2, 7
    s_lshr_b32 s45, s2, 3
    s_lshr_b32 s24, s44, 2
    s_lshr_b32 s27, s44, 1
    s_and_b32 s27, s27, 1
    s_and_b32 s51, s44, 1
    s_lshl_b32 s51, s51, 2
    s_and_b32 s25, s45, 3
    s_add_u32 s25, s25, s51
    s_lshr_b32 s26, s45, 2
    s_mov_b32 s31, 0
    s_mov_b32 s32, s96
    s_mov_b32 s33, s97
    s_lshl_b32 s44, s26, 8
    s_lshl_b32 s45, s27, 22
    s_add_u32 s44, s44, s45
    s_add_u32 s8, s32, s44
    s_addc_u32 s9, s33, 0
    s_mov_b32 s10, 4192512
    s_mov_b32 s11, 0x20000
    v_lshrrev_b32 v14, 4, v1
    v_and_b32 v15, 15, v1
    v_lshlrev_b32 v16, 1, v14
    v_xor_b32 v16, v16, v15
    v_lshlrev_b32 v16, 4, v16
    v_mul_u32_u24 v17, 2048, v14
    v_add_u32 v2, v16, v17
    v_xor_b32 v3, 128, v2
    s_mul_i32 s46, s30, 65536
    s_lshl_b32 s47, s30, 13
    s_mov_b32 s43, 0
    s_waitcnt vmcnt(8)
    s_barrier
    s_mov_b32 s43, 0
    s_mul_i32 s42, s43, 131072
    s_add_u32 s42, s42, s46
    s_add_u32 m0, s47, 18432
    s_add_u32 s44, s42, 0
    buffer_load_dwordx4 v2, s[8:11], s44 offen lds
    s_add_u32 m0, s47, 19456
    s_add_u32 s44, s42, 8192
    buffer_load_dwordx4 v2, s[8:11], s44 offen lds
    s_add_u32 m0, s47, 20480
    s_add_u32 s44, s42, 16384
    buffer_load_dwordx4 v3, s[8:11], s44 offen lds
    s_add_u32 m0, s47, 21504
    s_add_u32 s44, s42, 24576
    buffer_load_dwordx4 v3, s[8:11], s44 offen lds
    s_add_u32 m0, s47, 22528
    s_add_u32 s44, s42, 32768
    buffer_load_dwordx4 v2, s[8:11], s44 offen lds
    s_add_u32 m0, s47, 23552
    s_add_u32 s44, s42, 40960
    buffer_load_dwordx4 v2, s[8:11], s44 offen lds
    s_add_u32 m0, s47, 24576
    s_add_u32 s44, s42, 49152
    buffer_load_dwordx4 v3, s[8:11], s44 offen lds
    s_add_u32 m0, s47, 25600
    s_add_u32 s44, s42, 57344
    buffer_load_dwordx4 v3, s[8:11], s44 offen lds
    s_add_u32 s43, s43, 1
    s_and_b32 s43, s43, 31
    s_waitcnt vmcnt(8)
    s_barrier
    s_mov_b32 s43, 1
    s_mul_i32 s42, s43, 131072
    s_add_u32 s42, s42, s46
    s_add_u32 m0, s47, 53248
    s_add_u32 s44, s42, 0
    buffer_load_dwordx4 v2, s[8:11], s44 offen lds
    s_add_u32 m0, s47, 54272
    s_add_u32 s44, s42, 8192
    buffer_load_dwordx4 v2, s[8:11], s44 offen lds
    s_add_u32 m0, s47, 55296
    s_add_u32 s44, s42, 16384
    buffer_load_dwordx4 v3, s[8:11], s44 offen lds
    s_add_u32 m0, s47, 56320
    s_add_u32 s44, s42, 24576
    buffer_load_dwordx4 v3, s[8:11], s44 offen lds
    s_add_u32 m0, s47, 57344
    s_add_u32 s44, s42, 32768
    buffer_load_dwordx4 v2, s[8:11], s44 offen lds
    s_add_u32 m0, s47, 58368
    s_add_u32 s44, s42, 40960
    buffer_load_dwordx4 v2, s[8:11], s44 offen lds
    s_add_u32 m0, s47, 59392
    s_add_u32 s44, s42, 49152
    buffer_load_dwordx4 v3, s[8:11], s44 offen lds
    s_add_u32 m0, s47, 60416
    s_add_u32 s44, s42, 57344
    buffer_load_dwordx4 v3, s[8:11], s44 offen lds
    s_add_u32 s43, s43, 1
    s_and_b32 s43, s43, 31
    s_barrier
    s_barrier
    s_waitcnt vmcnt(8)
    s_barrier
    s_mov_b32 s43, 2
    s_mul_i32 s42, s43, 131072
    s_add_u32 s42, s42, s46
    s_add_u32 m0, s47, 88064
    s_add_u32 s44, s42, 0
    buffer_load_dwordx4 v2, s[8:11], s44 offen lds
    s_add_u32 m0, s47, 89088
    s_add_u32 s44, s42, 8192
    buffer_load_dwordx4 v2, s[8:11], s44 offen lds
    s_add_u32 m0, s47, 90112
    s_add_u32 s44, s42, 16384
    buffer_load_dwordx4 v3, s[8:11], s44 offen lds
    s_add_u32 m0, s47, 91136
    s_add_u32 s44, s42, 24576
    buffer_load_dwordx4 v3, s[8:11], s44 offen lds
    s_add_u32 m0, s47, 92160
    s_add_u32 s44, s42, 32768
    buffer_load_dwordx4 v2, s[8:11], s44 offen lds
    s_add_u32 m0, s47, 93184
    s_add_u32 s44, s42, 40960
    buffer_load_dwordx4 v2, s[8:11], s44 offen lds
    s_add_u32 m0, s47, 94208
    s_add_u32 s44, s42, 49152
    buffer_load_dwordx4 v3, s[8:11], s44 offen lds
    s_add_u32 m0, s47, 95232
    s_add_u32 s44, s42, 57344
    buffer_load_dwordx4 v3, s[8:11], s44 offen lds
    s_add_u32 s43, s43, 1
    s_and_b32 s43, s43, 31
    s_mov_b32 s43, 3
    s_mul_i32 s42, s43, 131072
    s_add_u32 s42, s42, s46
    s_add_u32 m0, s47, 122880
    s_add_u32 s44, s42, 0
    buffer_load_dwordx4 v2, s[8:11], s44 offen lds
    s_add_u32 m0, s47, 123904
    s_add_u32 s44, s42, 8192
    buffer_load_dwordx4 v2, s[8:11], s44 offen lds
    s_add_u32 m0, s47, 124928
    s_add_u32 s44, s42, 16384
    buffer_load_dwordx4 v3, s[8:11], s44 offen lds
    s_add_u32 m0, s47, 125952
    s_add_u32 s44, s42, 24576
    buffer_load_dwordx4 v3, s[8:11], s44 offen lds
    s_add_u32 m0, s47, 126976
    s_add_u32 s44, s42, 32768
    buffer_load_dwordx4 v2, s[8:11], s44 offen lds
    s_add_u32 m0, s47, 128000
    s_add_u32 s44, s42, 40960
    buffer_load_dwordx4 v2, s[8:11], s44 offen lds
    s_add_u32 m0, s47, 129024
    s_add_u32 s44, s42, 49152
    buffer_load_dwordx4 v3, s[8:11], s44 offen lds
    s_add_u32 m0, s47, 130048
    s_add_u32 s44, s42, 57344
    buffer_load_dwordx4 v3, s[8:11], s44 offen lds
    s_add_u32 s43, s43, 1
    s_and_b32 s43, s43, 31
    s_waitcnt vmcnt(16)
    s_barrier
    s_mov_b32 s43, 4
    s_mul_i32 s42, s43, 131072
    s_add_u32 s42, s42, s46
    s_add_u32 m0, s47, 18432
    s_add_u32 s44, s42, 0
    buffer_load_dwordx4 v2, s[8:11], s44 offen lds
    s_add_u32 m0, s47, 19456
    s_add_u32 s44, s42, 8192
    buffer_load_dwordx4 v2, s[8:11], s44 offen lds
    s_add_u32 m0, s47, 20480
    s_add_u32 s44, s42, 16384
    buffer_load_dwordx4 v3, s[8:11], s44 offen lds
    s_add_u32 m0, s47, 21504
    s_add_u32 s44, s42, 24576
    buffer_load_dwordx4 v3, s[8:11], s44 offen lds
    s_add_u32 m0, s47, 22528
    s_add_u32 s44, s42, 32768
    buffer_load_dwordx4 v2, s[8:11], s44 offen lds
    s_add_u32 m0, s47, 23552
    s_add_u32 s44, s42, 40960
    buffer_load_dwordx4 v2, s[8:11], s44 offen lds
    s_add_u32 m0, s47, 24576
    s_add_u32 s44, s42, 49152
    buffer_load_dwordx4 v3, s[8:11], s44 offen lds
    s_add_u32 m0, s47, 25600
    s_add_u32 s44, s42, 57344
    buffer_load_dwordx4 v3, s[8:11], s44 offen lds
    s_add_u32 s43, s43, 1
    s_and_b32 s43, s43, 31
    s_waitcnt vmcnt(16)
    s_barrier
    s_mov_b32 s43, 5
    s_mul_i32 s42, s43, 131072
    s_add_u32 s42, s42, s46
    s_add_u32 m0, s47, 53248
    s_add_u32 s44, s42, 0
    buffer_load_dwordx4 v2, s[8:11], s44 offen lds
    s_add_u32 m0, s47, 54272
    s_add_u32 s44, s42, 8192
    buffer_load_dwordx4 v2, s[8:11], s44 offen lds
    s_add_u32 m0, s47, 55296
    s_add_u32 s44, s42, 16384
    buffer_load_dwordx4 v3, s[8:11], s44 offen lds
    s_add_u32 m0, s47, 56320
    s_add_u32 s44, s42, 24576
    buffer_load_dwordx4 v3, s[8:11], s44 offen lds
    s_add_u32 m0, s47, 57344
    s_add_u32 s44, s42, 32768
    buffer_load_dwordx4 v2, s[8:11], s44 offen lds
    s_add_u32 m0, s47, 58368
    s_add_u32 s44, s42, 40960
    buffer_load_dwordx4 v2, s[8:11], s44 offen lds
    s_add_u32 m0, s47, 59392
    s_add_u32 s44, s42, 49152
    buffer_load_dwordx4 v3, s[8:11], s44 offen lds
    s_add_u32 m0, s47, 60416
    s_add_u32 s44, s42, 57344
    buffer_load_dwordx4 v3, s[8:11], s44 offen lds
    s_add_u32 s43, s43, 1
    s_and_b32 s43, s43, 31
    s_waitcnt vmcnt(16)
    s_barrier
    s_mov_b32 s43, 6
    s_mul_i32 s42, s43, 131072
    s_add_u32 s42, s42, s46
    s_add_u32 m0, s47, 88064
    s_add_u32 s44, s42, 0
    buffer_load_dwordx4 v2, s[8:11], s44 offen lds
    s_add_u32 m0, s47, 89088
    s_add_u32 s44, s42, 8192
    buffer_load_dwordx4 v2, s[8:11], s44 offen lds
    s_add_u32 m0, s47, 90112
    s_add_u32 s44, s42, 16384
    buffer_load_dwordx4 v3, s[8:11], s44 offen lds
    s_add_u32 m0, s47, 91136
    s_add_u32 s44, s42, 24576
    buffer_load_dwordx4 v3, s[8:11], s44 offen lds
    s_add_u32 m0, s47, 92160
    s_add_u32 s44, s42, 32768
    buffer_load_dwordx4 v2, s[8:11], s44 offen lds
    s_add_u32 m0, s47, 93184
    s_add_u32 s44, s42, 40960
    buffer_load_dwordx4 v2, s[8:11], s44 offen lds
    s_add_u32 m0, s47, 94208
    s_add_u32 s44, s42, 49152
    buffer_load_dwordx4 v3, s[8:11], s44 offen lds
    s_add_u32 m0, s47, 95232
    s_add_u32 s44, s42, 57344
    buffer_load_dwordx4 v3, s[8:11], s44 offen lds
    s_add_u32 s43, s43, 1
    s_and_b32 s43, s43, 31
    s_waitcnt vmcnt(16)
    s_barrier
    s_mov_b32 s43, 7
    s_mul_i32 s42, s43, 131072
    s_add_u32 s42, s42, s46
    s_add_u32 m0, s47, 122880
    s_add_u32 s44, s42, 0
    buffer_load_dwordx4 v2, s[8:11], s44 offen lds
    s_add_u32 m0, s47, 123904
    s_add_u32 s44, s42, 8192
    buffer_load_dwordx4 v2, s[8:11], s44 offen lds
    s_add_u32 m0, s47, 124928
    s_add_u32 s44, s42, 16384
    buffer_load_dwordx4 v3, s[8:11], s44 offen lds
    s_add_u32 m0, s47, 125952
    s_add_u32 s44, s42, 24576
    buffer_load_dwordx4 v3, s[8:11], s44 offen lds
    s_add_u32 m0, s47, 126976
    s_add_u32 s44, s42, 32768
    buffer_load_dwordx4 v2, s[8:11], s44 offen lds
    s_add_u32 m0, s47, 128000
    s_add_u32 s44, s42, 40960
    buffer_load_dwordx4 v2, s[8:11], s44 offen lds
    s_add_u32 m0, s47, 129024
    s_add_u32 s44, s42, 49152
    buffer_load_dwordx4 v3, s[8:11], s44 offen lds
    s_add_u32 m0, s47, 130048
    s_add_u32 s44, s42, 57344
    buffer_load_dwordx4 v3, s[8:11], s44 offen lds
    s_add_u32 s43, s43, 1
    s_and_b32 s43, s43, 31
    s_waitcnt vmcnt(16)
    s_barrier
    s_mov_b32 s43, 16
    s_mul_i32 s42, s43, 131072
    s_add_u32 s42, s42, s46
    s_add_u32 m0, s47, 18432
    s_add_u32 s44, s42, 0
    buffer_load_dwordx4 v2, s[8:11], s44 offen lds
    s_add_u32 m0, s47, 19456
    s_add_u32 s44, s42, 8192
    buffer_load_dwordx4 v2, s[8:11], s44 offen lds
    s_add_u32 m0, s47, 20480
    s_add_u32 s44, s42, 16384
    buffer_load_dwordx4 v3, s[8:11], s44 offen lds
    s_add_u32 m0, s47, 21504
    s_add_u32 s44, s42, 24576
    buffer_load_dwordx4 v3, s[8:11], s44 offen lds
    s_add_u32 m0, s47, 22528
    s_add_u32 s44, s42, 32768
    buffer_load_dwordx4 v2, s[8:11], s44 offen lds
    s_add_u32 m0, s47, 23552
    s_add_u32 s44, s42, 40960
    buffer_load_dwordx4 v2, s[8:11], s44 offen lds
    s_add_u32 m0, s47, 24576
    s_add_u32 s44, s42, 49152
    buffer_load_dwordx4 v3, s[8:11], s44 offen lds
    s_add_u32 m0, s47, 25600
    s_add_u32 s44, s42, 57344
    buffer_load_dwordx4 v3, s[8:11], s44 offen lds
    s_add_u32 s43, s43, 1
    s_and_b32 s43, s43, 31
    s_waitcnt vmcnt(16)
    s_barrier
    s_mov_b32 s43, 17
    s_mul_i32 s42, s43, 131072
    s_add_u32 s42, s42, s46
    s_add_u32 m0, s47, 53248
    s_add_u32 s44, s42, 0
    buffer_load_dwordx4 v2, s[8:11], s44 offen lds
    s_add_u32 m0, s47, 54272
    s_add_u32 s44, s42, 8192
    buffer_load_dwordx4 v2, s[8:11], s44 offen lds
    s_add_u32 m0, s47, 55296
    s_add_u32 s44, s42, 16384
    buffer_load_dwordx4 v3, s[8:11], s44 offen lds
    s_add_u32 m0, s47, 56320
    s_add_u32 s44, s42, 24576
    buffer_load_dwordx4 v3, s[8:11], s44 offen lds
    s_add_u32 m0, s47, 57344
    s_add_u32 s44, s42, 32768
    buffer_load_dwordx4 v2, s[8:11], s44 offen lds
    s_add_u32 m0, s47, 58368
    s_add_u32 s44, s42, 40960
    buffer_load_dwordx4 v2, s[8:11], s44 offen lds
    s_add_u32 m0, s47, 59392
    s_add_u32 s44, s42, 49152
    buffer_load_dwordx4 v3, s[8:11], s44 offen lds
    s_add_u32 m0, s47, 60416
    s_add_u32 s44, s42, 57344
    buffer_load_dwordx4 v3, s[8:11], s44 offen lds
    s_add_u32 s43, s43, 1
    s_and_b32 s43, s43, 31
    s_waitcnt vmcnt(16)
    s_barrier
    s_mov_b32 s43, 18
    s_mul_i32 s42, s43, 131072
    s_add_u32 s42, s42, s46
    s_add_u32 m0, s47, 88064
    s_add_u32 s44, s42, 0
    buffer_load_dwordx4 v2, s[8:11], s44 offen lds
    s_add_u32 m0, s47, 89088
    s_add_u32 s44, s42, 8192
    buffer_load_dwordx4 v2, s[8:11], s44 offen lds
    s_add_u32 m0, s47, 90112
    s_add_u32 s44, s42, 16384
    buffer_load_dwordx4 v3, s[8:11], s44 offen lds
    s_add_u32 m0, s47, 91136
    s_add_u32 s44, s42, 24576
    buffer_load_dwordx4 v3, s[8:11], s44 offen lds
    s_add_u32 m0, s47, 92160
    s_add_u32 s44, s42, 32768
    buffer_load_dwordx4 v2, s[8:11], s44 offen lds
    s_add_u32 m0, s47, 93184
    s_add_u32 s44, s42, 40960
    buffer_load_dwordx4 v2, s[8:11], s44 offen lds
    s_add_u32 m0, s47, 94208
    s_add_u32 s44, s42, 49152
    buffer_load_dwordx4 v3, s[8:11], s44 offen lds
    s_add_u32 m0, s47, 95232
    s_add_u32 s44, s42, 57344
    buffer_load_dwordx4 v3, s[8:11], s44 offen lds
    s_add_u32 s43, s43, 1
    s_and_b32 s43, s43, 31
    s_waitcnt vmcnt(16)
    s_barrier
    s_mov_b32 s43, 19
    s_mul_i32 s42, s43, 131072
    s_add_u32 s42, s42, s46
    s_add_u32 m0, s47, 122880
    s_add_u32 s44, s42, 0
    buffer_load_dwordx4 v2, s[8:11], s44 offen lds
    s_add_u32 m0, s47, 123904
    s_add_u32 s44, s42, 8192
    buffer_load_dwordx4 v2, s[8:11], s44 offen lds
    s_add_u32 m0, s47, 124928
    s_add_u32 s44, s42, 16384
    buffer_load_dwordx4 v3, s[8:11], s44 offen lds
    s_add_u32 m0, s47, 125952
    s_add_u32 s44, s42, 24576
    buffer_load_dwordx4 v3, s[8:11], s44 offen lds
    s_add_u32 m0, s47, 126976
    s_add_u32 s44, s42, 32768
    buffer_load_dwordx4 v2, s[8:11], s44 offen lds
    s_add_u32 m0, s47, 128000
    s_add_u32 s44, s42, 40960
    buffer_load_dwordx4 v2, s[8:11], s44 offen lds
    s_add_u32 m0, s47, 129024
    s_add_u32 s44, s42, 49152
    buffer_load_dwordx4 v3, s[8:11], s44 offen lds
    s_add_u32 m0, s47, 130048
    s_add_u32 s44, s42, 57344
    buffer_load_dwordx4 v3, s[8:11], s44 offen lds
    s_add_u32 s43, s43, 1
    s_and_b32 s43, s43, 31
    s_waitcnt vmcnt(16)
    s_barrier
    s_mov_b32 s43, 20
    s_mul_i32 s42, s43, 131072
    s_add_u32 s42, s42, s46
    s_add_u32 m0, s47, 18432
    s_add_u32 s44, s42, 0
    buffer_load_dwordx4 v2, s[8:11], s44 offen lds
    s_add_u32 m0, s47, 19456
    s_add_u32 s44, s42, 8192
    buffer_load_dwordx4 v2, s[8:11], s44 offen lds
    s_add_u32 m0, s47, 20480
    s_add_u32 s44, s42, 16384
    buffer_load_dwordx4 v3, s[8:11], s44 offen lds
    s_add_u32 m0, s47, 21504
    s_add_u32 s44, s42, 24576
    buffer_load_dwordx4 v3, s[8:11], s44 offen lds
    s_add_u32 m0, s47, 22528
    s_add_u32 s44, s42, 32768
    buffer_load_dwordx4 v2, s[8:11], s44 offen lds
    s_add_u32 m0, s47, 23552
    s_add_u32 s44, s42, 40960
    buffer_load_dwordx4 v2, s[8:11], s44 offen lds
    s_add_u32 m0, s47, 24576
    s_add_u32 s44, s42, 49152
    buffer_load_dwordx4 v3, s[8:11], s44 offen lds
    s_add_u32 m0, s47, 25600
    s_add_u32 s44, s42, 57344
    buffer_load_dwordx4 v3, s[8:11], s44 offen lds
    s_add_u32 s43, s43, 1
    s_and_b32 s43, s43, 31
    s_waitcnt vmcnt(16)
    s_barrier
    s_mov_b32 s43, 21
    s_mul_i32 s42, s43, 131072
    s_add_u32 s42, s42, s46
    s_add_u32 m0, s47, 53248
    s_add_u32 s44, s42, 0
    buffer_load_dwordx4 v2, s[8:11], s44 offen lds
    s_add_u32 m0, s47, 54272
    s_add_u32 s44, s42, 8192
    buffer_load_dwordx4 v2, s[8:11], s44 offen lds
    s_add_u32 m0, s47, 55296
    s_add_u32 s44, s42, 16384
    buffer_load_dwordx4 v3, s[8:11], s44 offen lds
    s_add_u32 m0, s47, 56320
    s_add_u32 s44, s42, 24576
    buffer_load_dwordx4 v3, s[8:11], s44 offen lds
    s_add_u32 m0, s47, 57344
    s_add_u32 s44, s42, 32768
    buffer_load_dwordx4 v2, s[8:11], s44 offen lds
    s_add_u32 m0, s47, 58368
    s_add_u32 s44, s42, 40960
    buffer_load_dwordx4 v2, s[8:11], s44 offen lds
    s_add_u32 m0, s47, 59392
    s_add_u32 s44, s42, 49152
    buffer_load_dwordx4 v3, s[8:11], s44 offen lds
    s_add_u32 m0, s47, 60416
    s_add_u32 s44, s42, 57344
    buffer_load_dwordx4 v3, s[8:11], s44 offen lds
    s_add_u32 s43, s43, 1
    s_and_b32 s43, s43, 31
    s_waitcnt vmcnt(16)
    s_barrier
    s_mov_b32 s43, 22
    s_mul_i32 s42, s43, 131072
    s_add_u32 s42, s42, s46
    s_add_u32 m0, s47, 88064
    s_add_u32 s44, s42, 0
    buffer_load_dwordx4 v2, s[8:11], s44 offen lds
    s_add_u32 m0, s47, 89088
    s_add_u32 s44, s42, 8192
    buffer_load_dwordx4 v2, s[8:11], s44 offen lds
    s_add_u32 m0, s47, 90112
    s_add_u32 s44, s42, 16384
    buffer_load_dwordx4 v3, s[8:11], s44 offen lds
    s_add_u32 m0, s47, 91136
    s_add_u32 s44, s42, 24576
    buffer_load_dwordx4 v3, s[8:11], s44 offen lds
    s_add_u32 m0, s47, 92160
    s_add_u32 s44, s42, 32768
    buffer_load_dwordx4 v2, s[8:11], s44 offen lds
    s_add_u32 m0, s47, 93184
    s_add_u32 s44, s42, 40960
    buffer_load_dwordx4 v2, s[8:11], s44 offen lds
    s_add_u32 m0, s47, 94208
    s_add_u32 s44, s42, 49152
    buffer_load_dwordx4 v3, s[8:11], s44 offen lds
    s_add_u32 m0, s47, 95232
    s_add_u32 s44, s42, 57344
    buffer_load_dwordx4 v3, s[8:11], s44 offen lds
    s_add_u32 s43, s43, 1
    s_and_b32 s43, s43, 31
    s_waitcnt vmcnt(16)
    s_barrier
    s_mov_b32 s43, 23
    s_mul_i32 s42, s43, 131072
    s_add_u32 s42, s42, s46
    s_add_u32 m0, s47, 122880
    s_add_u32 s44, s42, 0
    buffer_load_dwordx4 v2, s[8:11], s44 offen lds
    s_add_u32 m0, s47, 123904
    s_add_u32 s44, s42, 8192
    buffer_load_dwordx4 v2, s[8:11], s44 offen lds
    s_add_u32 m0, s47, 124928
    s_add_u32 s44, s42, 16384
    buffer_load_dwordx4 v3, s[8:11], s44 offen lds
    s_add_u32 m0, s47, 125952
    s_add_u32 s44, s42, 24576
    buffer_load_dwordx4 v3, s[8:11], s44 offen lds
    s_add_u32 m0, s47, 126976
    s_add_u32 s44, s42, 32768
    buffer_load_dwordx4 v2, s[8:11], s44 offen lds
    s_add_u32 m0, s47, 128000
    s_add_u32 s44, s42, 40960
    buffer_load_dwordx4 v2, s[8:11], s44 offen lds
    s_add_u32 m0, s47, 129024
    s_add_u32 s44, s42, 49152
    buffer_load_dwordx4 v3, s[8:11], s44 offen lds
    s_add_u32 m0, s47, 130048
    s_add_u32 s44, s42, 57344
    buffer_load_dwordx4 v3, s[8:11], s44 offen lds
    s_add_u32 s43, s43, 1
    s_and_b32 s43, s43, 31
    s_waitcnt vmcnt(16)
    s_barrier
    s_mov_b32 s43, 8
    s_mul_i32 s42, s43, 131072
    s_add_u32 s42, s42, s46
    s_add_u32 m0, s47, 18432
    s_add_u32 s44, s42, 0
    buffer_load_dwordx4 v2, s[8:11], s44 offen lds
    s_add_u32 m0, s47, 19456
    s_add_u32 s44, s42, 8192
    buffer_load_dwordx4 v2, s[8:11], s44 offen lds
    s_add_u32 m0, s47, 20480
    s_add_u32 s44, s42, 16384
    buffer_load_dwordx4 v3, s[8:11], s44 offen lds
    s_add_u32 m0, s47, 21504
    s_add_u32 s44, s42, 24576
    buffer_load_dwordx4 v3, s[8:11], s44 offen lds
    s_add_u32 m0, s47, 22528
    s_add_u32 s44, s42, 32768
    buffer_load_dwordx4 v2, s[8:11], s44 offen lds
    s_add_u32 m0, s47, 23552
    s_add_u32 s44, s42, 40960
    buffer_load_dwordx4 v2, s[8:11], s44 offen lds
    s_add_u32 m0, s47, 24576
    s_add_u32 s44, s42, 49152
    buffer_load_dwordx4 v3, s[8:11], s44 offen lds
    s_add_u32 m0, s47, 25600
    s_add_u32 s44, s42, 57344
    buffer_load_dwordx4 v3, s[8:11], s44 offen lds
    s_add_u32 s43, s43, 1
    s_and_b32 s43, s43, 31
    s_waitcnt vmcnt(16)
    s_barrier
    s_mov_b32 s43, 9
    s_mul_i32 s42, s43, 131072
    s_add_u32 s42, s42, s46
    s_add_u32 m0, s47, 53248
    s_add_u32 s44, s42, 0
    buffer_load_dwordx4 v2, s[8:11], s44 offen lds
    s_add_u32 m0, s47, 54272
    s_add_u32 s44, s42, 8192
    buffer_load_dwordx4 v2, s[8:11], s44 offen lds
    s_add_u32 m0, s47, 55296
    s_add_u32 s44, s42, 16384
    buffer_load_dwordx4 v3, s[8:11], s44 offen lds
    s_add_u32 m0, s47, 56320
    s_add_u32 s44, s42, 24576
    buffer_load_dwordx4 v3, s[8:11], s44 offen lds
    s_add_u32 m0, s47, 57344
    s_add_u32 s44, s42, 32768
    buffer_load_dwordx4 v2, s[8:11], s44 offen lds
    s_add_u32 m0, s47, 58368
    s_add_u32 s44, s42, 40960
    buffer_load_dwordx4 v2, s[8:11], s44 offen lds
    s_add_u32 m0, s47, 59392
    s_add_u32 s44, s42, 49152
    buffer_load_dwordx4 v3, s[8:11], s44 offen lds
    s_add_u32 m0, s47, 60416
    s_add_u32 s44, s42, 57344
    buffer_load_dwordx4 v3, s[8:11], s44 offen lds
    s_add_u32 s43, s43, 1
    s_and_b32 s43, s43, 31
    s_waitcnt vmcnt(16)
    s_barrier
    s_mov_b32 s43, 10
    s_mul_i32 s42, s43, 131072
    s_add_u32 s42, s42, s46
    s_add_u32 m0, s47, 88064
    s_add_u32 s44, s42, 0
    buffer_load_dwordx4 v2, s[8:11], s44 offen lds
    s_add_u32 m0, s47, 89088
    s_add_u32 s44, s42, 8192
    buffer_load_dwordx4 v2, s[8:11], s44 offen lds
    s_add_u32 m0, s47, 90112
    s_add_u32 s44, s42, 16384
    buffer_load_dwordx4 v3, s[8:11], s44 offen lds
    s_add_u32 m0, s47, 91136
    s_add_u32 s44, s42, 24576
    buffer_load_dwordx4 v3, s[8:11], s44 offen lds
    s_add_u32 m0, s47, 92160
    s_add_u32 s44, s42, 32768
    buffer_load_dwordx4 v2, s[8:11], s44 offen lds
    s_add_u32 m0, s47, 93184
    s_add_u32 s44, s42, 40960
    buffer_load_dwordx4 v2, s[8:11], s44 offen lds
    s_add_u32 m0, s47, 94208
    s_add_u32 s44, s42, 49152
    buffer_load_dwordx4 v3, s[8:11], s44 offen lds
    s_add_u32 m0, s47, 95232
    s_add_u32 s44, s42, 57344
    buffer_load_dwordx4 v3, s[8:11], s44 offen lds
    s_add_u32 s43, s43, 1
    s_and_b32 s43, s43, 31
    s_waitcnt vmcnt(16)
    s_barrier
    s_mov_b32 s43, 11
    s_mul_i32 s42, s43, 131072
    s_add_u32 s42, s42, s46
    s_add_u32 m0, s47, 122880
    s_add_u32 s44, s42, 0
    buffer_load_dwordx4 v2, s[8:11], s44 offen lds
    s_add_u32 m0, s47, 123904
    s_add_u32 s44, s42, 8192
    buffer_load_dwordx4 v2, s[8:11], s44 offen lds
    s_add_u32 m0, s47, 124928
    s_add_u32 s44, s42, 16384
    buffer_load_dwordx4 v3, s[8:11], s44 offen lds
    s_add_u32 m0, s47, 125952
    s_add_u32 s44, s42, 24576
    buffer_load_dwordx4 v3, s[8:11], s44 offen lds
    s_add_u32 m0, s47, 126976
    s_add_u32 s44, s42, 32768
    buffer_load_dwordx4 v2, s[8:11], s44 offen lds
    s_add_u32 m0, s47, 128000
    s_add_u32 s44, s42, 40960
    buffer_load_dwordx4 v2, s[8:11], s44 offen lds
    s_add_u32 m0, s47, 129024
    s_add_u32 s44, s42, 49152
    buffer_load_dwordx4 v3, s[8:11], s44 offen lds
    s_add_u32 m0, s47, 130048
    s_add_u32 s44, s42, 57344
    buffer_load_dwordx4 v3, s[8:11], s44 offen lds
    s_add_u32 s43, s43, 1
    s_and_b32 s43, s43, 31
    s_waitcnt vmcnt(16)
    s_barrier
    s_mov_b32 s43, 12
    s_mul_i32 s42, s43, 131072
    s_add_u32 s42, s42, s46
    s_add_u32 m0, s47, 18432
    s_add_u32 s44, s42, 0
    buffer_load_dwordx4 v2, s[8:11], s44 offen lds
    s_add_u32 m0, s47, 19456
    s_add_u32 s44, s42, 8192
    buffer_load_dwordx4 v2, s[8:11], s44 offen lds
    s_add_u32 m0, s47, 20480
    s_add_u32 s44, s42, 16384
    buffer_load_dwordx4 v3, s[8:11], s44 offen lds
    s_add_u32 m0, s47, 21504
    s_add_u32 s44, s42, 24576
    buffer_load_dwordx4 v3, s[8:11], s44 offen lds
    s_add_u32 m0, s47, 22528
    s_add_u32 s44, s42, 32768
    buffer_load_dwordx4 v2, s[8:11], s44 offen lds
    s_add_u32 m0, s47, 23552
    s_add_u32 s44, s42, 40960
    buffer_load_dwordx4 v2, s[8:11], s44 offen lds
    s_add_u32 m0, s47, 24576
    s_add_u32 s44, s42, 49152
    buffer_load_dwordx4 v3, s[8:11], s44 offen lds
    s_add_u32 m0, s47, 25600
    s_add_u32 s44, s42, 57344
    buffer_load_dwordx4 v3, s[8:11], s44 offen lds
    s_add_u32 s43, s43, 1
    s_and_b32 s43, s43, 31
    s_waitcnt vmcnt(16)
    s_barrier
    s_mov_b32 s43, 13
    s_mul_i32 s42, s43, 131072
    s_add_u32 s42, s42, s46
    s_add_u32 m0, s47, 53248
    s_add_u32 s44, s42, 0
    buffer_load_dwordx4 v2, s[8:11], s44 offen lds
    s_add_u32 m0, s47, 54272
    s_add_u32 s44, s42, 8192
    buffer_load_dwordx4 v2, s[8:11], s44 offen lds
    s_add_u32 m0, s47, 55296
    s_add_u32 s44, s42, 16384
    buffer_load_dwordx4 v3, s[8:11], s44 offen lds
    s_add_u32 m0, s47, 56320
    s_add_u32 s44, s42, 24576
    buffer_load_dwordx4 v3, s[8:11], s44 offen lds
    s_add_u32 m0, s47, 57344
    s_add_u32 s44, s42, 32768
    buffer_load_dwordx4 v2, s[8:11], s44 offen lds
    s_add_u32 m0, s47, 58368
    s_add_u32 s44, s42, 40960
    buffer_load_dwordx4 v2, s[8:11], s44 offen lds
    s_add_u32 m0, s47, 59392
    s_add_u32 s44, s42, 49152
    buffer_load_dwordx4 v3, s[8:11], s44 offen lds
    s_add_u32 m0, s47, 60416
    s_add_u32 s44, s42, 57344
    buffer_load_dwordx4 v3, s[8:11], s44 offen lds
    s_add_u32 s43, s43, 1
    s_and_b32 s43, s43, 31
    s_waitcnt vmcnt(16)
    s_barrier
    s_mov_b32 s43, 14
    s_mul_i32 s42, s43, 131072
    s_add_u32 s42, s42, s46
    s_add_u32 m0, s47, 88064
    s_add_u32 s44, s42, 0
    buffer_load_dwordx4 v2, s[8:11], s44 offen lds
    s_add_u32 m0, s47, 89088
    s_add_u32 s44, s42, 8192
    buffer_load_dwordx4 v2, s[8:11], s44 offen lds
    s_add_u32 m0, s47, 90112
    s_add_u32 s44, s42, 16384
    buffer_load_dwordx4 v3, s[8:11], s44 offen lds
    s_add_u32 m0, s47, 91136
    s_add_u32 s44, s42, 24576
    buffer_load_dwordx4 v3, s[8:11], s44 offen lds
    s_add_u32 m0, s47, 92160
    s_add_u32 s44, s42, 32768
    buffer_load_dwordx4 v2, s[8:11], s44 offen lds
    s_add_u32 m0, s47, 93184
    s_add_u32 s44, s42, 40960
    buffer_load_dwordx4 v2, s[8:11], s44 offen lds
    s_add_u32 m0, s47, 94208
    s_add_u32 s44, s42, 49152
    buffer_load_dwordx4 v3, s[8:11], s44 offen lds
    s_add_u32 m0, s47, 95232
    s_add_u32 s44, s42, 57344
    buffer_load_dwordx4 v3, s[8:11], s44 offen lds
    s_add_u32 s43, s43, 1
    s_and_b32 s43, s43, 31
    s_waitcnt vmcnt(16)
    s_barrier
    s_mov_b32 s43, 15
    s_mul_i32 s42, s43, 131072
    s_add_u32 s42, s42, s46
    s_add_u32 m0, s47, 122880
    s_add_u32 s44, s42, 0
    buffer_load_dwordx4 v2, s[8:11], s44 offen lds
    s_add_u32 m0, s47, 123904
    s_add_u32 s44, s42, 8192
    buffer_load_dwordx4 v2, s[8:11], s44 offen lds
    s_add_u32 m0, s47, 124928
    s_add_u32 s44, s42, 16384
    buffer_load_dwordx4 v3, s[8:11], s44 offen lds
    s_add_u32 m0, s47, 125952
    s_add_u32 s44, s42, 24576
    buffer_load_dwordx4 v3, s[8:11], s44 offen lds
    s_add_u32 m0, s47, 126976
    s_add_u32 s44, s42, 32768
    buffer_load_dwordx4 v2, s[8:11], s44 offen lds
    s_add_u32 m0, s47, 128000
    s_add_u32 s44, s42, 40960
    buffer_load_dwordx4 v2, s[8:11], s44 offen lds
    s_add_u32 m0, s47, 129024
    s_add_u32 s44, s42, 49152
    buffer_load_dwordx4 v3, s[8:11], s44 offen lds
    s_add_u32 m0, s47, 130048
    s_add_u32 s44, s42, 57344
    buffer_load_dwordx4 v3, s[8:11], s44 offen lds
    s_add_u32 s43, s43, 1
    s_and_b32 s43, s43, 31
    s_waitcnt vmcnt(16)
    s_barrier
    s_mov_b32 s43, 24
    s_mul_i32 s42, s43, 131072
    s_add_u32 s42, s42, s46
    s_add_u32 m0, s47, 18432
    s_add_u32 s44, s42, 0
    buffer_load_dwordx4 v2, s[8:11], s44 offen lds
    s_add_u32 m0, s47, 19456
    s_add_u32 s44, s42, 8192
    buffer_load_dwordx4 v2, s[8:11], s44 offen lds
    s_add_u32 m0, s47, 20480
    s_add_u32 s44, s42, 16384
    buffer_load_dwordx4 v3, s[8:11], s44 offen lds
    s_add_u32 m0, s47, 21504
    s_add_u32 s44, s42, 24576
    buffer_load_dwordx4 v3, s[8:11], s44 offen lds
    s_add_u32 m0, s47, 22528
    s_add_u32 s44, s42, 32768
    buffer_load_dwordx4 v2, s[8:11], s44 offen lds
    s_add_u32 m0, s47, 23552
    s_add_u32 s44, s42, 40960
    buffer_load_dwordx4 v2, s[8:11], s44 offen lds
    s_add_u32 m0, s47, 24576
    s_add_u32 s44, s42, 49152
    buffer_load_dwordx4 v3, s[8:11], s44 offen lds
    s_add_u32 m0, s47, 25600
    s_add_u32 s44, s42, 57344
    buffer_load_dwordx4 v3, s[8:11], s44 offen lds
    s_add_u32 s43, s43, 1
    s_and_b32 s43, s43, 31
    s_waitcnt vmcnt(16)
    s_barrier
    s_mov_b32 s43, 25
    s_mul_i32 s42, s43, 131072
    s_add_u32 s42, s42, s46
    s_add_u32 m0, s47, 53248
    s_add_u32 s44, s42, 0
    buffer_load_dwordx4 v2, s[8:11], s44 offen lds
    s_add_u32 m0, s47, 54272
    s_add_u32 s44, s42, 8192
    buffer_load_dwordx4 v2, s[8:11], s44 offen lds
    s_add_u32 m0, s47, 55296
    s_add_u32 s44, s42, 16384
    buffer_load_dwordx4 v3, s[8:11], s44 offen lds
    s_add_u32 m0, s47, 56320
    s_add_u32 s44, s42, 24576
    buffer_load_dwordx4 v3, s[8:11], s44 offen lds
    s_add_u32 m0, s47, 57344
    s_add_u32 s44, s42, 32768
    buffer_load_dwordx4 v2, s[8:11], s44 offen lds
    s_add_u32 m0, s47, 58368
    s_add_u32 s44, s42, 40960
    buffer_load_dwordx4 v2, s[8:11], s44 offen lds
    s_add_u32 m0, s47, 59392
    s_add_u32 s44, s42, 49152
    buffer_load_dwordx4 v3, s[8:11], s44 offen lds
    s_add_u32 m0, s47, 60416
    s_add_u32 s44, s42, 57344
    buffer_load_dwordx4 v3, s[8:11], s44 offen lds
    s_add_u32 s43, s43, 1
    s_and_b32 s43, s43, 31
    s_waitcnt vmcnt(16)
    s_barrier
    s_mov_b32 s43, 26
    s_mul_i32 s42, s43, 131072
    s_add_u32 s42, s42, s46
    s_add_u32 m0, s47, 88064
    s_add_u32 s44, s42, 0
    buffer_load_dwordx4 v2, s[8:11], s44 offen lds
    s_add_u32 m0, s47, 89088
    s_add_u32 s44, s42, 8192
    buffer_load_dwordx4 v2, s[8:11], s44 offen lds
    s_add_u32 m0, s47, 90112
    s_add_u32 s44, s42, 16384
    buffer_load_dwordx4 v3, s[8:11], s44 offen lds
    s_add_u32 m0, s47, 91136
    s_add_u32 s44, s42, 24576
    buffer_load_dwordx4 v3, s[8:11], s44 offen lds
    s_add_u32 m0, s47, 92160
    s_add_u32 s44, s42, 32768
    buffer_load_dwordx4 v2, s[8:11], s44 offen lds
    s_add_u32 m0, s47, 93184
    s_add_u32 s44, s42, 40960
    buffer_load_dwordx4 v2, s[8:11], s44 offen lds
    s_add_u32 m0, s47, 94208
    s_add_u32 s44, s42, 49152
    buffer_load_dwordx4 v3, s[8:11], s44 offen lds
    s_add_u32 m0, s47, 95232
    s_add_u32 s44, s42, 57344
    buffer_load_dwordx4 v3, s[8:11], s44 offen lds
    s_add_u32 s43, s43, 1
    s_and_b32 s43, s43, 31
    s_waitcnt vmcnt(16)
    s_barrier
    s_mov_b32 s43, 27
    s_mul_i32 s42, s43, 131072
    s_add_u32 s42, s42, s46
    s_add_u32 m0, s47, 122880
    s_add_u32 s44, s42, 0
    buffer_load_dwordx4 v2, s[8:11], s44 offen lds
    s_add_u32 m0, s47, 123904
    s_add_u32 s44, s42, 8192
    buffer_load_dwordx4 v2, s[8:11], s44 offen lds
    s_add_u32 m0, s47, 124928
    s_add_u32 s44, s42, 16384
    buffer_load_dwordx4 v3, s[8:11], s44 offen lds
    s_add_u32 m0, s47, 125952
    s_add_u32 s44, s42, 24576
    buffer_load_dwordx4 v3, s[8:11], s44 offen lds
    s_add_u32 m0, s47, 126976
    s_add_u32 s44, s42, 32768
    buffer_load_dwordx4 v2, s[8:11], s44 offen lds
    s_add_u32 m0, s47, 128000
    s_add_u32 s44, s42, 40960
    buffer_load_dwordx4 v2, s[8:11], s44 offen lds
    s_add_u32 m0, s47, 129024
    s_add_u32 s44, s42, 49152
    buffer_load_dwordx4 v3, s[8:11], s44 offen lds
    s_add_u32 m0, s47, 130048
    s_add_u32 s44, s42, 57344
    buffer_load_dwordx4 v3, s[8:11], s44 offen lds
    s_add_u32 s43, s43, 1
    s_and_b32 s43, s43, 31
    s_waitcnt vmcnt(16)
    s_barrier
    s_mov_b32 s43, 28
    s_mul_i32 s42, s43, 131072
    s_add_u32 s42, s42, s46
    s_add_u32 m0, s47, 18432
    s_add_u32 s44, s42, 0
    buffer_load_dwordx4 v2, s[8:11], s44 offen lds
    s_add_u32 m0, s47, 19456
    s_add_u32 s44, s42, 8192
    buffer_load_dwordx4 v2, s[8:11], s44 offen lds
    s_add_u32 m0, s47, 20480
    s_add_u32 s44, s42, 16384
    buffer_load_dwordx4 v3, s[8:11], s44 offen lds
    s_add_u32 m0, s47, 21504
    s_add_u32 s44, s42, 24576
    buffer_load_dwordx4 v3, s[8:11], s44 offen lds
    s_add_u32 m0, s47, 22528
    s_add_u32 s44, s42, 32768
    buffer_load_dwordx4 v2, s[8:11], s44 offen lds
    s_add_u32 m0, s47, 23552
    s_add_u32 s44, s42, 40960
    buffer_load_dwordx4 v2, s[8:11], s44 offen lds
    s_add_u32 m0, s47, 24576
    s_add_u32 s44, s42, 49152
    buffer_load_dwordx4 v3, s[8:11], s44 offen lds
    s_add_u32 m0, s47, 25600
    s_add_u32 s44, s42, 57344
    buffer_load_dwordx4 v3, s[8:11], s44 offen lds
    s_add_u32 s43, s43, 1
    s_and_b32 s43, s43, 31
    s_waitcnt vmcnt(16)
    s_barrier
    s_mov_b32 s43, 29
    s_mul_i32 s42, s43, 131072
    s_add_u32 s42, s42, s46
    s_add_u32 m0, s47, 53248
    s_add_u32 s44, s42, 0
    buffer_load_dwordx4 v2, s[8:11], s44 offen lds
    s_add_u32 m0, s47, 54272
    s_add_u32 s44, s42, 8192
    buffer_load_dwordx4 v2, s[8:11], s44 offen lds
    s_add_u32 m0, s47, 55296
    s_add_u32 s44, s42, 16384
    buffer_load_dwordx4 v3, s[8:11], s44 offen lds
    s_add_u32 m0, s47, 56320
    s_add_u32 s44, s42, 24576
    buffer_load_dwordx4 v3, s[8:11], s44 offen lds
    s_add_u32 m0, s47, 57344
    s_add_u32 s44, s42, 32768
    buffer_load_dwordx4 v2, s[8:11], s44 offen lds
    s_add_u32 m0, s47, 58368
    s_add_u32 s44, s42, 40960
    buffer_load_dwordx4 v2, s[8:11], s44 offen lds
    s_add_u32 m0, s47, 59392
    s_add_u32 s44, s42, 49152
    buffer_load_dwordx4 v3, s[8:11], s44 offen lds
    s_add_u32 m0, s47, 60416
    s_add_u32 s44, s42, 57344
    buffer_load_dwordx4 v3, s[8:11], s44 offen lds
    s_add_u32 s43, s43, 1
    s_and_b32 s43, s43, 31
    s_waitcnt vmcnt(16)
    s_barrier
    s_mov_b32 s43, 30
    s_mul_i32 s42, s43, 131072
    s_add_u32 s42, s42, s46
    s_add_u32 m0, s47, 88064
    s_add_u32 s44, s42, 0
    buffer_load_dwordx4 v2, s[8:11], s44 offen lds
    s_add_u32 m0, s47, 89088
    s_add_u32 s44, s42, 8192
    buffer_load_dwordx4 v2, s[8:11], s44 offen lds
    s_add_u32 m0, s47, 90112
    s_add_u32 s44, s42, 16384
    buffer_load_dwordx4 v3, s[8:11], s44 offen lds
    s_add_u32 m0, s47, 91136
    s_add_u32 s44, s42, 24576
    buffer_load_dwordx4 v3, s[8:11], s44 offen lds
    s_add_u32 m0, s47, 92160
    s_add_u32 s44, s42, 32768
    buffer_load_dwordx4 v2, s[8:11], s44 offen lds
    s_add_u32 m0, s47, 93184
    s_add_u32 s44, s42, 40960
    buffer_load_dwordx4 v2, s[8:11], s44 offen lds
    s_add_u32 m0, s47, 94208
    s_add_u32 s44, s42, 49152
    buffer_load_dwordx4 v3, s[8:11], s44 offen lds
    s_add_u32 m0, s47, 95232
    s_add_u32 s44, s42, 57344
    buffer_load_dwordx4 v3, s[8:11], s44 offen lds
    s_add_u32 s43, s43, 1
    s_and_b32 s43, s43, 31
    s_waitcnt vmcnt(16)
    s_barrier
    s_mov_b32 s43, 31
    s_mul_i32 s42, s43, 131072
    s_add_u32 s42, s42, s46
    s_add_u32 m0, s47, 122880
    s_add_u32 s44, s42, 0
    buffer_load_dwordx4 v2, s[8:11], s44 offen lds
    s_add_u32 m0, s47, 123904
    s_add_u32 s44, s42, 8192
    buffer_load_dwordx4 v2, s[8:11], s44 offen lds
    s_add_u32 m0, s47, 124928
    s_add_u32 s44, s42, 16384
    buffer_load_dwordx4 v3, s[8:11], s44 offen lds
    s_add_u32 m0, s47, 125952
    s_add_u32 s44, s42, 24576
    buffer_load_dwordx4 v3, s[8:11], s44 offen lds
    s_add_u32 m0, s47, 126976
    s_add_u32 s44, s42, 32768
    buffer_load_dwordx4 v2, s[8:11], s44 offen lds
    s_add_u32 m0, s47, 128000
    s_add_u32 s44, s42, 40960
    buffer_load_dwordx4 v2, s[8:11], s44 offen lds
    s_add_u32 m0, s47, 129024
    s_add_u32 s44, s42, 49152
    buffer_load_dwordx4 v3, s[8:11], s44 offen lds
    s_add_u32 m0, s47, 130048
    s_add_u32 s44, s42, 57344
    buffer_load_dwordx4 v3, s[8:11], s44 offen lds
    s_add_u32 s43, s43, 1
    s_and_b32 s43, s43, 31
    s_waitcnt vmcnt(16)
    s_barrier
    s_waitcnt vmcnt(8)
    s_barrier
    s_waitcnt vmcnt(0)
    s_barrier
    s_endpgm
L_k1_lb:
    s_mul_i32 s44, s25, 294912
    s_add_u32 s4, s32, s44
    s_addc_u32 s5, s33, 0
    s_mov_b32 s6, 294912
    s_mov_b32 s7, 0x20000
    s_mov_b32 s51, 0
    v_lshrrev_b32 v14, 3, v1
    v_and_b32 v15, 7, v1
    v_lshrrev_b32 v16, 1, v14
    s_lshl_b32 s45, s51, 2
    v_add_u32 v16, s45, v16
    v_and_b32 v16, 7, v16
    v_xor_b32 v16, v16, v15
    v_lshlrev_b32 v16, 4, v16
    v_mul_u32_u24 v17, 2048, v14
    v_add_u32 v2, v16, v17
    v_xor_b32 v3, 64, v2
    s_mul_i32 s46, s51, 16384
    s_lshl_b32 s47, s51, 10
    s_lshl_b32 s42, s43, 7
    s_add_u32 s42, s42, s46
    s_add_u32 m0, s47, 0
    s_add_u32 s44, s42, 0
    buffer_load_dwordx4 v2, s[4:7], s44 offen lds
    s_add_u32 m0, s47, 1024
    s_add_u32 s44, s42, 16384
    buffer_load_dwordx4 v3, s[4:7], s44 offen lds
    s_add_u32 m0, s47, 2048
    s_add_u32 s44, s42, 32768
    buffer_load_dwordx4 v2, s[4:7], s44 offen lds
    s_add_u32 m0, s47, 3072
    s_add_u32 s44, s42, 49152
    buffer_load_dwordx4 v3, s[4:7], s44 offen lds
    s_add_u32 m0, s47, 4096
    s_add_u32 s44, s42, 65536
    buffer_load_dwordx4 v2, s[4:7], s44 offen lds
    s_add_u32 m0, s47, 5120
    s_add_u32 s44, s42, 81920
    buffer_load_dwordx4 v3, s[4:7], s44 offen lds
    s_add_u32 m0, s47, 6144
    s_add_u32 s44, s42, 98304
    buffer_load_dwordx4 v2, s[4:7], s44 offen lds
    s_add_u32 m0, s47, 7168
    s_add_u32 s44, s42, 114688
    buffer_load_dwordx4 v3, s[4:7], s44 offen lds
    s_add_u32 m0, s47, 8192
    s_add_u32 s44, s42, 131072
    buffer_load_dwordx4 v2, s[4:7], s44 offen lds
    s_add_u32 m0, s47, 9216
    s_add_u32 s44, s42, 147456
    buffer_load_dwordx4 v3, s[4:7], s44 offen lds
    s_add_u32 m0, s47, 10240
    s_add_u32 s44, s42, 163840
    buffer_load_dwordx4 v2, s[4:7], s44 offen lds
    s_add_u32 m0, s47, 11264
    s_add_u32 s44, s42, 180224
    buffer_load_dwordx4 v3, s[4:7], s44 offen lds
    s_add_u32 m0, s47, 12288
    s_add_u32 s44, s42, 196608
    buffer_load_dwordx4 v2, s[4:7], s44 offen lds
    s_add_u32 m0, s47, 13312
    s_add_u32 s44, s42, 212992
    buffer_load_dwordx4 v3, s[4:7], s44 offen lds
    s_add_u32 m0, s47, 14336
    s_add_u32 s44, s42, 229376
    buffer_load_dwordx4 v2, s[4:7], s44 offen lds
    s_add_u32 m0, s47, 15360
    s_add_u32 s44, s42, 245760
    buffer_load_dwordx4 v3, s[4:7], s44 offen lds
    s_add_u32 m0, s47, 16384
    s_add_u32 s44, s42, 262144
    buffer_load_dwordx4 v2, s[4:7], s44 offen lds
    s_add_u32 m0, s47, 17408
    s_add_u32 s44, s42, 278528
    buffer_load_dwordx4 v3, s[4:7], s44 offen lds
    s_add_u32 s43, s43, 1
    s_and_b32 s43, s43, 15
    s_lshl_b32 s42, s43, 7
    s_add_u32 s42, s42, s46
    s_add_u32 m0, s47, 34816
    s_add_u32 s44, s42, 0
    buffer_load_dwordx4 v2, s[4:7], s44 offen lds
    s_add_u32 m0, s47, 35840
    s_add_u32 s44, s42, 16384
    buffer_load_dwordx4 v3, s[4:7], s44 offen lds
    s_add_u32 m0, s47, 36864
    s_add_u32 s44, s42, 32768
    buffer_load_dwordx4 v2, s[4:7], s44 offen lds
    s_add_u32 m0, s47, 37888
    s_add_u32 s44, s42, 49152
    buffer_load_dwordx4 v3, s[4:7], s44 offen lds
    s_add_u32 m0, s47, 38912
    s_add_u32 s44, s42, 65536
    buffer_load_dwordx4 v2, s[4:7], s44 offen lds
    s_add_u32 m0, s47, 39936
    s_add_u32 s44, s42, 81920
    buffer_load_dwordx4 v3, s[4:7], s44 offen lds
    s_add_u32 m0, s47, 40960
    s_add_u32 s44, s42, 98304
    buffer_load_dwordx4 v2, s[4:7], s44 offen lds
    s_add_u32 m0, s47, 41984
    s_add_u32 s44, s42, 114688
    buffer_load_dwordx4 v3, s[4:7], s44 offen lds
    s_add_u32 m0, s47, 43008
    s_add_u32 s44, s42, 131072
    buffer_load_dwordx4 v2, s[4:7], s44 offen lds
    s_add_u32 m0, s47, 44032
    s_add_u32 s44, s42, 147456
    buffer_load_dwordx4 v3, s[4:7], s44 offen lds
    s_add_u32 m0, s47, 45056
    s_add_u32 s44, s42, 163840
    buffer_load_dwordx4 v2, s[4:7], s44 offen lds
    s_add_u32 m0, s47, 46080
    s_add_u32 s44, s42, 180224
    buffer_load_dwordx4 v3, s[4:7], s44 offen lds
    s_add_u32 m0, s47, 47104
    s_add_u32 s44, s42, 196608
    buffer_load_dwordx4 v2, s[4:7], s44 offen lds
    s_add_u32 m0, s47, 48128
    s_add_u32 s44, s42, 212992
    buffer_load_dwordx4 v3, s[4:7], s44 offen lds
    s_add_u32 m0, s47, 49152
    s_add_u32 s44, s42, 229376
    buffer_load_dwordx4 v2, s[4:7], s44 offen lds
    s_add_u32 m0, s47, 50176
    s_add_u32 s44, s42, 245760
    buffer_load_dwordx4 v3, s[4:7], s44 offen lds
    s_add_u32 m0, s47, 51200
    s_add_u32 s44, s42, 262144
    buffer_load_dwordx4 v2, s[4:7], s44 offen lds
    s_add_u32 m0, s47, 52224
    s_add_u32 s44, s42, 278528
    buffer_load_dwordx4 v3, s[4:7], s44 offen lds
    s_add_u32 s43, s43, 1
    s_and_b32 s43, s43, 15
    s_waitcnt vmcnt(18)
    s_barrier
    s_lshl_b32 s42, s43, 7
    s_add_u32 s42, s42, s46
    s_add_u32 m0, s47, 69632
    s_add_u32 s44, s42, 0
    buffer_load_dwordx4 v2, s[4:7], s44 offen lds
    s_add_u32 m0, s47, 70656
    s_add_u32 s44, s42, 16384
    buffer_load_dwordx4 v3, s[4:7], s44 offen lds
    s_add_u32 m0, s47, 71680
    s_add_u32 s44, s42, 32768
    buffer_load_dwordx4 v2, s[4:7], s44 offen lds
    s_add_u32 m0, s47, 72704
    s_add_u32 s44, s42, 49152
    buffer_load_dwordx4 v3, s[4:7], s44 offen lds
    s_add_u32 m0, s47, 73728
    s_add_u32 s44, s42, 65536
    buffer_load_dwordx4 v2, s[4:7], s44 offen lds
    s_add_u32 m0, s47, 74752
    s_add_u32 s44, s42, 81920
    buffer_load_dwordx4 v3, s[4:7], s44 offen lds
    s_add_u32 m0, s47, 75776
    s_add_u32 s44, s42, 98304
    buffer_load_dwordx4 v2, s[4:7], s44 offen lds
    s_add_u32 m0, s47, 76800
    s_add_u32 s44, s42, 114688
    buffer_load_dwordx4 v3, s[4:7], s44 offen lds
    s_add_u32 m0, s47, 77824
    s_add_u32 s44, s42, 131072
    buffer_load_dwordx4 v2, s[4:7], s44 offen lds
    s_add_u32 m0, s47, 78848
    s_add_u32 s44, s42, 147456
    buffer_load_dwordx4 v3, s[4:7], s44 offen lds
    s_add_u32 m0, s47, 79872
    s_add_u32 s44, s42, 163840
    buffer_load_dwordx4 v2, s[4:7], s44 offen lds
    s_add_u32 m0, s47, 80896
    s_add_u32 s44, s42, 180224
    buffer_load_dwordx4 v3, s[4:7], s44 offen lds
    s_add_u32 m0, s47, 81920
    s_add_u32 s44, s42, 196608
    buffer_load_dwordx4 v2, s[4:7], s44 offen lds
    s_add_u32 m0, s47, 82944
    s_add_u32 s44, s42, 212992
    buffer_load_dwordx4 v3, s[4:7], s44 offen lds
    s_add_u32 m0, s47, 83968
    s_add_u32 s44, s42, 229376
    buffer_load_dwordx4 v2, s[4:7], s44 offen lds
    s_add_u32 m0, s47, 84992
    s_add_u32 s44, s42, 245760
    buffer_load_dwordx4 v3, s[4:7], s44 offen lds
    s_add_u32 m0, s47, 86016
    s_add_u32 s44, s42, 262144
    buffer_load_dwordx4 v2, s[4:7], s44 offen lds
    s_add_u32 m0, s47, 87040
    s_add_u32 s44, s42, 278528
    buffer_load_dwordx4 v3, s[4:7], s44 offen lds
    s_add_u32 s43, s43, 1
    s_and_b32 s43, s43, 15
    s_waitcnt vmcnt(18)
    s_barrier
    s_lshl_b32 s42, s43, 7
    s_add_u32 s42, s42, s46
    s_add_u32 m0, s47, 0
    s_add_u32 s44, s42, 0
    buffer_load_dwordx4 v2, s[4:7], s44 offen lds
    s_add_u32 m0, s47, 1024
    s_add_u32 s44, s42, 16384
    buffer_load_dwordx4 v3, s[4:7], s44 offen lds
    s_add_u32 m0, s47, 2048
    s_add_u32 s44, s42, 32768
    buffer_load_dwordx4 v2, s[4:7], s44 offen lds
    s_add_u32 m0, s47, 3072
    s_add_u32 s44, s42, 49152
    buffer_load_dwordx4 v3, s[4:7], s44 offen lds
    s_add_u32 m0, s47, 4096
    s_add_u32 s44, s42, 65536
    buffer_load_dwordx4 v2, s[4:7], s44 offen lds
    s_add_u32 m0, s47, 5120
    s_add_u32 s44, s42, 81920
    buffer_load_dwordx4 v3, s[4:7], s44 offen lds
    s_add_u32 m0, s47, 6144
    s_add_u32 s44, s42, 98304
    buffer_load_dwordx4 v2, s[4:7], s44 offen lds
    s_add_u32 m0, s47, 7168
    s_add_u32 s44, s42, 114688
    buffer_load_dwordx4 v3, s[4:7], s44 offen lds
    s_add_u32 m0, s47, 8192
    s_add_u32 s44, s42, 131072
    buffer_load_dwordx4 v2, s[4:7], s44 offen lds
    s_add_u32 m0, s47, 9216
    s_add_u32 s44, s42, 147456
    buffer_load_dwordx4 v3, s[4:7], s44 offen lds
    s_add_u32 m0, s47, 10240
    s_add_u32 s44, s42, 163840
    buffer_load_dwordx4 v2, s[4:7], s44 offen lds
    s_add_u32 m0, s47, 11264
    s_add_u32 s44, s42, 180224
    buffer_load_dwordx4 v3, s[4:7], s44 offen lds
    s_add_u32 m0, s47, 12288
    s_add_u32 s44, s42, 196608
    buffer_load_dwordx4 v2, s[4:7], s44 offen lds
    s_add_u32 m0, s47, 13312
    s_add_u32 s44, s42, 212992
    buffer_load_dwordx4 v3, s[4:7], s44 offen lds
    s_add_u32 m0, s47, 14336
    s_add_u32 s44, s42, 229376
    buffer_load_dwordx4 v2, s[4:7], s44 offen lds
    s_add_u32 m0, s47, 15360
    s_add_u32 s44, s42, 245760
    buffer_load_dwordx4 v3, s[4:7], s44 offen lds
    s_add_u32 m0, s47, 16384
    s_add_u32 s44, s42, 262144
    buffer_load_dwordx4 v2, s[4:7], s44 offen lds
    s_add_u32 m0, s47, 17408
    s_add_u32 s44, s42, 278528
    buffer_load_dwordx4 v3, s[4:7], s44 offen lds
    s_add_u32 s43, s43, 1
    s_and_b32 s43, s43, 15
    v_lshrrev_b32 v14, 4, v1
    v_and_b32 v15, 15, v1
    v_lshrrev_b32 v16, 1, v15
    v_xor_b32 v16, v16, v14
    v_lshlrev_b32 v16, 4, v16
    v_lshl_add_u32 v16, v15, 7, v16
    s_mul_i32 s44, s53, 6144
    v_add_u32 v212, s44, v16
    v_xor_b32 v213, 64, v212
    v_lshrrev_b32 v16, 2, v15
    v_and_b32 v17, 1, v14
    v_lshl_add_u32 v17, v17, 2, v16
    v_lshlrev_b32 v18, 5, v17
    v_lshl_add_u32 v18, v14, 11, v18
    v_lshl_add_u32 v18, v16, 8, v18
    v_and_b32 v19, 3, v15
    v_lshl_add_u32 v18, v19, 3, v18
    v_add_u32 v214, 18432, v18
    v_xor_b32 v215, 32, v214
    v_xor_b32 v216, 64, v214
    v_xor_b32 v217, 96, v214
    v_xor_b32 v218, 128, v214
    v_xor_b32 v219, 160, v214
    v_xor_b32 v220, 192, v214
    v_xor_b32 v221, 224, v214
    v_mov_b32 v28, 0
    v_mov_b32 v29, 0
    v_mov_b32 v30, 0
    v_mov_b32 v31, 0
    v_mov_b32 v32, 0
    v_mov_b32 v33, 0
    v_mov_b32 v34, 0
    v_mov_b32 v35, 0
    v_mov_b32 v36, 0
    v_mov_b32 v37, 0
    v_mov_b32 v38, 0
    v_mov_b32 v39, 0
    v_mov_b32 v40, 0
    v_mov_b32 v41, 0
    v_mov_b32 v42, 0
    v_mov_b32 v43, 0
    v_mov_b32 v44, 0
    v_mov_b32 v45, 0
    v_mov_b32 v46, 0
    v_mov_b32 v47, 0
    v_mov_b32 v48, 0
    v_mov_b32 v49, 0
    v_mov_b32 v50, 0
    v_mov_b32 v51, 0
    v_mov_b32 v52, 0
    v_mov_b32 v53, 0
    v_mov_b32 v54, 0
    v_mov_b32 v55, 0
    v_mov_b32 v56, 0
    v_mov_b32 v57, 0
    v_mov_b32 v58, 0
    v_mov_b32 v59, 0
    v_mov_b32 v60, 0
    v_mov_b32 v61, 0
    v_mov_b32 v62, 0
    v_mov_b32 v63, 0
    v_mov_b32 v64, 0
    v_mov_b32 v65, 0
    v_mov_b32 v66, 0
    v_mov_b32 v67, 0
    v_mov_b32 v68, 0
    v_mov_b32 v69, 0
    v_mov_b32 v70, 0
    v_mov_b32 v71, 0
    v_mov_b32 v72, 0
    v_mov_b32 v73, 0
    v_mov_b32 v74, 0
    v_mov_b32 v75, 0
    v_mov_b32 v76, 0
    v_mov_b32 v77, 0
    v_mov_b32 v78, 0
    v_mov_b32 v79, 0
    v_mov_b32 v80, 0
    v_mov_b32 v81, 0
    v_mov_b32 v82, 0
    v_mov_b32 v83, 0
    v_mov_b32 v84, 0
    v_mov_b32 v85, 0
    v_mov_b32 v86, 0
    v_mov_b32 v87, 0
    v_mov_b32 v88, 0
    v_mov_b32 v89, 0
    v_mov_b32 v90, 0
    v_mov_b32 v91, 0
    v_mov_b32 v92, 0
    v_mov_b32 v93, 0
    v_mov_b32 v94, 0
    v_mov_b32 v95, 0
    v_mov_b32 v96, 0
    v_mov_b32 v97, 0
    v_mov_b32 v98, 0
    v_mov_b32 v99, 0
    v_mov_b32 v100, 0
    v_mov_b32 v101, 0
    v_mov_b32 v102, 0
    v_mov_b32 v103, 0
    v_mov_b32 v104, 0
    v_mov_b32 v105, 0
    v_mov_b32 v106, 0
    v_mov_b32 v107, 0
    v_mov_b32 v108, 0
    v_mov_b32 v109, 0
    v_mov_b32 v110, 0
    v_mov_b32 v111, 0
    v_mov_b32 v112, 0
    v_mov_b32 v113, 0
    v_mov_b32 v114, 0
    v_mov_b32 v115, 0
    v_mov_b32 v116, 0
    v_mov_b32 v117, 0
    v_mov_b32 v118, 0
    v_mov_b32 v119, 0
    v_mov_b32 v120, 0
    v_mov_b32 v121, 0
    v_mov_b32 v122, 0
    v_mov_b32 v123, 0
    s_waitcnt vmcnt(18)
    s_barrier
    s_lshl_b32 s42, s43, 7
    s_add_u32 s42, s42, s46
    s_add_u32 m0, s47, 34816
    s_add_u32 s44, s42, 0
    buffer_load_dwordx4 v2, s[4:7], s44 offen lds
    s_add_u32 m0, s47, 35840
    s_add_u32 s44, s42, 16384
    buffer_load_dwordx4 v3, s[4:7], s44 offen lds
    s_add_u32 m0, s47, 36864
    s_add_u32 s44, s42, 32768
    buffer_load_dwordx4 v2, s[4:7], s44 offen lds
    s_add_u32 m0, s47, 37888
    s_add_u32 s44, s42, 49152
    buffer_load_dwordx4 v3, s[4:7], s44 offen lds
    s_add_u32 m0, s47, 38912
    s_add_u32 s44, s42, 65536
    buffer_load_dwordx4 v2, s[4:7], s44 offen lds
    s_add_u32 m0, s47, 39936
    s_add_u32 s44, s42, 81920
    buffer_load_dwordx4 v3, s[4:7], s44 offen lds
    s_add_u32 m0, s47, 40960
    s_add_u32 s44, s42, 98304
    buffer_load_dwordx4 v2, s[4:7], s44 offen lds
    s_add_u32 m0, s47, 41984
    s_add_u32 s44, s42, 114688
    buffer_load_dwordx4 v3, s[4:7], s44 offen lds
    s_add_u32 m0, s47, 43008
    s_add_u32 s44, s42, 131072
    buffer_load_dwordx4 v2, s[4:7], s44 offen lds
    s_add_u32 m0, s47, 44032
    s_add_u32 s44, s42, 147456
    buffer_load_dwordx4 v3, s[4:7], s44 offen lds
    s_add_u32 m0, s47, 45056
    s_add_u32 s44, s42, 163840
    buffer_load_dwordx4 v2, s[4:7], s44 offen lds
    s_add_u32 m0, s47, 46080
    s_add_u32 s44, s42, 180224
    buffer_load_dwordx4 v3, s[4:7], s44 offen lds
    s_add_u32 m0, s47, 47104
    s_add_u32 s44, s42, 196608
    buffer_load_dwordx4 v2, s[4:7], s44 offen lds
    s_add_u32 m0, s47, 48128
    s_add_u32 s44, s42, 212992
    buffer_load_dwordx4 v3, s[4:7], s44 offen lds
    s_add_u32 m0, s47, 49152
    s_add_u32 s44, s42, 229376
    buffer_load_dwordx4 v2, s[4:7], s44 offen lds
    s_add_u32 m0, s47, 50176
    s_add_u32 s44, s42, 245760
    buffer_load_dwordx4 v3, s[4:7], s44 offen lds
    s_add_u32 m0, s47, 51200
    s_add_u32 s44, s42, 262144
    buffer_load_dwordx4 v2, s[4:7], s44 offen lds
    s_add_u32 m0, s47, 52224
    s_add_u32 s44, s42, 278528
    buffer_load_dwordx4 v3, s[4:7], s44 offen lds
    s_add_u32 s43, s43, 1
    s_and_b32 s43, s43, 15
    s_waitcnt vmcnt(18)
    s_barrier
    s_lshl_b32 s42, s43, 7
    s_add_u32 s42, s42, s46
    s_add_u32 m0, s47, 69632
    s_add_u32 s44, s42, 0
    buffer_load_dwordx4 v2, s[4:7], s44 offen lds
    s_add_u32 m0, s47, 70656
    s_add_u32 s44, s42, 16384
    buffer_load_dwordx4 v3, s[4:7], s44 offen lds
    s_add_u32 m0, s47, 71680
    s_add_u32 s44, s42, 32768
    buffer_load_dwordx4 v2, s[4:7], s44 offen lds
    s_add_u32 m0, s47, 72704
    s_add_u32 s44, s42, 49152
    buffer_load_dwordx4 v3, s[4:7], s44 offen lds
    s_add_u32 m0, s47, 73728
    s_add_u32 s44, s42, 65536
    buffer_load_dwordx4 v2, s[4:7], s44 offen lds
    s_add_u32 m0, s47, 74752
    s_add_u32 s44, s42, 81920
    buffer_load_dwordx4 v3, s[4:7], s44 offen lds
    s_add_u32 m0, s47, 75776
    s_add_u32 s44, s42, 98304
    buffer_load_dwordx4 v2, s[4:7], s44 offen lds
    s_add_u32 m0, s47, 76800
    s_add_u32 s44, s42, 114688
    buffer_load_dwordx4 v3, s[4:7], s44 offen lds
    s_add_u32 m0, s47, 77824
    s_add_u32 s44, s42, 131072
    buffer_load_dwordx4 v2, s[4:7], s44 offen lds
    s_add_u32 m0, s47, 78848
    s_add_u32 s44, s42, 147456
    buffer_load_dwordx4 v3, s[4:7], s44 offen lds
    s_add_u32 m0, s47, 79872
    s_add_u32 s44, s42, 163840
    buffer_load_dwordx4 v2, s[4:7], s44 offen lds
    s_add_u32 m0, s47, 80896
    s_add_u32 s44, s42, 180224
    buffer_load_dwordx4 v3, s[4:7], s44 offen lds
    s_add_u32 m0, s47, 81920
    s_add_u32 s44, s42, 196608
    buffer_load_dwordx4 v2, s[4:7], s44 offen lds
    s_add_u32 m0, s47, 82944
    s_add_u32 s44, s42, 212992
    buffer_load_dwordx4 v3, s[4:7], s44 offen lds
    s_add_u32 m0, s47, 83968
    s_add_u32 s44, s42, 229376
    buffer_load_dwordx4 v2, s[4:7], s44 offen lds
    s_add_u32 m0, s47, 84992
    s_add_u32 s44, s42, 245760
    buffer_load_dwordx4 v3, s[4:7], s44 offen lds
    s_add_u32 m0, s47, 86016
    s_add_u32 s44, s42, 262144
    buffer_load_dwordx4 v2, s[4:7], s44 offen lds
    s_add_u32 m0, s47, 87040
    s_add_u32 s44, s42, 278528
    buffer_load_dwordx4 v3, s[4:7], s44 offen lds
    s_add_u32 s43, s43, 1
    s_and_b32 s43, s43, 15
    s_waitcnt vmcnt(18)
    s_barrier
    s_lshl_b32 s42, s43, 7
    s_add_u32 s42, s42, s46
    s_add_u32 m0, s47, 0
    s_add_u32 s44, s42, 0
    buffer_load_dwordx4 v2, s[4:7], s44 offen lds
    s_add_u32 m0, s47, 1024
    s_add_u32 s44, s42, 16384
    buffer_load_dwordx4 v3, s[4:7], s44 offen lds
    s_add_u32 m0, s47, 2048
    s_add_u32 s44, s42, 32768
    buffer_load_dwordx4 v2, s[4:7], s44 offen lds
    s_add_u32 m0, s47, 3072
    s_add_u32 s44, s42, 49152
    buffer_load_dwordx4 v3, s[4:7], s44 offen lds
    s_add_u32 m0, s47, 4096
    s_add_u32 s44, s42, 65536
    buffer_load_dwordx4 v2, s[4:7], s44 offen lds
    s_add_u32 m0, s47, 5120
    s_add_u32 s44, s42, 81920
    buffer_load_dwordx4 v3, s[4:7], s44 offen lds
    s_add_u32 m0, s47, 6144
    s_add_u32 s44, s42, 98304
    buffer_load_dwordx4 v2, s[4:7], s44 offen lds
    s_add_u32 m0, s47, 7168
    s_add_u32 s44, s42, 114688
    buffer_load_dwordx4 v3, s[4:7], s44 offen lds
    s_add_u32 m0, s47, 8192
    s_add_u32 s44, s42, 131072
    buffer_load_dwordx4 v2, s[4:7], s44 offen lds
    s_add_u32 m0, s47, 9216
    s_add_u32 s44, s42, 147456
    buffer_load_dwordx4 v3, s[4:7], s44 offen lds
    s_add_u32 m0, s47, 10240
    s_add_u32 s44, s42, 163840
    buffer_load_dwordx4 v2, s[4:7], s44 offen lds
    s_add_u32 m0, s47, 11264
    s_add_u32 s44, s42, 180224
    buffer_load_dwordx4 v3, s[4:7], s44 offen lds
    s_add_u32 m0, s47, 12288
    s_add_u32 s44, s42, 196608
    buffer_load_dwordx4 v2, s[4:7], s44 offen lds
    s_add_u32 m0, s47, 13312
    s_add_u32 s44, s42, 212992
    buffer_load_dwordx4 v3, s[4:7], s44 offen lds
    s_add_u32 m0, s47, 14336
    s_add_u32 s44, s42, 229376
    buffer_load_dwordx4 v2, s[4:7], s44 offen lds
    s_add_u32 m0, s47, 15360
    s_add_u32 s44, s42, 245760
    buffer_load_dwordx4 v3, s[4:7], s44 offen lds
    s_add_u32 m0, s47, 16384
    s_add_u32 s44, s42, 262144
    buffer_load_dwordx4 v2, s[4:7], s44 offen lds
    s_add_u32 m0, s47, 17408
    s_add_u32 s44, s42, 278528
    buffer_load_dwordx4 v3, s[4:7], s44 offen lds
    s_add_u32 s43, s43, 1
    s_and_b32 s43, s43, 15
    s_waitcnt vmcnt(18)
    s_barrier
    s_lshl_b32 s42, s43, 7
    s_add_u32 s42, s42, s46
    s_add_u32 m0, s47, 34816
    s_add_u32 s44, s42, 0
    buffer_load_dwordx4 v2, s[4:7], s44 offen lds
    s_add_u32 m0, s47, 35840
    s_add_u32 s44, s42, 16384
    buffer_load_dwordx4 v3, s[4:7], s44 offen lds
    s_add_u32 m0, s47, 36864
    s_add_u32 s44, s42, 32768
    buffer_load_dwordx4 v2, s[4:7], s44 offen lds
    s_add_u32 m0, s47, 37888
    s_add_u32 s44, s42, 49152
    buffer_load_dwordx4 v3, s[4:7], s44 offen lds
    s_add_u32 m0, s47, 38912
    s_add_u32 s44, s42, 65536
    buffer_load_dwordx4 v2, s[4:7], s44 offen lds
    s_add_u32 m0, s47, 39936
    s_add_u32 s44, s42, 81920
    buffer_load_dwordx4 v3, s[4:7], s44 offen lds
    s_add_u32 m0, s47, 40960
    s_add_u32 s44, s42, 98304
    buffer_load_dwordx4 v2, s[4:7], s44 offen lds
    s_add_u32 m0, s47, 41984
    s_add_u32 s44, s42, 114688
    buffer_load_dwordx4 v3, s[4:7], s44 offen lds
    s_add_u32 m0, s47, 43008
    s_add_u32 s44, s42, 131072
    buffer_load_dwordx4 v2, s[4:7], s44 offen lds
    s_add_u32 m0, s47, 44032
    s_add_u32 s44, s42, 147456
    buffer_load_dwordx4 v3, s[4:7], s44 offen lds
    s_add_u32 m0, s47, 45056
    s_add_u32 s44, s42, 163840
    buffer_load_dwordx4 v2, s[4:7], s44 offen lds
    s_add_u32 m0, s47, 46080
    s_add_u32 s44, s42, 180224
    buffer_load_dwordx4 v3, s[4:7], s44 offen lds
    s_add_u32 m0, s47, 47104
    s_add_u32 s44, s42, 196608
    buffer_load_dwordx4 v2, s[4:7], s44 offen lds
    s_add_u32 m0, s47, 48128
    s_add_u32 s44, s42, 212992
    buffer_load_dwordx4 v3, s[4:7], s44 offen lds
    s_add_u32 m0, s47, 49152
    s_add_u32 s44, s42, 229376
    buffer_load_dwordx4 v2, s[4:7], s44 offen lds
    s_add_u32 m0, s47, 50176
    s_add_u32 s44, s42, 245760
    buffer_load_dwordx4 v3, s[4:7], s44 offen lds
    s_add_u32 m0, s47, 51200
    s_add_u32 s44, s42, 262144
    buffer_load_dwordx4 v2, s[4:7], s44 offen lds
    s_add_u32 m0, s47, 52224
    s_add_u32 s44, s42, 278528
    buffer_load_dwordx4 v3, s[4:7], s44 offen lds
    s_add_u32 s43, s43, 1
    s_and_b32 s43, s43, 15
    s_mov_b32 s51, 0
    s_mov_b32 s48, s46
    v_lshrrev_b32 v14, 4, v1
    v_and_b32 v15, 15, v1
    v_lshlrev_b32 v16, 1, v14
    v_xor_b32 v16, v16, v15
    v_lshlrev_b32 v16, 4, v16
    v_mul_u32_u24 v17, 8192, v14
    v_add_u32 v10, v16, v17
    v_xor_b32 v11, 128, v10
    s_mov_b32 s46, 0
    s_lshl_b32 s47, s51, 14
    s_mov_b32 s46, s48
    s_mov_b32 s47, 0
    s_add_u32 s26, s26, 4
    s_lshl_b32 s44, s26, 8
    s_add_u32 s8, s38, s44
    s_addc_u32 s9, s39, 0
    s_sub_u32 s10, 8388608, s44
    s_mov_b32 s11, 0x20000
    s_lshr_b32 s44, s2, 7
    s_mul_i32 s44, s44, 40
    s_add_u32 s56, s0, s44
    s_addc_u32 s57, s1, 0
    s_load_dwordx2 s[74:75], s[56:57], 32
    s_and_b32 s44, s2, 127
    s_lshl_b32 s44, s44, 16
    v_lshlrev_b32 v8, 6, v1
    s_waitcnt lgkmcnt(0)
    s_add_u32 s68, s74, s44
    s_addc_u32 s69, s75, 0
    s_mov_b32 s70, 65536
    s_mov_b32 s71, 0x20000
    s_waitcnt vmcnt(18)
    s_barrier
    s_lshl_b32 s42, s43, 7
    s_add_u32 s42, s42, s46
    s_add_u32 m0, s47, 69632
    s_add_u32 s44, s42, 0
    buffer_load_dwordx4 v2, s[4:7], s44 offen lds
    s_add_u32 m0, s47, 70656
    s_add_u32 s44, s42, 16384
    buffer_load_dwordx4 v3, s[4:7], s44 offen lds
    s_add_u32 m0, s47, 71680
    s_add_u32 s44, s42, 32768
    buffer_load_dwordx4 v2, s[4:7], s44 offen lds
    s_add_u32 m0, s47, 72704
    s_add_u32 s44, s42, 49152
    buffer_load_dwordx4 v3, s[4:7], s44 offen lds
    s_add_u32 m0, s47, 73728
    s_add_u32 s44, s42, 65536
    buffer_load_dwordx4 v2, s[4:7], s44 offen lds
    s_add_u32 m0, s47, 74752
    s_add_u32 s44, s42, 81920
    buffer_load_dwordx4 v3, s[4:7], s44 offen lds
    s_add_u32 m0, s47, 75776
    s_add_u32 s44, s42, 98304
    buffer_load_dwordx4 v2, s[4:7], s44 offen lds
    s_add_u32 m0, s47, 76800
    s_add_u32 s44, s42, 114688
    buffer_load_dwordx4 v3, s[4:7], s44 offen lds
    s_add_u32 m0, s47, 77824
    s_add_u32 s44, s42, 131072
    buffer_load_dwordx4 v2, s[4:7], s44 offen lds
    s_add_u32 m0, s47, 78848
    s_add_u32 s44, s42, 147456
    buffer_load_dwordx4 v3, s[4:7], s44 offen lds
    s_add_u32 m0, s47, 79872
    s_add_u32 s44, s42, 163840
    buffer_load_dwordx4 v2, s[4:7], s44 offen lds
    s_add_u32 m0, s47, 80896
    s_add_u32 s44, s42, 180224
    buffer_load_dwordx4 v3, s[4:7], s44 offen lds
    s_add_u32 m0, s47, 81920
    s_add_u32 s44, s42, 196608
    buffer_load_dwordx4 v2, s[4:7], s44 offen lds
    s_add_u32 m0, s47, 82944
    s_add_u32 s44, s42, 212992
    buffer_load_dwordx4 v3, s[4:7], s44 offen lds
    s_add_u32 m0, s47, 83968
    s_add_u32 s44, s42, 229376
    buffer_load_dwordx4 v2, s[4:7], s44 offen lds
    s_add_u32 m0, s47, 84992
    s_add_u32 s44, s42, 245760
    buffer_load_dwordx4 v3, s[4:7], s44 offen lds
    s_add_u32 m0, s47, 86016
    s_add_u32 s44, s42, 262144
    buffer_load_dwordx4 v2, s[4:7], s44 offen lds
    s_add_u32 m0, s47, 87040
    s_add_u32 s44, s42, 278528
    buffer_load_dwordx4 v3, s[4:7], s44 offen lds
    s_add_u32 s43, s43, 1
    s_and_b32 s43, s43, 15
    s_waitcnt vmcnt(18)
    s_barrier
    s_lshl_b32 s42, s43, 7
    s_add_u32 s42, s42, s46
    s_add_u32 m0, s47, 0
    s_add_u32 s44, s42, 0
    buffer_load_dwordx4 v2, s[4:7], s44 offen lds
    s_add_u32 m0, s47, 1024
    s_add_u32 s44, s42, 16384
    buffer_load_dwordx4 v3, s[4:7], s44 offen lds
    s_add_u32 m0, s47, 2048
    s_add_u32 s44, s42, 32768
    buffer_load_dwordx4 v2, s[4:7], s44 offen lds
    s_add_u32 m0, s47, 3072
    s_add_u32 s44, s42, 49152
    buffer_load_dwordx4 v3, s[4:7], s44 offen lds
    s_add_u32 m0, s47, 4096
    s_add_u32 s44, s42, 65536
    buffer_load_dwordx4 v2, s[4:7], s44 offen lds
    s_add_u32 m0, s47, 5120
    s_add_u32 s44, s42, 81920
    buffer_load_dwordx4 v3, s[4:7], s44 offen lds
    s_add_u32 m0, s47, 6144
    s_add_u32 s44, s42, 98304
    buffer_load_dwordx4 v2, s[4:7], s44 offen lds
    s_add_u32 m0, s47, 7168
    s_add_u32 s44, s42, 114688
    buffer_load_dwordx4 v3, s[4:7], s44 offen lds
    s_add_u32 m0, s47, 8192
    s_add_u32 s44, s42, 131072
    buffer_load_dwordx4 v2, s[4:7], s44 offen lds
    s_add_u32 m0, s47, 9216
    s_add_u32 s44, s42, 147456
    buffer_load_dwordx4 v3, s[4:7], s44 offen lds
    s_add_u32 m0, s47, 10240
    s_add_u32 s44, s42, 163840
    buffer_load_dwordx4 v2, s[4:7], s44 offen lds
    s_add_u32 m0, s47, 11264
    s_add_u32 s44, s42, 180224
    buffer_load_dwordx4 v3, s[4:7], s44 offen lds
    s_add_u32 m0, s47, 12288
    s_add_u32 s44, s42, 196608
    buffer_load_dwordx4 v2, s[4:7], s44 offen lds
    s_add_u32 m0, s47, 13312
    s_add_u32 s44, s42, 212992
    buffer_load_dwordx4 v3, s[4:7], s44 offen lds
    s_add_u32 m0, s47, 14336
    s_add_u32 s44, s42, 229376
    buffer_load_dwordx4 v2, s[4:7], s44 offen lds
    s_add_u32 m0, s47, 15360
    s_add_u32 s44, s42, 245760
    buffer_load_dwordx4 v3, s[4:7], s44 offen lds
    s_add_u32 m0, s47, 16384
    s_add_u32 s44, s42, 262144
    buffer_load_dwordx4 v2, s[4:7], s44 offen lds
    s_add_u32 m0, s47, 17408
    s_add_u32 s44, s42, 278528
    buffer_load_dwordx4 v3, s[4:7], s44 offen lds
    s_add_u32 s43, s43, 1
    s_and_b32 s43, s43, 15
    s_waitcnt vmcnt(18)
    s_barrier
    s_lshl_b32 s42, s43, 7
    s_add_u32 s42, s42, s46
    s_add_u32 m0, s47, 34816
    s_add_u32 s44, s42, 0
    buffer_load_dwordx4 v2, s[4:7], s44 offen lds
    s_add_u32 m0, s47, 35840
    s_add_u32 s44, s42, 16384
    buffer_load_dwordx4 v3, s[4:7], s44 offen lds
    s_add_u32 m0, s47, 36864
    s_add_u32 s44, s42, 32768
    buffer_load_dwordx4 v2, s[4:7], s44 offen lds
    s_add_u32 m0, s47, 37888
    s_add_u32 s44, s42, 49152
    buffer_load_dwordx4 v3, s[4:7], s44 offen lds
    s_add_u32 m0, s47, 38912
    s_add_u32 s44, s42, 65536
    buffer_load_dwordx4 v2, s[4:7], s44 offen lds
    s_add_u32 m0, s47, 39936
    s_add_u32 s44, s42, 81920
    buffer_load_dwordx4 v3, s[4:7], s44 offen lds
    s_add_u32 m0, s47, 40960
    s_add_u32 s44, s42, 98304
    buffer_load_dwordx4 v2, s[4:7], s44 offen lds
    s_add_u32 m0, s47, 41984
    s_add_u32 s44, s42, 114688
    buffer_load_dwordx4 v3, s[4:7], s44 offen lds
    s_add_u32 m0, s47, 43008
    s_add_u32 s44, s42, 131072
    buffer_load_dwordx4 v2, s[4:7], s44 offen lds
    s_add_u32 m0, s47, 44032
    s_add_u32 s44, s42, 147456
    buffer_load_dwordx4 v3, s[4:7], s44 offen lds
    s_add_u32 m0, s47, 45056
    s_add_u32 s44, s42, 163840
    buffer_load_dwordx4 v2, s[4:7], s44 offen lds
    s_add_u32 m0, s47, 46080
    s_add_u32 s44, s42, 180224
    buffer_load_dwordx4 v3, s[4:7], s44 offen lds
    s_add_u32 m0, s47, 47104
    s_add_u32 s44, s42, 196608
    buffer_load_dwordx4 v2, s[4:7], s44 offen lds
    s_add_u32 m0, s47, 48128
    s_add_u32 s44, s42, 212992
    buffer_load_dwordx4 v3, s[4:7], s44 offen lds
    s_add_u32 m0, s47, 49152
    s_add_u32 s44, s42, 229376
    buffer_load_dwordx4 v2, s[4:7], s44 offen lds
    s_add_u32 m0, s47, 50176
    s_add_u32 s44, s42, 245760
    buffer_load_dwordx4 v3, s[4:7], s44 offen lds
    s_add_u32 m0, s47, 51200
    s_add_u32 s44, s42, 262144
    buffer_load_dwordx4 v2, s[4:7], s44 offen lds
    s_add_u32 m0, s47, 52224
    s_add_u32 s44, s42, 278528
    buffer_load_dwordx4 v3, s[4:7], s44 offen lds
    s_add_u32 s43, s43, 1
    s_and_b32 s43, s43, 15
    s_waitcnt vmcnt(18)
    s_barrier
    s_lshl_b32 s42, s43, 7
    s_add_u32 s42, s42, s46
    s_add_u32 m0, s47, 69632
    s_add_u32 s44, s42, 0
    buffer_load_dwordx4 v2, s[4:7], s44 offen lds
    s_add_u32 m0, s47, 70656
    s_add_u32 s44, s42, 16384
    buffer_load_dwordx4 v3, s[4:7], s44 offen lds
    s_add_u32 m0, s47, 71680
    s_add_u32 s44, s42, 32768
    buffer_load_dwordx4 v2, s[4:7], s44 offen lds
    s_add_u32 m0, s47, 72704
    s_add_u32 s44, s42, 49152
    buffer_load_dwordx4 v3, s[4:7], s44 offen lds
    s_add_u32 m0, s47, 73728
    s_add_u32 s44, s42, 65536
    buffer_load_dwordx4 v2, s[4:7], s44 offen lds
    s_add_u32 m0, s47, 74752
    s_add_u32 s44, s42, 81920
    buffer_load_dwordx4 v3, s[4:7], s44 offen lds
    s_add_u32 m0, s47, 75776
    s_add_u32 s44, s42, 98304
    buffer_load_dwordx4 v2, s[4:7], s44 offen lds
    s_add_u32 m0, s47, 76800
    s_add_u32 s44, s42, 114688
    buffer_load_dwordx4 v3, s[4:7], s44 offen lds
    s_add_u32 m0, s47, 77824
    s_add_u32 s44, s42, 131072
    buffer_load_dwordx4 v2, s[4:7], s44 offen lds
    s_add_u32 m0, s47, 78848
    s_add_u32 s44, s42, 147456
    buffer_load_dwordx4 v3, s[4:7], s44 offen lds
    s_add_u32 m0, s47, 79872
    s_add_u32 s44, s42, 163840
    buffer_load_dwordx4 v2, s[4:7], s44 offen lds
    s_add_u32 m0, s47, 80896
    s_add_u32 s44, s42, 180224
    buffer_load_dwordx4 v3, s[4:7], s44 offen lds
    s_add_u32 m0, s47, 81920
    s_add_u32 s44, s42, 196608
    buffer_load_dwordx4 v2, s[4:7], s44 offen lds
    s_add_u32 m0, s47, 82944
    s_add_u32 s44, s42, 212992
    buffer_load_dwordx4 v3, s[4:7], s44 offen lds
    s_add_u32 m0, s47, 83968
    s_add_u32 s44, s42, 229376
    buffer_load_dwordx4 v2, s[4:7], s44 offen lds
    s_add_u32 m0, s47, 84992
    s_add_u32 s44, s42, 245760
    buffer_load_dwordx4 v3, s[4:7], s44 offen lds
    s_add_u32 m0, s47, 86016
    s_add_u32 s44, s42, 262144
    buffer_load_dwordx4 v2, s[4:7], s44 offen lds
    s_add_u32 m0, s47, 87040
    s_add_u32 s44, s42, 278528
    buffer_load_dwordx4 v3, s[4:7], s44 offen lds
    s_add_u32 s43, s43, 1
    s_and_b32 s43, s43, 15
    s_waitcnt vmcnt(18)
    s_barrier
    s_lshl_b32 s42, s43, 7
    s_add_u32 s42, s42, s46
    s_add_u32 m0, s47, 0
    s_add_u32 s44, s42, 0
    buffer_load_dwordx4 v2, s[4:7], s44 offen lds
    s_add_u32 m0, s47, 1024
    s_add_u32 s44, s42, 16384
    buffer_load_dwordx4 v3, s[4:7], s44 offen lds
    s_add_u32 m0, s47, 2048
    s_add_u32 s44, s42, 32768
    buffer_load_dwordx4 v2, s[4:7], s44 offen lds
    s_add_u32 m0, s47, 3072
    s_add_u32 s44, s42, 49152
    buffer_load_dwordx4 v3, s[4:7], s44 offen lds
    s_add_u32 m0, s47, 4096
    s_add_u32 s44, s42, 65536
    buffer_load_dwordx4 v2, s[4:7], s44 offen lds
    s_add_u32 m0, s47, 5120
    s_add_u32 s44, s42, 81920
    buffer_load_dwordx4 v3, s[4:7], s44 offen lds
    s_add_u32 m0, s47, 6144
    s_add_u32 s44, s42, 98304
    buffer_load_dwordx4 v2, s[4:7], s44 offen lds
    s_add_u32 m0, s47, 7168
    s_add_u32 s44, s42, 114688
    buffer_load_dwordx4 v3, s[4:7], s44 offen lds
    s_add_u32 m0, s47, 8192
    s_add_u32 s44, s42, 131072
    buffer_load_dwordx4 v2, s[4:7], s44 offen lds
    s_add_u32 m0, s47, 9216
    s_add_u32 s44, s42, 147456
    buffer_load_dwordx4 v3, s[4:7], s44 offen lds
    s_add_u32 m0, s47, 10240
    s_add_u32 s44, s42, 163840
    buffer_load_dwordx4 v2, s[4:7], s44 offen lds
    s_add_u32 m0, s47, 11264
    s_add_u32 s44, s42, 180224
    buffer_load_dwordx4 v3, s[4:7], s44 offen lds
    s_add_u32 m0, s47, 12288
    s_add_u32 s44, s42, 196608
    buffer_load_dwordx4 v2, s[4:7], s44 offen lds
    s_add_u32 m0, s47, 13312
    s_add_u32 s44, s42, 212992
    buffer_load_dwordx4 v3, s[4:7], s44 offen lds
    s_add_u32 m0, s47, 14336
    s_add_u32 s44, s42, 229376
    buffer_load_dwordx4 v2, s[4:7], s44 offen lds
    s_add_u32 m0, s47, 15360
    s_add_u32 s44, s42, 245760
    buffer_load_dwordx4 v3, s[4:7], s44 offen lds
    s_add_u32 m0, s47, 16384
    s_add_u32 s44, s42, 262144
    buffer_load_dwordx4 v2, s[4:7], s44 offen lds
    s_add_u32 m0, s47, 17408
    s_add_u32 s44, s42, 278528
    buffer_load_dwordx4 v3, s[4:7], s44 offen lds
    s_add_u32 s43, s43, 1
    s_and_b32 s43, s43, 15
    s_waitcnt vmcnt(18)
    s_barrier
    s_lshl_b32 s42, s43, 7
    s_add_u32 s42, s42, s46
    s_add_u32 m0, s47, 34816
    s_add_u32 s44, s42, 0
    buffer_load_dwordx4 v2, s[4:7], s44 offen lds
    s_add_u32 m0, s47, 35840
    s_add_u32 s44, s42, 16384
    buffer_load_dwordx4 v3, s[4:7], s44 offen lds
    s_add_u32 m0, s47, 36864
    s_add_u32 s44, s42, 32768
    buffer_load_dwordx4 v2, s[4:7], s44 offen lds
    s_add_u32 m0, s47, 37888
    s_add_u32 s44, s42, 49152
    buffer_load_dwordx4 v3, s[4:7], s44 offen lds
    s_add_u32 m0, s47, 38912
    s_add_u32 s44, s42, 65536
    buffer_load_dwordx4 v2, s[4:7], s44 offen lds
    s_add_u32 m0, s47, 39936
    s_add_u32 s44, s42, 81920
    buffer_load_dwordx4 v3, s[4:7], s44 offen lds
    s_add_u32 m0, s47, 40960
    s_add_u32 s44, s42, 98304
    buffer_load_dwordx4 v2, s[4:7], s44 offen lds
    s_add_u32 m0, s47, 41984
    s_add_u32 s44, s42, 114688
    buffer_load_dwordx4 v3, s[4:7], s44 offen lds
    s_add_u32 m0, s47, 43008
    s_add_u32 s44, s42, 131072
    buffer_load_dwordx4 v2, s[4:7], s44 offen lds
    s_add_u32 m0, s47, 44032
    s_add_u32 s44, s42, 147456
    buffer_load_dwordx4 v3, s[4:7], s44 offen lds
    s_add_u32 m0, s47, 45056
    s_add_u32 s44, s42, 163840
    buffer_load_dwordx4 v2, s[4:7], s44 offen lds
    s_add_u32 m0, s47, 46080
    s_add_u32 s44, s42, 180224
    buffer_load_dwordx4 v3, s[4:7], s44 offen lds
    s_add_u32 m0, s47, 47104
    s_add_u32 s44, s42, 196608
    buffer_load_dwordx4 v2, s[4:7], s44 offen lds
    s_add_u32 m0, s47, 48128
    s_add_u32 s44, s42, 212992
    buffer_load_dwordx4 v3, s[4:7], s44 offen lds
    s_add_u32 m0, s47, 49152
    s_add_u32 s44, s42, 229376
    buffer_load_dwordx4 v2, s[4:7], s44 offen lds
    s_add_u32 m0, s47, 50176
    s_add_u32 s44, s42, 245760
    buffer_load_dwordx4 v3, s[4:7], s44 offen lds
    s_add_u32 m0, s47, 51200
    s_add_u32 s44, s42, 262144
    buffer_load_dwordx4 v2, s[4:7], s44 offen lds
    s_add_u32 m0, s47, 52224
    s_add_u32 s44, s42, 278528
    buffer_load_dwordx4 v3, s[4:7], s44 offen lds
    s_add_u32 s43, s43, 1
    s_and_b32 s43, s43, 15
    s_waitcnt vmcnt(18)
    s_barrier
    s_lshl_b32 s42, s43, 7
    s_add_u32 s42, s42, s46
    s_add_u32 m0, s47, 69632
    s_add_u32 s44, s42, 0
    buffer_load_dwordx4 v2, s[4:7], s44 offen lds
    s_add_u32 m0, s47, 70656
    s_add_u32 s44, s42, 16384
    buffer_load_dwordx4 v3, s[4:7], s44 offen lds
    s_add_u32 m0, s47, 71680
    s_add_u32 s44, s42, 32768
    buffer_load_dwordx4 v2, s[4:7], s44 offen lds
    s_add_u32 m0, s47, 72704
    s_add_u32 s44, s42, 49152
    buffer_load_dwordx4 v3, s[4:7], s44 offen lds
    s_add_u32 m0, s47, 73728
    s_add_u32 s44, s42, 65536
    buffer_load_dwordx4 v2, s[4:7], s44 offen lds
    s_add_u32 m0, s47, 74752
    s_add_u32 s44, s42, 81920
    buffer_load_dwordx4 v3, s[4:7], s44 offen lds
    s_add_u32 m0, s47, 75776
    s_add_u32 s44, s42, 98304
    buffer_load_dwordx4 v2, s[4:7], s44 offen lds
    s_add_u32 m0, s47, 76800
    s_add_u32 s44, s42, 114688
    buffer_load_dwordx4 v3, s[4:7], s44 offen lds
    s_add_u32 m0, s47, 77824
    s_add_u32 s44, s42, 131072
    buffer_load_dwordx4 v2, s[4:7], s44 offen lds
    s_add_u32 m0, s47, 78848
    s_add_u32 s44, s42, 147456
    buffer_load_dwordx4 v3, s[4:7], s44 offen lds
    s_add_u32 m0, s47, 79872
    s_add_u32 s44, s42, 163840
    buffer_load_dwordx4 v2, s[4:7], s44 offen lds
    s_add_u32 m0, s47, 80896
    s_add_u32 s44, s42, 180224
    buffer_load_dwordx4 v3, s[4:7], s44 offen lds
    s_add_u32 m0, s47, 81920
    s_add_u32 s44, s42, 196608
    buffer_load_dwordx4 v2, s[4:7], s44 offen lds
    s_add_u32 m0, s47, 82944
    s_add_u32 s44, s42, 212992
    buffer_load_dwordx4 v3, s[4:7], s44 offen lds
    s_add_u32 m0, s47, 83968
    s_add_u32 s44, s42, 229376
    buffer_load_dwordx4 v2, s[4:7], s44 offen lds
    s_add_u32 m0, s47, 84992
    s_add_u32 s44, s42, 245760
    buffer_load_dwordx4 v3, s[4:7], s44 offen lds
    s_add_u32 m0, s47, 86016
    s_add_u32 s44, s42, 262144
    buffer_load_dwordx4 v2, s[4:7], s44 offen lds
    s_add_u32 m0, s47, 87040
    s_add_u32 s44, s42, 278528
    buffer_load_dwordx4 v3, s[4:7], s44 offen lds
    s_add_u32 s43, s43, 1
    s_and_b32 s43, s43, 15
    s_waitcnt vmcnt(18)
    s_barrier
    s_lshl_b32 s42, s43, 7
    s_add_u32 s42, s42, s46
    s_add_u32 m0, s47, 0
    s_add_u32 s44, s42, 0
    buffer_load_dwordx4 v2, s[4:7], s44 offen lds
    s_add_u32 m0, s47, 1024
    s_add_u32 s44, s42, 16384
    buffer_load_dwordx4 v3, s[4:7], s44 offen lds
    s_add_u32 m0, s47, 2048
    s_add_u32 s44, s42, 32768
    buffer_load_dwordx4 v2, s[4:7], s44 offen lds
    s_add_u32 m0, s47, 3072
    s_add_u32 s44, s42, 49152
    buffer_load_dwordx4 v3, s[4:7], s44 offen lds
    s_add_u32 m0, s47, 4096
    s_add_u32 s44, s42, 65536
    buffer_load_dwordx4 v2, s[4:7], s44 offen lds
    s_add_u32 m0, s47, 5120
    s_add_u32 s44, s42, 81920
    buffer_load_dwordx4 v3, s[4:7], s44 offen lds
    s_add_u32 m0, s47, 6144
    s_add_u32 s44, s42, 98304
    buffer_load_dwordx4 v2, s[4:7], s44 offen lds
    s_add_u32 m0, s47, 7168
    s_add_u32 s44, s42, 114688
    buffer_load_dwordx4 v3, s[4:7], s44 offen lds
    s_add_u32 m0, s47, 8192
    s_add_u32 s44, s42, 131072
    buffer_load_dwordx4 v2, s[4:7], s44 offen lds
    s_add_u32 m0, s47, 9216
    s_add_u32 s44, s42, 147456
    buffer_load_dwordx4 v3, s[4:7], s44 offen lds
    s_add_u32 m0, s47, 10240
    s_add_u32 s44, s42, 163840
    buffer_load_dwordx4 v2, s[4:7], s44 offen lds
    s_add_u32 m0, s47, 11264
    s_add_u32 s44, s42, 180224
    buffer_load_dwordx4 v3, s[4:7], s44 offen lds
    s_add_u32 m0, s47, 12288
    s_add_u32 s44, s42, 196608
    buffer_load_dwordx4 v2, s[4:7], s44 offen lds
    s_add_u32 m0, s47, 13312
    s_add_u32 s44, s42, 212992
    buffer_load_dwordx4 v3, s[4:7], s44 offen lds
    s_add_u32 m0, s47, 14336
    s_add_u32 s44, s42, 229376
    buffer_load_dwordx4 v2, s[4:7], s44 offen lds
    s_add_u32 m0, s47, 15360
    s_add_u32 s44, s42, 245760
    buffer_load_dwordx4 v3, s[4:7], s44 offen lds
    s_add_u32 m0, s47, 16384
    s_add_u32 s44, s42, 262144
    buffer_load_dwordx4 v2, s[4:7], s44 offen lds
    s_add_u32 m0, s47, 17408
    s_add_u32 s44, s42, 278528
    buffer_load_dwordx4 v3, s[4:7], s44 offen lds
    s_add_u32 s43, s43, 1
    s_and_b32 s43, s43, 15
    s_waitcnt vmcnt(18)
    s_barrier
    s_mov_b32 s43, s31
    s_mul_i32 s42, s43, 524288
    s_lshl_b32 s46, s43, 7
    s_mov_b32 m0, 53248
    s_add_u32 s44, s42, 0
    buffer_load_dwordx4 v10, s[8:11], s44 offen lds
    s_mov_b32 m0, 54272
    s_add_u32 s44, s42, 32768
    buffer_load_dwordx4 v10, s[8:11], s44 offen lds
    s_mov_b32 m0, 55296
    s_add_u32 s44, s42, 65536
    buffer_load_dwordx4 v11, s[8:11], s44 offen lds
    s_mov_b32 m0, 56320
    s_add_u32 s44, s42, 98304
    buffer_load_dwordx4 v11, s[8:11], s44 offen lds
    s_mov_b32 m0, 57344
    s_add_u32 s44, s42, 131072
    buffer_load_dwordx4 v10, s[8:11], s44 offen lds
    s_mov_b32 m0, 58368
    s_add_u32 s44, s42, 163840
    buffer_load_dwordx4 v10, s[8:11], s44 offen lds
    s_mov_b32 m0, 59392
    s_add_u32 s44, s42, 196608
    buffer_load_dwordx4 v11, s[8:11], s44 offen lds
    s_mov_b32 m0, 60416
    s_add_u32 s44, s42, 229376
    buffer_load_dwordx4 v11, s[8:11], s44 offen lds
    s_mov_b32 m0, 61440
    s_add_u32 s44, s42, 262144
    buffer_load_dwordx4 v10, s[8:11], s44 offen lds
    s_mov_b32 m0, 62464
    s_add_u32 s44, s42, 294912
    buffer_load_dwordx4 v10, s[8:11], s44 offen lds
    s_mov_b32 m0, 63488
    s_add_u32 s44, s42, 327680
    buffer_load_dwordx4 v11, s[8:11], s44 offen lds
    s_mov_b32 m0, 64512
    s_add_u32 s44, s42, 360448
    buffer_load_dwordx4 v11, s[8:11], s44 offen lds
    s_mov_b32 m0, 65536
    s_add_u32 s44, s42, 393216
    buffer_load_dwordx4 v10, s[8:11], s44 offen lds
    s_mov_b32 m0, 66560
    s_add_u32 s44, s42, 425984
    buffer_load_dwordx4 v10, s[8:11], s44 offen lds
    s_mov_b32 m0, 67584
    s_add_u32 s44, s42, 458752
    buffer_load_dwordx4 v11, s[8:11], s44 offen lds
    s_mov_b32 m0, 68608
    s_add_u32 s44, s42, 491520
    buffer_load_dwordx4 v11, s[8:11], s44 offen lds
    s_mov_b32 m0, 34816
    s_add_u32 s44, s46, 0
    buffer_load_dwordx4 v2, s[4:7], s44 offen lds
    s_mov_b32 m0, 35840
    s_add_u32 s44, s46, 16384
    buffer_load_dwordx4 v3, s[4:7], s44 offen lds
    s_mov_b32 m0, 36864
    s_add_u32 s44, s46, 32768
    buffer_load_dwordx4 v2, s[4:7], s44 offen lds
    s_mov_b32 m0, 37888
    s_add_u32 s44, s46, 49152
    buffer_load_dwordx4 v3, s[4:7], s44 offen lds
    s_mov_b32 m0, 38912
    s_add_u32 s44, s46, 65536
    buffer_load_dwordx4 v2, s[4:7], s44 offen lds
    s_mov_b32 m0, 39936
    s_add_u32 s44, s46, 81920
    buffer_load_dwordx4 v3, s[4:7], s44 offen lds
    s_mov_b32 m0, 40960
    s_add_u32 s44, s46, 98304
    buffer_load_dwordx4 v2, s[4:7], s44 offen lds
    s_mov_b32 m0, 41984
    s_add_u32 s44, s46, 114688
    buffer_load_dwordx4 v3, s[4:7], s44 offen lds
    s_mov_b32 m0, 43008
    s_add_u32 s44, s46, 131072
    buffer_load_dwordx4 v2, s[4:7], s44 offen lds
    s_mov_b32 m0, 44032
    s_add_u32 s44, s46, 147456
    buffer_load_dwordx4 v3, s[4:7], s44 offen lds
    s_mov_b32 m0, 45056
    s_add_u32 s44, s46, 163840
    buffer_load_dwordx4 v2, s[4:7], s44 offen lds
    s_mov_b32 m0, 46080
    s_add_u32 s44, s46, 180224
    buffer_load_dwordx4 v3, s[4:7], s44 offen lds
    s_mov_b32 m0, 47104
    s_add_u32 s44, s46, 196608
    buffer_load_dwordx4 v2, s[4:7], s44 offen lds
    s_mov_b32 m0, 48128
    s_add_u32 s44, s46, 212992
    buffer_load_dwordx4 v3, s[4:7], s44 offen lds
    s_mov_b32 m0, 49152
    s_add_u32 s44, s46, 229376
    buffer_load_dwordx4 v2, s[4:7], s44 offen lds
    s_mov_b32 m0, 50176
    s_add_u32 s44, s46, 245760
    buffer_load_dwordx4 v3, s[4:7], s44 offen lds
    s_mov_b32 m0, 51200
    s_add_u32 s44, s46, 262144
    buffer_load_dwordx4 v2, s[4:7], s44 offen lds
    s_mov_b32 m0, 52224
    s_add_u32 s44, s46, 278528
    buffer_load_dwordx4 v3, s[4:7], s44 offen lds
    s_add_u32 s43, s43, 1
    s_and_b32 s43, s43, 15
    s_waitcnt vmcnt(34)
    s_barrier
    s_barrier
    s_mul_i32 s42, s43, 524288
    s_lshl_b32 s46, s43, 7
    s_mov_b32 m0, 18432
    s_add_u32 s44, s42, 0
    buffer_load_dwordx4 v10, s[8:11], s44 offen lds
    s_mov_b32 m0, 19456
    s_add_u32 s44, s42, 32768
    buffer_load_dwordx4 v10, s[8:11], s44 offen lds
    s_mov_b32 m0, 20480
    s_add_u32 s44, s42, 65536
    buffer_load_dwordx4 v11, s[8:11], s44 offen lds
    s_mov_b32 m0, 21504
    s_add_u32 s44, s42, 98304
    buffer_load_dwordx4 v11, s[8:11], s44 offen lds
    s_mov_b32 m0, 22528
    s_add_u32 s44, s42, 131072
    buffer_load_dwordx4 v10, s[8:11], s44 offen lds
    s_mov_b32 m0, 23552
    s_add_u32 s44, s42, 163840
    buffer_load_dwordx4 v10, s[8:11], s44 offen lds
    s_mov_b32 m0, 24576
    s_add_u32 s44, s42, 196608
    buffer_load_dwordx4 v11, s[8:11], s44 offen lds
    s_mov_b32 m0, 25600
    s_add_u32 s44, s42, 229376
    buffer_load_dwordx4 v11, s[8:11], s44 offen lds
    s_mov_b32 m0, 26624
    s_add_u32 s44, s42, 262144
    buffer_load_dwordx4 v10, s[8:11], s44 offen lds
    s_mov_b32 m0, 27648
    s_add_u32 s44, s42, 294912
    buffer_load_dwordx4 v10, s[8:11], s44 offen lds
    s_mov_b32 m0, 28672
    s_add_u32 s44, s42, 327680
    buffer_load_dwordx4 v11, s[8:11], s44 offen lds
    s_mov_b32 m0, 29696
    s_add_u32 s44, s42, 360448
    buffer_load_dwordx4 v11, s[8:11], s44 offen lds
    s_mov_b32 m0, 30720
    s_add_u32 s44, s42, 393216
    buffer_load_dwordx4 v10, s[8:11], s44 offen lds
    s_mov_b32 m0, 31744
    s_add_u32 s44, s42, 425984
    buffer_load_dwordx4 v10, s[8:11], s44 offen lds
    s_mov_b32 m0, 32768
    s_add_u32 s44, s42, 458752
    buffer_load_dwordx4 v11, s[8:11], s44 offen lds
    s_mov_b32 m0, 33792
    s_add_u32 s44, s42, 491520
    buffer_load_dwordx4 v11, s[8:11], s44 offen lds
    s_mov_b32 m0, 0
    s_add_u32 s44, s46, 0
    buffer_load_dwordx4 v2, s[4:7], s44 offen lds
    s_mov_b32 m0, 1024
    s_add_u32 s44, s46, 16384
    buffer_load_dwordx4 v3, s[4:7], s44 offen lds
    s_mov_b32 m0, 2048
    s_add_u32 s44, s46, 32768
    buffer_load_dwordx4 v2, s[4:7], s44 offen lds
    s_mov_b32 m0, 3072
    s_add_u32 s44, s46, 49152
    buffer_load_dwordx4 v3, s[4:7], s44 offen lds
    s_mov_b32 m0, 4096
    s_add_u32 s44, s46, 65536
    buffer_load_dwordx4 v2, s[4:7], s44 offen lds
    s_mov_b32 m0, 5120
    s_add_u32 s44, s46, 81920
    buffer_load_dwordx4 v3, s[4:7], s44 offen lds
    s_mov_b32 m0, 6144
    s_add_u32 s44, s46, 98304
    buffer_load_dwordx4 v2, s[4:7], s44 offen lds
    s_mov_b32 m0, 7168
    s_add_u32 s44, s46, 114688
    buffer_load_dwordx4 v3, s[4:7], s44 offen lds
    s_mov_b32 m0, 8192
    s_add_u32 s44, s46, 131072
    buffer_load_dwordx4 v2, s[4:7], s44 offen lds
    s_mov_b32 m0, 9216
    s_add_u32 s44, s46, 147456
    buffer_load_dwordx4 v3, s[4:7], s44 offen lds
    s_mov_b32 m0, 10240
    s_add_u32 s44, s46, 163840
    buffer_load_dwordx4 v2, s[4:7], s44 offen lds
    s_mov_b32 m0, 11264
    s_add_u32 s44, s46, 180224
    buffer_load_dwordx4 v3, s[4:7], s44 offen lds
    s_mov_b32 m0, 12288
    s_add_u32 s44, s46, 196608
    buffer_load_dwordx4 v2, s[4:7], s44 offen lds
    s_mov_b32 m0, 13312
    s_add_u32 s44, s46, 212992
    buffer_load_dwordx4 v3, s[4:7], s44 offen lds
    s_mov_b32 m0, 14336
    s_add_u32 s44, s46, 229376
    buffer_load_dwordx4 v2, s[4:7], s44 offen lds
    s_mov_b32 m0, 15360
    s_add_u32 s44, s46, 245760
    buffer_load_dwordx4 v3, s[4:7], s44 offen lds
    s_mov_b32 m0, 16384
    s_add_u32 s44, s46, 262144
    buffer_load_dwordx4 v2, s[4:7], s44 offen lds
    s_mov_b32 m0, 17408
    s_add_u32 s44, s46, 278528
    buffer_load_dwordx4 v3, s[4:7], s44 offen lds
    s_add_u32 s43, s43, 1
    s_and_b32 s43, s43, 15
    s_waitcnt vmcnt(34)
    s_barrier
    s_mov_b32 s49, 0
L_h1loop_4:
    ds_read_b128 v[124:127], v212 offset:34816
    ds_read_b128 v[128:131], v212 offset:36864
    ds_read_b128 v[132:135], v212 offset:38912
    ds_read_b64_tr_b16 v[148:149], v214 offset:34816
    ds_read_b64_tr_b16 v[150:151], v214 offset:35840
    ds_read_b64_tr_b16 v[152:153], v215 offset:34816
    ds_read_b64_tr_b16 v[154:155], v215 offset:35840
    ds_read_b64_tr_b16 v[156:157], v216 offset:34816
    ds_read_b64_tr_b16 v[158:159], v216 offset:35840
    ds_read_b64_tr_b16 v[160:161], v217 offset:34816
    ds_read_b64_tr_b16 v[162:163], v217 offset:35840
    ds_read_b64_tr_b16 v[164:165], v218 offset:34816
    ds_read_b64_tr_b16 v[166:167], v218 offset:35840
    ds_read_b64_tr_b16 v[168:169], v219 offset:34816
    ds_read_b64_tr_b16 v[170:171], v219 offset:35840
    ds_read_b64_tr_b16 v[172:173], v220 offset:34816
    ds_read_b64_tr_b16 v[174:175], v220 offset:35840
    ds_read_b64_tr_b16 v[176:177], v221 offset:34816
    ds_read_b64_tr_b16 v[178:179], v221 offset:35840
    ds_read_b128 v[136:139], v213 offset:34816
    ds_read_b128 v[140:143], v213 offset:36864
    ds_read_b128 v[144:147], v213 offset:38912
    ds_read_b64_tr_b16 v[180:181], v214 offset:43008
    ds_read_b64_tr_b16 v[182:183], v214 offset:44032
    ds_read_b64_tr_b16 v[184:185], v215 offset:43008
    ds_read_b64_tr_b16 v[186:187], v215 offset:44032
    ds_read_b64_tr_b16 v[188:189], v216 offset:43008
    ds_read_b64_tr_b16 v[190:191], v216 offset:44032
    ds_read_b64_tr_b16 v[192:193], v217 offset:43008
    ds_read_b64_tr_b16 v[194:195], v217 offset:44032
    ds_read_b64_tr_b16 v[196:197], v218 offset:43008
    ds_read_b64_tr_b16 v[198:199], v218 offset:44032
    ds_read_b64_tr_b16 v[200:201], v219 offset:43008
    ds_read_b64_tr_b16 v[202:203], v219 offset:44032
    ds_read_b64_tr_b16 v[204:205], v220 offset:43008
    ds_read_b64_tr_b16 v[206:207], v220 offset:44032
    ds_read_b64_tr_b16 v[208:209], v221 offset:43008
    ds_read_b64_tr_b16 v[210:211], v221 offset:44032
    s_waitcnt lgkmcnt(15)
    v_mfma_f32_16x16x32_bf16 v[28:31], v[148:151], v[124:127], v[28:31]
    v_mfma_f32_16x16x32_bf16 v[60:63], v[148:151], v[128:131], v[60:63]
    v_mfma_f32_16x16x32_bf16 v[92:95], v[148:151], v[132:135], v[92:95]
    v_mfma_f32_16x16x32_bf16 v[32:35], v[152:155], v[124:127], v[32:35]
    v_mfma_f32_16x16x32_bf16 v[64:67], v[152:155], v[128:131], v[64:67]
    v_mfma_f32_16x16x32_bf16 v[96:99], v[152:155], v[132:135], v[96:99]
    v_mfma_f32_16x16x32_bf16 v[36:39], v[156:159], v[124:127], v[36:39]
    v_mfma_f32_16x16x32_bf16 v[68:71], v[156:159], v[128:131], v[68:71]
    v_mfma_f32_16x16x32_bf16 v[100:103], v[156:159], v[132:135], v[100:103]
    v_mfma_f32_16x16x32_bf16 v[40:43], v[160:163], v[124:127], v[40:43]
    v_mfma_f32_16x16x32_bf16 v[72:75], v[160:163], v[128:131], v[72:75]
    v_mfma_f32_16x16x32_bf16 v[104:107], v[160:163], v[132:135], v[104:107]
    v_mfma_f32_16x16x32_bf16 v[44:47], v[164:167], v[124:127], v[44:47]
    v_mfma_f32_16x16x32_bf16 v[76:79], v[164:167], v[128:131], v[76:79]
    v_mfma_f32_16x16x32_bf16 v[108:111], v[164:167], v[132:135], v[108:111]
    v_mfma_f32_16x16x32_bf16 v[48:51], v[168:171], v[124:127], v[48:51]
    v_mfma_f32_16x16x32_bf16 v[80:83], v[168:171], v[128:131], v[80:83]
    v_mfma_f32_16x16x32_bf16 v[112:115], v[168:171], v[132:135], v[112:115]
    v_mfma_f32_16x16x32_bf16 v[52:55], v[172:175], v[124:127], v[52:55]
    v_mfma_f32_16x16x32_bf16 v[84:87], v[172:175], v[128:131], v[84:87]
    v_mfma_f32_16x16x32_bf16 v[116:119], v[172:175], v[132:135], v[116:119]
    v_mfma_f32_16x16x32_bf16 v[56:59], v[176:179], v[124:127], v[56:59]
    v_mfma_f32_16x16x32_bf16 v[88:91], v[176:179], v[128:131], v[88:91]
    v_mfma_f32_16x16x32_bf16 v[120:123], v[176:179], v[132:135], v[120:123]
    s_waitcnt lgkmcnt(0)
    s_barrier
    v_mfma_f32_16x16x32_bf16 v[28:31], v[180:183], v[136:139], v[28:31]
    s_mul_i32 s42, s43, 524288
    s_lshl_b32 s46, s43, 7
    s_mov_b32 m0, 53248
    s_add_u32 s44, s42, 0
    buffer_load_dwordx4 v10, s[8:11], s44 offen lds
    s_mov_b32 m0, 54272
    s_add_u32 s44, s42, 32768
    buffer_load_dwordx4 v10, s[8:11], s44 offen lds
    v_mfma_f32_16x16x32_bf16 v[60:63], v[180:183], v[140:143], v[60:63]
    s_mov_b32 m0, 55296
    s_add_u32 s44, s42, 65536
    buffer_load_dwordx4 v11, s[8:11], s44 offen lds
    v_mfma_f32_16x16x32_bf16 v[92:95], v[180:183], v[144:147], v[92:95]
    s_mov_b32 m0, 56320
    s_add_u32 s44, s42, 98304
    buffer_load_dwordx4 v11, s[8:11], s44 offen lds
    s_mov_b32 m0, 57344
    s_add_u32 s44, s42, 131072
    buffer_load_dwordx4 v10, s[8:11], s44 offen lds
    v_mfma_f32_16x16x32_bf16 v[32:35], v[184:187], v[136:139], v[32:35]
    s_mov_b32 m0, 58368
    s_add_u32 s44, s42, 163840
    buffer_load_dwordx4 v10, s[8:11], s44 offen lds
    v_mfma_f32_16x16x32_bf16 v[64:67], v[184:187], v[140:143], v[64:67]
    s_mov_b32 m0, 59392
    s_add_u32 s44, s42, 196608
    buffer_load_dwordx4 v11, s[8:11], s44 offen lds
    s_mov_b32 m0, 60416
    s_add_u32 s44, s42, 229376
    buffer_load_dwordx4 v11, s[8:11], s44 offen lds
    v_mfma_f32_16x16x32_bf16 v[96:99], v[184:187], v[144:147], v[96:99]
    s_mov_b32 m0, 61440
    s_add_u32 s44, s42, 262144
    buffer_load_dwordx4 v10, s[8:11], s44 offen lds
    v_mfma_f32_16x16x32_bf16 v[36:39], v[188:191], v[136:139], v[36:39]
    s_mov_b32 m0, 62464
    s_add_u32 s44, s42, 294912
    buffer_load_dwordx4 v10, s[8:11], s44 offen lds
    v_mfma_f32_16x16x32_bf16 v[68:71], v[188:191], v[140:143], v[68:71]
    s_mov_b32 m0, 63488
    s_add_u32 s44, s42, 327680
    buffer_load_dwordx4 v11, s[8:11], s44 offen lds
    s_mov_b32 m0, 64512
    s_add_u32 s44, s42, 360448
    buffer_load_dwordx4 v11, s[8:11], s44 offen lds
    v_mfma_f32_16x16x32_bf16 v[100:103], v[188:191], v[144:147], v[100:103]
    s_mov_b32 m0, 65536
    s_add_u32 s44, s42, 393216
    buffer_load_dwordx4 v10, s[8:11], s44 offen lds
    v_mfma_f32_16x16x32_bf16 v[40:43], v[192:195], v[136:139], v[40:43]
    s_mov_b32 m0, 66560
    s_add_u32 s44, s42, 425984
    buffer_load_dwordx4 v10, s[8:11], s44 offen lds
    s_mov_b32 m0, 67584
    s_add_u32 s44, s42, 458752
    buffer_load_dwordx4 v11, s[8:11], s44 offen lds
    v_mfma_f32_16x16x32_bf16 v[72:75], v[192:195], v[140:143], v[72:75]
    s_mov_b32 m0, 68608
    s_add_u32 s44, s42, 491520
    buffer_load_dwordx4 v11, s[8:11], s44 offen lds
    v_mfma_f32_16x16x32_bf16 v[104:107], v[192:195], v[144:147], v[104:107]
    s_mov_b32 m0, 34816
    s_add_u32 s44, s46, 0
    buffer_load_dwordx4 v2, s[4:7], s44 offen lds
    v_mfma_f32_16x16x32_bf16 v[44:47], v[196:199], v[136:139], v[44:47]
    s_mov_b32 m0, 35840
    s_add_u32 s44, s46, 16384
    buffer_load_dwordx4 v3, s[4:7], s44 offen lds
    s_mov_b32 m0, 36864
    s_add_u32 s44, s46, 32768
    buffer_load_dwordx4 v2, s[4:7], s44 offen lds
    v_mfma_f32_16x16x32_bf16 v[76:79], v[196:199], v[140:143], v[76:79]
    s_mov_b32 m0, 37888
    s_add_u32 s44, s46, 49152
    buffer_load_dwordx4 v3, s[4:7], s44 offen lds
    v_mfma_f32_16x16x32_bf16 v[108:111], v[196:199], v[144:147], v[108:111]
    s_mov_b32 m0, 38912
    s_add_u32 s44, s46, 65536
    buffer_load_dwordx4 v2, s[4:7], s44 offen lds
    s_mov_b32 m0, 39936
    s_add_u32 s44, s46, 81920
    buffer_load_dwordx4 v3, s[4:7], s44 offen lds
    v_mfma_f32_16x16x32_bf16 v[48:51], v[200:203], v[136:139], v[48:51]
    s_mov_b32 m0, 40960
    s_add_u32 s44, s46, 98304
    buffer_load_dwordx4 v2, s[4:7], s44 offen lds
    v_mfma_f32_16x16x32_bf16 v[80:83], v[200:203], v[140:143], v[80:83]
    s_mov_b32 m0, 41984
    s_add_u32 s44, s46, 114688
    buffer_load_dwordx4 v3, s[4:7], s44 offen lds
    s_mov_b32 m0, 43008
    s_add_u32 s44, s46, 131072
    buffer_load_dwordx4 v2, s[4:7], s44 offen lds
    v_mfma_f32_16x16x32_bf16 v[112:115], v[200:203], v[144:147], v[112:115]
    s_mov_b32 m0, 44032
    s_add_u32 s44, s46, 147456
    buffer_load_dwordx4 v3, s[4:7], s44 offen lds
    v_mfma_f32_16x16x32_bf16 v[52:55], v[204:207], v[136:139], v[52:55]
    s_mov_b32 m0, 45056
    s_add_u32 s44, s46, 163840
    buffer_load_dwordx4 v2, s[4:7], s44 offen lds
    v_mfma_f32_16x16x32_bf16 v[84:87], v[204:207], v[140:143], v[84:87]
    s_mov_b32 m0, 46080
    s_add_u32 s44, s46, 180224
    buffer_load_dwordx4 v3, s[4:7], s44 offen lds
    s_mov_b32 m0, 47104
    s_add_u32 s44, s46, 196608
    buffer_load_dwordx4 v2, s[4:7], s44 offen lds
    v_mfma_f32_16x16x32_bf16 v[116:119], v[204:207], v[144:147], v[116:119]
    s_mov_b32 m0, 48128
    s_add_u32 s44, s46, 212992
    buffer_load_dwordx4 v3, s[4:7], s44 offen lds
    v_mfma_f32_16x16x32_bf16 v[56:59], v[208:211], v[136:139], v[56:59]
    s_mov_b32 m0, 49152
    s_add_u32 s44, s46, 229376
    buffer_load_dwordx4 v2, s[4:7], s44 offen lds
    s_mov_b32 m0, 50176
    s_add_u32 s44, s46, 245760
    buffer_load_dwordx4 v3, s[4:7], s44 offen lds
    v_mfma_f32_16x16x32_bf16 v[88:91], v[208:211], v[140:143], v[88:91]
    s_mov_b32 m0, 51200
    s_add_u32 s44, s46, 262144
    buffer_load_dwordx4 v2, s[4:7], s44 offen lds
    v_mfma_f32_16x16x32_bf16 v[120:123], v[208:211], v[144:147], v[120:123]
    s_mov_b32 m0, 52224
    s_add_u32 s44, s46, 278528
    buffer_load_dwordx4 v3, s[4:7], s44 offen lds
    s_add_u32 s43, s43, 1
    s_and_b32 s43, s43, 15
    s_waitcnt vmcnt(34)
    s_barrier
    ds_read_b128 v[124:127], v212 offset:0
    ds_read_b128 v[128:131], v212 offset:2048
    ds_read_b128 v[132:135], v212 offset:4096
    ds_read_b64_tr_b16 v[148:149], v214 offset:0
    ds_read_b64_tr_b16 v[150:151], v214 offset:1024
    ds_read_b64_tr_b16 v[152:153], v215 offset:0
    ds_read_b64_tr_b16 v[154:155], v215 offset:1024
    ds_read_b64_tr_b16 v[156:157], v216 offset:0
    ds_read_b64_tr_b16 v[158:159], v216 offset:1024
    ds_read_b64_tr_b16 v[160:161], v217 offset:0
    ds_read_b64_tr_b16 v[162:163], v217 offset:1024
    ds_read_b64_tr_b16 v[164:165], v218 offset:0
    ds_read_b64_tr_b16 v[166:167], v218 offset:1024
    ds_read_b64_tr_b16 v[168:169], v219 offset:0
    ds_read_b64_tr_b16 v[170:171], v219 offset:1024
    ds_read_b64_tr_b16 v[172:173], v220 offset:0
    ds_read_b64_tr_b16 v[174:175], v220 offset:1024
    ds_read_b64_tr_b16 v[176:177], v221 offset:0
    ds_read_b64_tr_b16 v[178:179], v221 offset:1024
    ds_read_b128 v[136:139], v213 offset:0
    ds_read_b128 v[140:143], v213 offset:2048
    ds_read_b128 v[144:147], v213 offset:4096
    ds_read_b64_tr_b16 v[180:181], v214 offset:8192
    ds_read_b64_tr_b16 v[182:183], v214 offset:9216
    ds_read_b64_tr_b16 v[184:185], v215 offset:8192
    ds_read_b64_tr_b16 v[186:187], v215 offset:9216
    ds_read_b64_tr_b16 v[188:189], v216 offset:8192
    ds_read_b64_tr_b16 v[190:191], v216 offset:9216
    ds_read_b64_tr_b16 v[192:193], v217 offset:8192
    ds_read_b64_tr_b16 v[194:195], v217 offset:9216
    ds_read_b64_tr_b16 v[196:197], v218 offset:8192
    ds_read_b64_tr_b16 v[198:199], v218 offset:9216
    ds_read_b64_tr_b16 v[200:201], v219 offset:8192
    ds_read_b64_tr_b16 v[202:203], v219 offset:9216
    ds_read_b64_tr_b16 v[204:205], v220 offset:8192
    ds_read_b64_tr_b16 v[206:207], v220 offset:9216
    ds_read_b64_tr_b16 v[208:209], v221 offset:8192
    ds_read_b64_tr_b16 v[210:211], v221 offset:9216
    s_waitcnt lgkmcnt(15)
    v_mfma_f32_16x16x32_bf16 v[28:31], v[148:151], v[124:127], v[28:31]
    v_mfma_f32_16x16x32_bf16 v[60:63], v[148:151], v[128:131], v[60:63]
    v_mfma_f32_16x16x32_bf16 v[92:95], v[148:151], v[132:135], v[92:95]
    v_mfma_f32_16x16x32_bf16 v[32:35], v[152:155], v[124:127], v[32:35]
    v_mfma_f32_16x16x32_bf16 v[64:67], v[152:155], v[128:131], v[64:67]
    v_mfma_f32_16x16x32_bf16 v[96:99], v[152:155], v[132:135], v[96:99]
    v_mfma_f32_16x16x32_bf16 v[36:39], v[156:159], v[124:127], v[36:39]
    v_mfma_f32_16x16x32_bf16 v[68:71], v[156:159], v[128:131], v[68:71]
    v_mfma_f32_16x16x32_bf16 v[100:103], v[156:159], v[132:135], v[100:103]
    v_mfma_f32_16x16x32_bf16 v[40:43], v[160:163], v[124:127], v[40:43]
    v_mfma_f32_16x16x32_bf16 v[72:75], v[160:163], v[128:131], v[72:75]
    v_mfma_f32_16x16x32_bf16 v[104:107], v[160:163], v[132:135], v[104:107]
    v_mfma_f32_16x16x32_bf16 v[44:47], v[164:167], v[124:127], v[44:47]
    v_mfma_f32_16x16x32_bf16 v[76:79], v[164:167], v[128:131], v[76:79]
    v_mfma_f32_16x16x32_bf16 v[108:111], v[164:167], v[132:135], v[108:111]
    v_mfma_f32_16x16x32_bf16 v[48:51], v[168:171], v[124:127], v[48:51]
    v_mfma_f32_16x16x32_bf16 v[80:83], v[168:171], v[128:131], v[80:83]
    v_mfma_f32_16x16x32_bf16 v[112:115], v[168:171], v[132:135], v[112:115]
    v_mfma_f32_16x16x32_bf16 v[52:55], v[172:175], v[124:127], v[52:55]
    v_mfma_f32_16x16x32_bf16 v[84:87], v[172:175], v[128:131], v[84:87]
    v_mfma_f32_16x16x32_bf16 v[116:119], v[172:175], v[132:135], v[116:119]
    v_mfma_f32_16x16x32_bf16 v[56:59], v[176:179], v[124:127], v[56:59]
    v_mfma_f32_16x16x32_bf16 v[88:91], v[176:179], v[128:131], v[88:91]
    v_mfma_f32_16x16x32_bf16 v[120:123], v[176:179], v[132:135], v[120:123]
    s_waitcnt lgkmcnt(0)
    s_barrier
    v_mfma_f32_16x16x32_bf16 v[28:31], v[180:183], v[136:139], v[28:31]
    s_mul_i32 s42, s43, 524288
    s_lshl_b32 s46, s43, 7
    s_mov_b32 m0, 18432
    s_add_u32 s44, s42, 0
    buffer_load_dwordx4 v10, s[8:11], s44 offen lds
    s_mov_b32 m0, 19456
    s_add_u32 s44, s42, 32768
    buffer_load_dwordx4 v10, s[8:11], s44 offen lds
    v_mfma_f32_16x16x32_bf16 v[60:63], v[180:183], v[140:143], v[60:63]
    s_mov_b32 m0, 20480
    s_add_u32 s44, s42, 65536
    buffer_load_dwordx4 v11, s[8:11], s44 offen lds
    v_mfma_f32_16x16x32_bf16 v[92:95], v[180:183], v[144:147], v[92:95]
    s_mov_b32 m0, 21504
    s_add_u32 s44, s42, 98304
    buffer_load_dwordx4 v11, s[8:11], s44 offen lds
    s_mov_b32 m0, 22528
    s_add_u32 s44, s42, 131072
    buffer_load_dwordx4 v10, s[8:11], s44 offen lds
    v_mfma_f32_16x16x32_bf16 v[32:35], v[184:187], v[136:139], v[32:35]
    s_mov_b32 m0, 23552
    s_add_u32 s44, s42, 163840
    buffer_load_dwordx4 v10, s[8:11], s44 offen lds
    v_mfma_f32_16x16x32_bf16 v[64:67], v[184:187], v[140:143], v[64:67]
    s_mov_b32 m0, 24576
    s_add_u32 s44, s42, 196608
    buffer_load_dwordx4 v11, s[8:11], s44 offen lds
    s_mov_b32 m0, 25600
    s_add_u32 s44, s42, 229376
    buffer_load_dwordx4 v11, s[8:11], s44 offen lds
    v_mfma_f32_16x16x32_bf16 v[96:99], v[184:187], v[144:147], v[96:99]
    s_mov_b32 m0, 26624
    s_add_u32 s44, s42, 262144
    buffer_load_dwordx4 v10, s[8:11], s44 offen lds
    v_mfma_f32_16x16x32_bf16 v[36:39], v[188:191], v[136:139], v[36:39]
    s_mov_b32 m0, 27648
    s_add_u32 s44, s42, 294912
    buffer_load_dwordx4 v10, s[8:11], s44 offen lds
    v_mfma_f32_16x16x32_bf16 v[68:71], v[188:191], v[140:143], v[68:71]
    s_mov_b32 m0, 28672
    s_add_u32 s44, s42, 327680
    buffer_load_dwordx4 v11, s[8:11], s44 offen lds
    s_mov_b32 m0, 29696
    s_add_u32 s44, s42, 360448
    buffer_load_dwordx4 v11, s[8:11], s44 offen lds
    v_mfma_f32_16x16x32_bf16 v[100:103], v[188:191], v[144:147], v[100:103]
    s_mov_b32 m0, 30720
    s_add_u32 s44, s42, 393216
    buffer_load_dwordx4 v10, s[8:11], s44 offen lds
    v_mfma_f32_16x16x32_bf16 v[40:43], v[192:195], v[136:139], v[40:43]
    s_mov_b32 m0, 31744
    s_add_u32 s44, s42, 425984
    buffer_load_dwordx4 v10, s[8:11], s44 offen lds
    s_mov_b32 m0, 32768
    s_add_u32 s44, s42, 458752
    buffer_load_dwordx4 v11, s[8:11], s44 offen lds
    v_mfma_f32_16x16x32_bf16 v[72:75], v[192:195], v[140:143], v[72:75]
    s_mov_b32 m0, 33792
    s_add_u32 s44, s42, 491520
    buffer_load_dwordx4 v11, s[8:11], s44 offen lds
    v_mfma_f32_16x16x32_bf16 v[104:107], v[192:195], v[144:147], v[104:107]
    s_mov_b32 m0, 0
    s_add_u32 s44, s46, 0
    buffer_load_dwordx4 v2, s[4:7], s44 offen lds
    v_mfma_f32_16x16x32_bf16 v[44:47], v[196:199], v[136:139], v[44:47]
    s_mov_b32 m0, 1024
    s_add_u32 s44, s46, 16384
    buffer_load_dwordx4 v3, s[4:7], s44 offen lds
    s_mov_b32 m0, 2048
    s_add_u32 s44, s46, 32768
    buffer_load_dwordx4 v2, s[4:7], s44 offen lds
    v_mfma_f32_16x16x32_bf16 v[76:79], v[196:199], v[140:143], v[76:79]
    s_mov_b32 m0, 3072
    s_add_u32 s44, s46, 49152
    buffer_load_dwordx4 v3, s[4:7], s44 offen lds
    v_mfma_f32_16x16x32_bf16 v[108:111], v[196:199], v[144:147], v[108:111]
    s_mov_b32 m0, 4096
    s_add_u32 s44, s46, 65536
    buffer_load_dwordx4 v2, s[4:7], s44 offen lds
    s_mov_b32 m0, 5120
    s_add_u32 s44, s46, 81920
    buffer_load_dwordx4 v3, s[4:7], s44 offen lds
    v_mfma_f32_16x16x32_bf16 v[48:51], v[200:203], v[136:139], v[48:51]
    s_mov_b32 m0, 6144
    s_add_u32 s44, s46, 98304
    buffer_load_dwordx4 v2, s[4:7], s44 offen lds
    v_mfma_f32_16x16x32_bf16 v[80:83], v[200:203], v[140:143], v[80:83]
    s_mov_b32 m0, 7168
    s_add_u32 s44, s46, 114688
    buffer_load_dwordx4 v3, s[4:7], s44 offen lds
    s_mov_b32 m0, 8192
    s_add_u32 s44, s46, 131072
    buffer_load_dwordx4 v2, s[4:7], s44 offen lds
    v_mfma_f32_16x16x32_bf16 v[112:115], v[200:203], v[144:147], v[112:115]
    s_mov_b32 m0, 9216
    s_add_u32 s44, s46, 147456
    buffer_load_dwordx4 v3, s[4:7], s44 offen lds
    v_mfma_f32_16x16x32_bf16 v[52:55], v[204:207], v[136:139], v[52:55]
    s_mov_b32 m0, 10240
    s_add_u32 s44, s46, 163840
    buffer_load_dwordx4 v2, s[4:7], s44 offen lds
    v_mfma_f32_16x16x32_bf16 v[84:87], v[204:207], v[140:143], v[84:87]
    s_mov_b32 m0, 11264
    s_add_u32 s44, s46, 180224
    buffer_load_dwordx4 v3, s[4:7], s44 offen lds
    s_mov_b32 m0, 12288
    s_add_u32 s44, s46, 196608
    buffer_load_dwordx4 v2, s[4:7], s44 offen lds
    v_mfma_f32_16x16x32_bf16 v[116:119], v[204:207], v[144:147], v[116:119]
    s_mov_b32 m0, 13312
    s_add_u32 s44, s46, 212992
    buffer_load_dwordx4 v3, s[4:7], s44 offen lds
    v_mfma_f32_16x16x32_bf16 v[56:59], v[208:211], v[136:139], v[56:59]
    s_mov_b32 m0, 14336
    s_add_u32 s44, s46, 229376
    buffer_load_dwordx4 v2, s[4:7], s44 offen lds
    s_mov_b32 m0, 15360
    s_add_u32 s44, s46, 245760
    buffer_load_dwordx4 v3, s[4:7], s44 offen lds
    v_mfma_f32_16x16x32_bf16 v[88:91], v[208:211], v[140:143], v[88:91]
    s_mov_b32 m0, 16384
    s_add_u32 s44, s46, 262144
    buffer_load_dwordx4 v2, s[4:7], s44 offen lds
    v_mfma_f32_16x16x32_bf16 v[120:123], v[208:211], v[144:147], v[120:123]
    s_mov_b32 m0, 17408
    s_add_u32 s44, s46, 278528
    buffer_load_dwordx4 v3, s[4:7], s44 offen lds
    s_add_u32 s43, s43, 1
    s_and_b32 s43, s43, 15
    s_waitcnt vmcnt(34)
    s_barrier
    s_add_u32 s49, s49, 1
    s_cmp_lt_u32 s49, 7
    s_cbranch_scc1 L_h1loop_4
    ds_read_b128 v[124:127], v212 offset:34816
    ds_read_b128 v[128:131], v212 offset:36864
    ds_read_b128 v[132:135], v212 offset:38912
    ds_read_b64_tr_b16 v[148:149], v214 offset:34816
    ds_read_b64_tr_b16 v[150:151], v214 offset:35840
    ds_read_b64_tr_b16 v[152:153], v215 offset:34816
    ds_read_b64_tr_b16 v[154:155], v215 offset:35840
    ds_read_b64_tr_b16 v[156:157], v216 offset:34816
    ds_read_b64_tr_b16 v[158:159], v216 offset:35840
    ds_read_b64_tr_b16 v[160:161], v217 offset:34816
    ds_read_b64_tr_b16 v[162:163], v217 offset:35840
    ds_read_b64_tr_b16 v[164:165], v218 offset:34816
    ds_read_b64_tr_b16 v[166:167], v218 offset:35840
    ds_read_b64_tr_b16 v[168:169], v219 offset:34816
    ds_read_b64_tr_b16 v[170:171], v219 offset:35840
    ds_read_b64_tr_b16 v[172:173], v220 offset:34816
    ds_read_b64_tr_b16 v[174:175], v220 offset:35840
    ds_read_b64_tr_b16 v[176:177], v221 offset:34816
    ds_read_b64_tr_b16 v[178:179], v221 offset:35840
    ds_read_b128 v[136:139], v213 offset:34816
    ds_read_b128 v[140:143], v213 offset:36864
    ds_read_b128 v[144:147], v213 offset:38912
    ds_read_b64_tr_b16 v[180:181], v214 offset:43008
    ds_read_b64_tr_b16 v[182:183], v214 offset:44032
    ds_read_b64_tr_b16 v[184:185], v215 offset:43008
    ds_read_b64_tr_b16 v[186:187], v215 offset:44032
    ds_read_b64_tr_b16 v[188:189], v216 offset:43008
    ds_read_b64_tr_b16 v[190:191], v216 offset:44032
    ds_read_b64_tr_b16 v[192:193], v217 offset:43008
    ds_read_b64_tr_b16 v[194:195], v217 offset:44032
    ds_read_b64_tr_b16 v[196:197], v218 offset:43008
    ds_read_b64_tr_b16 v[198:199], v218 offset:44032
    ds_read_b64_tr_b16 v[200:201], v219 offset:43008
    ds_read_b64_tr_b16 v[202:203], v219 offset:44032
    ds_read_b64_tr_b16 v[204:205], v220 offset:43008
    ds_read_b64_tr_b16 v[206:207], v220 offset:44032
    ds_read_b64_tr_b16 v[208:209], v221 offset:43008
    ds_read_b64_tr_b16 v[210:211], v221 offset:44032
    s_waitcnt lgkmcnt(15)
    v_mfma_f32_16x16x32_bf16 v[28:31], v[148:151], v[124:127], v[28:31]
    v_mfma_f32_16x16x32_bf16 v[60:63], v[148:151], v[128:131], v[60:63]
    v_mfma_f32_16x16x32_bf16 v[92:95], v[148:151], v[132:135], v[92:95]
    v_mfma_f32_16x16x32_bf16 v[32:35], v[152:155], v[124:127], v[32:35]
    v_mfma_f32_16x16x32_bf16 v[64:67], v[152:155], v[128:131], v[64:67]
    v_mfma_f32_16x16x32_bf16 v[96:99], v[152:155], v[132:135], v[96:99]
    v_mfma_f32_16x16x32_bf16 v[36:39], v[156:159], v[124:127], v[36:39]
    v_mfma_f32_16x16x32_bf16 v[68:71], v[156:159], v[128:131], v[68:71]
    v_mfma_f32_16x16x32_bf16 v[100:103], v[156:159], v[132:135], v[100:103]
    v_mfma_f32_16x16x32_bf16 v[40:43], v[160:163], v[124:127], v[40:43]
    v_mfma_f32_16x16x32_bf16 v[72:75], v[160:163], v[128:131], v[72:75]
    v_mfma_f32_16x16x32_bf16 v[104:107], v[160:163], v[132:135], v[104:107]
    v_mfma_f32_16x16x32_bf16 v[44:47], v[164:167], v[124:127], v[44:47]
    v_mfma_f32_16x16x32_bf16 v[76:79], v[164:167], v[128:131], v[76:79]
    v_mfma_f32_16x16x32_bf16 v[108:111], v[164:167], v[132:135], v[108:111]
    v_mfma_f32_16x16x32_bf16 v[48:51], v[168:171], v[124:127], v[48:51]
    v_mfma_f32_16x16x32_bf16 v[80:83], v[168:171], v[128:131], v[80:83]
    v_mfma_f32_16x16x32_bf16 v[112:115], v[168:171], v[132:135], v[112:115]
    v_mfma_f32_16x16x32_bf16 v[52:55], v[172:175], v[124:127], v[52:55]
    v_mfma_f32_16x16x32_bf16 v[84:87], v[172:175], v[128:131], v[84:87]
    v_mfma_f32_16x16x32_bf16 v[116:119], v[172:175], v[132:135], v[116:119]
    v_mfma_f32_16x16x32_bf16 v[56:59], v[176:179], v[124:127], v[56:59]
    v_mfma_f32_16x16x32_bf16 v[88:91], v[176:179], v[128:131], v[88:91]
    v_mfma_f32_16x16x32_bf16 v[120:123], v[176:179], v[132:135], v[120:123]
    s_waitcnt lgkmcnt(0)
    s_barrier
    v_mfma_f32_16x16x32_bf16 v[28:31], v[180:183], v[136:139], v[28:31]
    v_mfma_f32_16x16x32_bf16 v[60:63], v[180:183], v[140:143], v[60:63]
    v_mfma_f32_16x16x32_bf16 v[92:95], v[180:183], v[144:147], v[92:95]
    v_mfma_f32_16x16x32_bf16 v[32:35], v[184:187], v[136:139], v[32:35]
    v_mfma_f32_16x16x32_bf16 v[64:67], v[184:187], v[140:143], v[64:67]
    v_mfma_f32_16x16x32_bf16 v[96:99], v[184:187], v[144:147], v[96:99]
    v_mfma_f32_16x16x32_bf16 v[36:39], v[188:191], v[136:139], v[36:39]
    v_mfma_f32_16x16x32_bf16 v[68:71], v[188:191], v[140:143], v[68:71]
    v_mfma_f32_16x16x32_bf16 v[100:103], v[188:191], v[144:147], v[100:103]
    v_mfma_f32_16x16x32_bf16 v[40:43], v[192:195], v[136:139], v[40:43]
    v_mfma_f32_16x16x32_bf16 v[72:75], v[192:195], v[140:143], v[72:75]
    v_mfma_f32_16x16x32_bf16 v[104:107], v[192:195], v[144:147], v[104:107]
    v_mfma_f32_16x16x32_bf16 v[44:47], v[196:199], v[136:139], v[44:47]
    v_mfma_f32_16x16x32_bf16 v[76:79], v[196:199], v[140:143], v[76:79]
    v_mfma_f32_16x16x32_bf16 v[108:111], v[196:199], v[144:147], v[108:111]
    v_mfma_f32_16x16x32_bf16 v[48:51], v[200:203], v[136:139], v[48:51]
    v_mfma_f32_16x16x32_bf16 v[80:83], v[200:203], v[140:143], v[80:83]
    v_mfma_f32_16x16x32_bf16 v[112:115], v[200:203], v[144:147], v[112:115]
    v_mfma_f32_16x16x32_bf16 v[52:55], v[204:207], v[136:139], v[52:55]
    v_mfma_f32_16x16x32_bf16 v[84:87], v[204:207], v[140:143], v[84:87]
    v_mfma_f32_16x16x32_bf16 v[116:119], v[204:207], v[144:147], v[116:119]
    v_mfma_f32_16x16x32_bf16 v[56:59], v[208:211], v[136:139], v[56:59]
    v_mfma_f32_16x16x32_bf16 v[88:91], v[208:211], v[140:143], v[88:91]
    v_mfma_f32_16x16x32_bf16 v[120:123], v[208:211], v[144:147], v[120:123]
    s_waitcnt vmcnt(0)
    s_barrier
    ds_read_b128 v[124:127], v212 offset:0
    ds_read_b128 v[128:131], v212 offset:2048
    ds_read_b128 v[132:135], v212 offset:4096
    ds_read_b64_tr_b16 v[148:149], v214 offset:0
    ds_read_b64_tr_b16 v[150:151], v214 offset:1024
    ds_read_b64_tr_b16 v[152:153], v215 offset:0
    ds_read_b64_tr_b16 v[154:155], v215 offset:1024
    ds_read_b64_tr_b16 v[156:157], v216 offset:0
    ds_read_b64_tr_b16 v[158:159], v216 offset:1024
    ds_read_b64_tr_b16 v[160:161], v217 offset:0
    ds_read_b64_tr_b16 v[162:163], v217 offset:1024
    ds_read_b64_tr_b16 v[164:165], v218 offset:0
    ds_read_b64_tr_b16 v[166:167], v218 offset:1024
    ds_read_b64_tr_b16 v[168:169], v219 offset:0
    ds_read_b64_tr_b16 v[170:171], v219 offset:1024
    ds_read_b64_tr_b16 v[172:173], v220 offset:0
    ds_read_b64_tr_b16 v[174:175], v220 offset:1024
    ds_read_b64_tr_b16 v[176:177], v221 offset:0
    ds_read_b64_tr_b16 v[178:179], v221 offset:1024
    ds_read_b128 v[136:139], v213 offset:0
    ds_read_b128 v[140:143], v213 offset:2048
    ds_read_b128 v[144:147], v213 offset:4096
    ds_read_b64_tr_b16 v[180:181], v214 offset:8192
    ds_read_b64_tr_b16 v[182:183], v214 offset:9216
    ds_read_b64_tr_b16 v[184:185], v215 offset:8192
    ds_read_b64_tr_b16 v[186:187], v215 offset:9216
    ds_read_b64_tr_b16 v[188:189], v216 offset:8192
    ds_read_b64_tr_b16 v[190:191], v216 offset:9216
    ds_read_b64_tr_b16 v[192:193], v217 offset:8192
    ds_read_b64_tr_b16 v[194:195], v217 offset:9216
    ds_read_b64_tr_b16 v[196:197], v218 offset:8192
    ds_read_b64_tr_b16 v[198:199], v218 offset:9216
    ds_read_b64_tr_b16 v[200:201], v219 offset:8192
    ds_read_b64_tr_b16 v[202:203], v219 offset:9216
    ds_read_b64_tr_b16 v[204:205], v220 offset:8192
    ds_read_b64_tr_b16 v[206:207], v220 offset:9216
    ds_read_b64_tr_b16 v[208:209], v221 offset:8192
    ds_read_b64_tr_b16 v[210:211], v221 offset:9216
    s_waitcnt lgkmcnt(15)
    v_mfma_f32_16x16x32_bf16 v[28:31], v[148:151], v[124:127], v[28:31]
    v_mfma_f32_16x16x32_bf16 v[60:63], v[148:151], v[128:131], v[60:63]
    v_mfma_f32_16x16x32_bf16 v[92:95], v[148:151], v[132:135], v[92:95]
    v_mfma_f32_16x16x32_bf16 v[32:35], v[152:155], v[124:127], v[32:35]
    v_mfma_f32_16x16x32_bf16 v[64:67], v[152:155], v[128:131], v[64:67]
    v_mfma_f32_16x16x32_bf16 v[96:99], v[152:155], v[132:135], v[96:99]
    v_mfma_f32_16x16x32_bf16 v[36:39], v[156:159], v[124:127], v[36:39]
    v_mfma_f32_16x16x32_bf16 v[68:71], v[156:159], v[128:131], v[68:71]
    v_mfma_f32_16x16x32_bf16 v[100:103], v[156:159], v[132:135], v[100:103]
    v_mfma_f32_16x16x32_bf16 v[40:43], v[160:163], v[124:127], v[40:43]
    v_mfma_f32_16x16x32_bf16 v[72:75], v[160:163], v[128:131], v[72:75]
    v_mfma_f32_16x16x32_bf16 v[104:107], v[160:163], v[132:135], v[104:107]
    v_mfma_f32_16x16x32_bf16 v[44:47], v[164:167], v[124:127], v[44:47]
    v_mfma_f32_16x16x32_bf16 v[76:79], v[164:167], v[128:131], v[76:79]
    v_mfma_f32_16x16x32_bf16 v[108:111], v[164:167], v[132:135], v[108:111]
    v_mfma_f32_16x16x32_bf16 v[48:51], v[168:171], v[124:127], v[48:51]
    v_mfma_f32_16x16x32_bf16 v[80:83], v[168:171], v[128:131], v[80:83]
    v_mfma_f32_16x16x32_bf16 v[112:115], v[168:171], v[132:135], v[112:115]
    v_mfma_f32_16x16x32_bf16 v[52:55], v[172:175], v[124:127], v[52:55]
    v_mfma_f32_16x16x32_bf16 v[84:87], v[172:175], v[128:131], v[84:87]
    v_mfma_f32_16x16x32_bf16 v[116:119], v[172:175], v[132:135], v[116:119]
    v_mfma_f32_16x16x32_bf16 v[56:59], v[176:179], v[124:127], v[56:59]
    v_mfma_f32_16x16x32_bf16 v[88:91], v[176:179], v[128:131], v[88:91]
    v_mfma_f32_16x16x32_bf16 v[120:123], v[176:179], v[132:135], v[120:123]
    s_waitcnt lgkmcnt(0)
    s_barrier
    v_mfma_f32_16x16x32_bf16 v[28:31], v[180:183], v[136:139], v[28:31]
    v_mfma_f32_16x16x32_bf16 v[60:63], v[180:183], v[140:143], v[60:63]
    v_mfma_f32_16x16x32_bf16 v[92:95], v[180:183], v[144:147], v[92:95]
    v_mfma_f32_16x16x32_bf16 v[32:35], v[184:187], v[136:139], v[32:35]
    v_mfma_f32_16x16x32_bf16 v[64:67], v[184:187], v[140:143], v[64:67]
    v_mfma_f32_16x16x32_bf16 v[96:99], v[184:187], v[144:147], v[96:99]
    v_mfma_f32_16x16x32_bf16 v[36:39], v[188:191], v[136:139], v[36:39]
    v_mfma_f32_16x16x32_bf16 v[68:71], v[188:191], v[140:143], v[68:71]
    v_mfma_f32_16x16x32_bf16 v[100:103], v[188:191], v[144:147], v[100:103]
    v_mfma_f32_16x16x32_bf16 v[40:43], v[192:195], v[136:139], v[40:43]
    v_mfma_f32_16x16x32_bf16 v[72:75], v[192:195], v[140:143], v[72:75]
    v_mfma_f32_16x16x32_bf16 v[104:107], v[192:195], v[144:147], v[104:107]
    v_mfma_f32_16x16x32_bf16 v[44:47], v[196:199], v[136:139], v[44:47]
    v_mfma_f32_16x16x32_bf16 v[76:79], v[196:199], v[140:143], v[76:79]
    v_mfma_f32_16x16x32_bf16 v[108:111], v[196:199], v[144:147], v[108:111]
    v_mfma_f32_16x16x32_bf16 v[48:51], v[200:203], v[136:139], v[48:51]
    v_mfma_f32_16x16x32_bf16 v[80:83], v[200:203], v[140:143], v[80:83]
    v_mfma_f32_16x16x32_bf16 v[112:115], v[200:203], v[144:147], v[112:115]
    v_mfma_f32_16x16x32_bf16 v[52:55], v[204:207], v[136:139], v[52:55]
    v_mfma_f32_16x16x32_bf16 v[84:87], v[204:207], v[140:143], v[84:87]
    v_mfma_f32_16x16x32_bf16 v[116:119], v[204:207], v[144:147], v[116:119]
    v_mfma_f32_16x16x32_bf16 v[56:59], v[208:211], v[136:139], v[56:59]
    v_mfma_f32_16x16x32_bf16 v[88:91], v[208:211], v[140:143], v[88:91]
    v_mfma_f32_16x16x32_bf16 v[120:123], v[208:211], v[144:147], v[120:123]
    s_barrier
    s_nop 7
    v_lshrrev_b32 v14, 4, v1
    v_and_b32 v15, 15, v1
    v_lshrrev_b32 v16, 1, v14
    v_xor_b32 v16, v16, v15
    v_lshlrev_b32 v16, 4, v16
    v_lshl_add_u32 v16, v15, 8, v16
    v_and_b32 v17, 1, v14
    v_lshl_add_u32 v16, v17, 3, v16
    s_mul_i32 s44, s53, 12288
    s_add_u32 s44, s44, 0
    v_add_u32 v16, s44, v16
    v_xor_b32 v17, 0, v16
    v_pk_mul_f32 v[28:29], v[28:29], s[92:93]
    v_pk_mul_f32 v[30:31], v[30:31], s[92:93]
    v_cvt_pk_bf16_f32 v28, v28, v29
    v_cvt_pk_bf16_f32 v29, v30, v31
    ds_write_b64 v17, v[28:29] offset:0
    v_pk_mul_f32 v[60:61], v[60:61], s[92:93]
    v_pk_mul_f32 v[62:63], v[62:63], s[92:93]
    v_cvt_pk_bf16_f32 v60, v60, v61
    v_cvt_pk_bf16_f32 v61, v62, v63
    ds_write_b64 v17, v[60:61] offset:4096
    v_pk_mul_f32 v[92:93], v[92:93], s[92:93]
    v_pk_mul_f32 v[94:95], v[94:95], s[92:93]
    v_cvt_pk_bf16_f32 v92, v92, v93
    v_cvt_pk_bf16_f32 v93, v94, v95
    ds_write_b64 v17, v[92:93] offset:8192
    v_xor_b32 v17, 32, v16
    v_pk_mul_f32 v[32:33], v[32:33], s[92:93]
    v_pk_mul_f32 v[34:35], v[34:35], s[92:93]
    v_cvt_pk_bf16_f32 v32, v32, v33
    v_cvt_pk_bf16_f32 v33, v34, v35
    ds_write_b64 v17, v[32:33] offset:0
    v_pk_mul_f32 v[64:65], v[64:65], s[92:93]
    v_pk_mul_f32 v[66:67], v[66:67], s[92:93]
    v_cvt_pk_bf16_f32 v64, v64, v65
    v_cvt_pk_bf16_f32 v65, v66, v67
    ds_write_b64 v17, v[64:65] offset:4096
    v_pk_mul_f32 v[96:97], v[96:97], s[92:93]
    v_pk_mul_f32 v[98:99], v[98:99], s[92:93]
    v_cvt_pk_bf16_f32 v96, v96, v97
    v_cvt_pk_bf16_f32 v97, v98, v99
    ds_write_b64 v17, v[96:97] offset:8192
    v_xor_b32 v17, 64, v16
    v_pk_mul_f32 v[36:37], v[36:37], s[92:93]
    v_pk_mul_f32 v[38:39], v[38:39], s[92:93]
    v_cvt_pk_bf16_f32 v36, v36, v37
    v_cvt_pk_bf16_f32 v37, v38, v39
    ds_write_b64 v17, v[36:37] offset:0
    v_pk_mul_f32 v[68:69], v[68:69], s[92:93]
    v_pk_mul_f32 v[70:71], v[70:71], s[92:93]
    v_cvt_pk_bf16_f32 v68, v68, v69
    v_cvt_pk_bf16_f32 v69, v70, v71
    ds_write_b64 v17, v[68:69] offset:4096
    v_pk_mul_f32 v[100:101], v[100:101], s[92:93]
    v_pk_mul_f32 v[102:103], v[102:103], s[92:93]
    v_cvt_pk_bf16_f32 v100, v100, v101
    v_cvt_pk_bf16_f32 v101, v102, v103
    ds_write_b64 v17, v[100:101] offset:8192
    v_xor_b32 v17, 96, v16
    v_pk_mul_f32 v[40:41], v[40:41], s[92:93]
    v_pk_mul_f32 v[42:43], v[42:43], s[92:93]
    v_cvt_pk_bf16_f32 v40, v40, v41
    v_cvt_pk_bf16_f32 v41, v42, v43
    ds_write_b64 v17, v[40:41] offset:0
    v_pk_mul_f32 v[72:73], v[72:73], s[92:93]
    v_pk_mul_f32 v[74:75], v[74:75], s[92:93]
    v_cvt_pk_bf16_f32 v72, v72, v73
    v_cvt_pk_bf16_f32 v73, v74, v75
    ds_write_b64 v17, v[72:73] offset:4096
    v_pk_mul_f32 v[104:105], v[104:105], s[92:93]
    v_pk_mul_f32 v[106:107], v[106:107], s[92:93]
    v_cvt_pk_bf16_f32 v104, v104, v105
    v_cvt_pk_bf16_f32 v105, v106, v107
    ds_write_b64 v17, v[104:105] offset:8192
    v_xor_b32 v17, 128, v16
    v_pk_mul_f32 v[44:45], v[44:45], s[92:93]
    v_pk_mul_f32 v[46:47], v[46:47], s[92:93]
    v_cvt_pk_bf16_f32 v44, v44, v45
    v_cvt_pk_bf16_f32 v45, v46, v47
    ds_write_b64 v17, v[44:45] offset:0
    v_pk_mul_f32 v[76:77], v[76:77], s[92:93]
    v_pk_mul_f32 v[78:79], v[78:79], s[92:93]
    v_cvt_pk_bf16_f32 v76, v76, v77
    v_cvt_pk_bf16_f32 v77, v78, v79
    ds_write_b64 v17, v[76:77] offset:4096
    v_pk_mul_f32 v[108:109], v[108:109], s[92:93]
    v_pk_mul_f32 v[110:111], v[110:111], s[92:93]
    v_cvt_pk_bf16_f32 v108, v108, v109
    v_cvt_pk_bf16_f32 v109, v110, v111
    ds_write_b64 v17, v[108:109] offset:8192
    v_xor_b32 v17, 160, v16
    v_pk_mul_f32 v[48:49], v[48:49], s[92:93]
    v_pk_mul_f32 v[50:51], v[50:51], s[92:93]
    v_cvt_pk_bf16_f32 v48, v48, v49
    v_cvt_pk_bf16_f32 v49, v50, v51
    ds_write_b64 v17, v[48:49] offset:0
    v_pk_mul_f32 v[80:81], v[80:81], s[92:93]
    v_pk_mul_f32 v[82:83], v[82:83], s[92:93]
    v_cvt_pk_bf16_f32 v80, v80, v81
    v_cvt_pk_bf16_f32 v81, v82, v83
    ds_write_b64 v17, v[80:81] offset:4096
    v_pk_mul_f32 v[112:113], v[112:113], s[92:93]
    v_pk_mul_f32 v[114:115], v[114:115], s[92:93]
    v_cvt_pk_bf16_f32 v112, v112, v113
    v_cvt_pk_bf16_f32 v113, v114, v115
    ds_write_b64 v17, v[112:113] offset:8192
    v_xor_b32 v17, 192, v16
    v_pk_mul_f32 v[52:53], v[52:53], s[92:93]
    v_pk_mul_f32 v[54:55], v[54:55], s[92:93]
    v_cvt_pk_bf16_f32 v52, v52, v53
    v_cvt_pk_bf16_f32 v53, v54, v55
    ds_write_b64 v17, v[52:53] offset:0
    v_pk_mul_f32 v[84:85], v[84:85], s[92:93]
    v_pk_mul_f32 v[86:87], v[86:87], s[92:93]
    v_cvt_pk_bf16_f32 v84, v84, v85
    v_cvt_pk_bf16_f32 v85, v86, v87
    ds_write_b64 v17, v[84:85] offset:4096
    v_pk_mul_f32 v[116:117], v[116:117], s[92:93]
    v_pk_mul_f32 v[118:119], v[118:119], s[92:93]
    v_cvt_pk_bf16_f32 v116, v116, v117
    v_cvt_pk_bf16_f32 v117, v118, v119
    ds_write_b64 v17, v[116:117] offset:8192
    v_xor_b32 v17, 224, v16
    v_pk_mul_f32 v[56:57], v[56:57], s[92:93]
    v_pk_mul_f32 v[58:59], v[58:59], s[92:93]
    v_cvt_pk_bf16_f32 v56, v56, v57
    v_cvt_pk_bf16_f32 v57, v58, v59
    ds_write_b64 v17, v[56:57] offset:0
    v_pk_mul_f32 v[88:89], v[88:89], s[92:93]
    v_pk_mul_f32 v[90:91], v[90:91], s[92:93]
    v_cvt_pk_bf16_f32 v88, v88, v89
    v_cvt_pk_bf16_f32 v89, v90, v91
    ds_write_b64 v17, v[88:89] offset:4096
    v_pk_mul_f32 v[120:121], v[120:121], s[92:93]
    v_pk_mul_f32 v[122:123], v[122:123], s[92:93]
    v_cvt_pk_bf16_f32 v120, v120, v121
    v_cvt_pk_bf16_f32 v121, v122, v123
    ds_write_b64 v17, v[120:121] offset:8192
    s_waitcnt lgkmcnt(0)
    s_barrier
    s_mov_b32 s64, s100
    s_mov_b32 s65, s101
    s_mov_b32 s66, 256
    s_mov_b32 s67, 0x20000
    v_mov_b32 v20, 0
    s_nop 0
    buffer_load_dword v20, v20, s[64:67], 0 offen sc1
    s_mov_b32 s49, 0
L_h2loop_5:
    s_barrier
    s_cmp_eq_u32 s49, 1
    s_cbranch_scc0 L_sk_6
    s_waitcnt vmcnt(0)
    s_nop 0
    v_readfirstlane_b32 s91, v20
    s_nop 3
    s_add_u32 s64, s40, 50339840
    s_addc_u32 s65, s41, 0
    s_mov_b32 s66, 2048
    s_mov_b32 s67, 0x20000
    s_lshl_b32 s44, s24, 3
    s_add_u32 s44, s44, s25
    s_lshl_b32 s44, s44, 1
    s_lshr_b32 s45, s2, 1
    s_and_b32 s45, s45, 1
    s_add_u32 s44, s44, s45
    s_lshl_b32 s44, s44, 6
    s_and_b32 s45, s2, 1
    s_lshl_b32 s45, s45, 4
    s_add_u32 s44, s44, s45
    s_lshr_b32 s45, s2, 6
    s_lshl_b32 s45, s45, 2
    s_add_u32 s44, s44, s45
    s_add_u32 s44, s44, 32
    v_mov_b32 v14, 0
    v_mov_b32 v15, s91
    s_mov_b64 exec, 1
    buffer_store_dword v15, v14, s[64:67], s44 offen sc1
    s_mov_b64 exec, -1
L_sk_6:
    s_add_u32 s49, s49, 1
    s_cmp_lt_u32 s49, 27
    s_cbranch_scc1 L_h2loop_5
    s_barrier
    s_and_b32 s44, s2, 7
    s_lshr_b32 s45, s2, 3
    s_lshr_b32 s24, s44, 2
    s_lshr_b32 s27, s44, 1
    s_and_b32 s27, s27, 1
    s_and_b32 s51, s44, 1
    s_lshl_b32 s51, s51, 2
    s_and_b32 s25, s45, 3
    s_add_u32 s25, s25, s51
    s_lshr_b32 s26, s45, 2
    s_mov_b32 s31, 0
    s_mov_b32 s32, s96
    s_mov_b32 s33, s97
    s_mul_i32 s44, s24, 9437184
    s_mul_i32 s45, s25, 1179648
    s_add_u32 s44, s44, s45
    s_lshl_b32 s45, s27, 12
    s_add_u32 s44, s44, s45
    s_add_u32 s4, s40, s44
    s_addc_u32 s5, s41, 0
    s_mov_b32 s6, 1175552
    s_mov_b32 s7, 0x20000
    s_mov_b32 s51, 0
    v_lshrrev_b32 v14, 3, v1
    v_and_b32 v15, 7, v1
    v_lshrrev_b32 v16, 1, v14
    s_lshl_b32 s45, s51, 2
    v_add_u32 v16, s45, v16
    v_and_b32 v16, 7, v16
    v_xor_b32 v16, v16, v15
    v_lshlrev_b32 v16, 4, v16
    v_mul_u32_u24 v17, 8192, v14
    v_add_u32 v2, v16, v17
    v_xor_b32 v3, 64, v2
    s_mul_i32 s46, s51, 65536
    s_lshl_b32 s47, s51, 10
    s_add_u32 s64, s40, 50339840
    s_addc_u32 s65, s41, 0
    s_mov_b32 s66, 2048
    s_mov_b32 s67, 0x20000
    s_lshl_b32 s44, s24, 3
    s_add_u32 s44, s44, s25
    s_lshl_b32 s44, s44, 1
    s_add_u32 s44, s44, s27
    s_lshl_b32 s44, s44, 6
    s_add_u32 s44, s44, 32
    v_lshlrev_b32 v14, 2, v1
    s_mov_b32 s49, 0
    s_mov_b64 exec, 0xff
L_ppoll_7:
    buffer_load_dword v15, v14, s[64:67], s44 offen sc1
    s_waitcnt vmcnt(0)
    v_cmp_ne_u32 vcc, s91, v15
    s_add_u32 s49, s49, 1
    s_cbranch_vccz L_pgot_8
    s_sleep 4
    s_cmp_lt_u32 s49, 300000
    s_cbranch_scc1 L_ppoll_7
L_pgot_8:
    s_mov_b64 exec, -1
    s_mov_b32 s44, 0
    buffer_load_dword v9, v8, s[68:71], s44 offen
    s_mov_b32 s44, 4096
    buffer_load_dword v9, v8, s[68:71], s44 offen
    s_mov_b32 s44, 8192
    buffer_load_dword v9, v8, s[68:71], s44 offen
    s_mov_b32 s44, 12288
    buffer_load_dword v9, v8, s[68:71], s44 offen
    s_mov_b32 s44, 16384
    buffer_load_dword v9, v8, s[68:71], s44 offen
    s_mov_b32 s44, 20480
    buffer_load_dword v9, v8, s[68:71], s44 offen
    s_mov_b32 s44, 24576
    buffer_load_dword v9, v8, s[68:71], s44 offen
    s_mov_b32 s44, 28672
    buffer_load_dword v9, v8, s[68:71], s44 offen
    s_mov_b32 s44, 32768
    buffer_load_dword v9, v8, s[68:71], s44 offen
    s_mov_b32 s44, 36864
    buffer_load_dword v9, v8, s[68:71], s44 offen
    s_mov_b32 s44, 40960
    buffer_load_dword v9, v8, s[68:71], s44 offen
    s_mov_b32 s44, 45056
    buffer_load_dword v9, v8, s[68:71], s44 offen
    s_mov_b32 s44, 49152
    buffer_load_dword v9, v8, s[68:71], s44 offen
    s_mov_b32 s44, 53248
    buffer_load_dword v9, v8, s[68:71], s44 offen
    s_mov_b32 s44, 57344
    buffer_load_dword v9, v8, s[68:71], s44 offen
    s_mov_b32 s44, 61440
    buffer_load_dword v9, v8, s[68:71], s44 offen
    s_barrier
    s_mov_b32 s43, 0
    s_lshl_b32 s42, s43, 7
    s_add_u32 s42, s42, s46
    s_add_u32 m0, s47, 0
    s_add_u32 s44, s42, 0
    buffer_load_dwordx4 v2, s[4:7], s44 offen sc1 lds
    s_add_u32 m0, s47, 1024
    s_add_u32 s44, s42, 65536
    buffer_load_dwordx4 v3, s[4:7], s44 offen sc1 lds
    s_add_u32 m0, s47, 2048
    s_add_u32 s44, s42, 131072
    buffer_load_dwordx4 v2, s[4:7], s44 offen sc1 lds
    s_add_u32 m0, s47, 3072
    s_add_u32 s44, s42, 196608
    buffer_load_dwordx4 v3, s[4:7], s44 offen sc1 lds
    s_add_u32 m0, s47, 4096
    s_add_u32 s44, s42, 262144
    buffer_load_dwordx4 v2, s[4:7], s44 offen sc1 lds
    s_add_u32 m0, s47, 5120
    s_add_u32 s44, s42, 327680
    buffer_load_dwordx4 v3, s[4:7], s44 offen sc1 lds
    s_add_u32 m0, s47, 6144
    s_add_u32 s44, s42, 393216
    buffer_load_dwordx4 v2, s[4:7], s44 offen sc1 lds
    s_add_u32 m0, s47, 7168
    s_add_u32 s44, s42, 458752
    buffer_load_dwordx4 v3, s[4:7], s44 offen sc1 lds
    s_add_u32 m0, s47, 8192
    s_add_u32 s44, s42, 524288
    buffer_load_dwordx4 v2, s[4:7], s44 offen sc1 lds
    s_add_u32 m0, s47, 9216
    s_add_u32 s44, s42, 589824
    buffer_load_dwordx4 v3, s[4:7], s44 offen sc1 lds
    s_add_u32 m0, s47, 10240
    s_add_u32 s44, s42, 655360
    buffer_load_dwordx4 v2, s[4:7], s44 offen sc1 lds
    s_add_u32 m0, s47, 11264
    s_add_u32 s44, s42, 720896
    buffer_load_dwordx4 v3, s[4:7], s44 offen sc1 lds
    s_add_u32 m0, s47, 12288
    s_add_u32 s44, s42, 786432
    buffer_load_dwordx4 v2, s[4:7], s44 offen sc1 lds
    s_add_u32 m0, s47, 13312
    s_add_u32 s44, s42, 851968
    buffer_load_dwordx4 v3, s[4:7], s44 offen sc1 lds
    s_add_u32 m0, s47, 14336
    s_add_u32 s44, s42, 917504
    buffer_load_dwordx4 v2, s[4:7], s44 offen sc1 lds
    s_add_u32 m0, s47, 15360
    s_add_u32 s44, s42, 983040
    buffer_load_dwordx4 v3, s[4:7], s44 offen sc1 lds
    s_add_u32 m0, s47, 16384
    s_add_u32 s44, s42, 1048576
    buffer_load_dwordx4 v2, s[4:7], s44 offen sc1 lds
    s_add_u32 m0, s47, 17408
    s_add_u32 s44, s42, 1114112
    buffer_load_dwordx4 v3, s[4:7], s44 offen sc1 lds
    s_add_u32 s43, s43, 1
    s_and_b32 s43, s43, 31
    s_barrier
    s_mov_b32 s43, 1
    s_lshl_b32 s42, s43, 7
    s_add_u32 s42, s42, s46
    s_add_u32 m0, s47, 34816
    s_add_u32 s44, s42, 0
    buffer_load_dwordx4 v2, s[4:7], s44 offen sc1 lds
    s_add_u32 m0, s47, 35840
    s_add_u32 s44, s42, 65536
    buffer_load_dwordx4 v3, s[4:7], s44 offen sc1 lds
    s_add_u32 m0, s47, 36864
    s_add_u32 s44, s42, 131072
    buffer_load_dwordx4 v2, s[4:7], s44 offen sc1 lds
    s_add_u32 m0, s47, 37888
    s_add_u32 s44, s42, 196608
    buffer_load_dwordx4 v3, s[4:7], s44 offen sc1 lds
    s_add_u32 m0, s47, 38912
    s_add_u32 s44, s42, 262144
    buffer_load_dwordx4 v2, s[4:7], s44 offen sc1 lds
    s_add_u32 m0, s47, 39936
    s_add_u32 s44, s42, 327680
    buffer_load_dwordx4 v3, s[4:7], s44 offen sc1 lds
    s_add_u32 m0, s47, 40960
    s_add_u32 s44, s42, 393216
    buffer_load_dwordx4 v2, s[4:7], s44 offen sc1 lds
    s_add_u32 m0, s47, 41984
    s_add_u32 s44, s42, 458752
    buffer_load_dwordx4 v3, s[4:7], s44 offen sc1 lds
    s_add_u32 m0, s47, 43008
    s_add_u32 s44, s42, 524288
    buffer_load_dwordx4 v2, s[4:7], s44 offen sc1 lds
    s_add_u32 m0, s47, 44032
    s_add_u32 s44, s42, 589824
    buffer_load_dwordx4 v3, s[4:7], s44 offen sc1 lds
    s_add_u32 m0, s47, 45056
    s_add_u32 s44, s42, 655360
    buffer_load_dwordx4 v2, s[4:7], s44 offen sc1 lds
    s_add_u32 m0, s47, 46080
    s_add_u32 s44, s42, 720896
    buffer_load_dwordx4 v3, s[4:7], s44 offen sc1 lds
    s_add_u32 m0, s47, 47104
    s_add_u32 s44, s42, 786432
    buffer_load_dwordx4 v2, s[4:7], s44 offen sc1 lds
    s_add_u32 m0, s47, 48128
    s_add_u32 s44, s42, 851968
    buffer_load_dwordx4 v3, s[4:7], s44 offen sc1 lds
    s_add_u32 m0, s47, 49152
    s_add_u32 s44, s42, 917504
    buffer_load_dwordx4 v2, s[4:7], s44 offen sc1 lds
    s_add_u32 m0, s47, 50176
    s_add_u32 s44, s42, 983040
    buffer_load_dwordx4 v3, s[4:7], s44 offen sc1 lds
    s_add_u32 m0, s47, 51200
    s_add_u32 s44, s42, 1048576
    buffer_load_dwordx4 v2, s[4:7], s44 offen sc1 lds
    s_add_u32 m0, s47, 52224
    s_add_u32 s44, s42, 1114112
    buffer_load_dwordx4 v3, s[4:7], s44 offen sc1 lds
    s_add_u32 s43, s43, 1
    s_and_b32 s43, s43, 31
    s_barrier
    s_barrier
    s_waitcnt vmcnt(18)
    s_barrier
    s_mov_b32 s43, 2
    s_lshl_b32 s42, s43, 7
    s_add_u32 s42, s42, s46
    s_add_u32 m0, s47, 69632
    s_add_u32 s44, s42, 0
    buffer_load_dwordx4 v2, s[4:7], s44 offen sc1 lds
    s_add_u32 m0, s47, 70656
    s_add_u32 s44, s42, 65536
    buffer_load_dwordx4 v3, s[4:7], s44 offen sc1 lds
    s_add_u32 m0, s47, 71680
    s_add_u32 s44, s42, 131072
    buffer_load_dwordx4 v2, s[4:7], s44 offen sc1 lds
    s_add_u32 m0, s47, 72704
    s_add_u32 s44, s42, 196608
    buffer_load_dwordx4 v3, s[4:7], s44 offen sc1 lds
    s_add_u32 m0, s47, 73728
    s_add_u32 s44, s42, 262144
    buffer_load_dwordx4 v2, s[4:7], s44 offen sc1 lds
    s_add_u32 m0, s47, 74752
    s_add_u32 s44, s42, 327680
    buffer_load_dwordx4 v3, s[4:7], s44 offen sc1 lds
    s_add_u32 m0, s47, 75776
    s_add_u32 s44, s42, 393216
    buffer_load_dwordx4 v2, s[4:7], s44 offen sc1 lds
    s_add_u32 m0, s47, 76800
    s_add_u32 s44, s42, 458752
    buffer_load_dwordx4 v3, s[4:7], s44 offen sc1 lds
    s_add_u32 m0, s47, 77824
    s_add_u32 s44, s42, 524288
    buffer_load_dwordx4 v2, s[4:7], s44 offen sc1 lds
    s_add_u32 s43, s43, 1
    s_and_b32 s43, s43, 31
    s_mov_b32 s43, 3
    s_lshl_b32 s42, s43, 7
    s_add_u32 s42, s42, s46
    s_add_u32 m0, s47, 104448
    s_add_u32 s44, s42, 0
    buffer_load_dwordx4 v2, s[4:7], s44 offen sc1 lds
    s_add_u32 m0, s47, 105472
    s_add_u32 s44, s42, 65536
    buffer_load_dwordx4 v3, s[4:7], s44 offen sc1 lds
    s_add_u32 m0, s47, 106496
    s_add_u32 s44, s42, 131072
    buffer_load_dwordx4 v2, s[4:7], s44 offen sc1 lds
    s_add_u32 m0, s47, 107520
    s_add_u32 s44, s42, 196608
    buffer_load_dwordx4 v3, s[4:7], s44 offen sc1 lds
    s_add_u32 m0, s47, 108544
    s_add_u32 s44, s42, 262144
    buffer_load_dwordx4 v2, s[4:7], s44 offen sc1 lds
    s_add_u32 m0, s47, 109568
    s_add_u32 s44, s42, 327680
    buffer_load_dwordx4 v3, s[4:7], s44 offen sc1 lds
    s_add_u32 m0, s47, 110592
    s_add_u32 s44, s42, 393216
    buffer_load_dwordx4 v2, s[4:7], s44 offen sc1 lds
    s_add_u32 m0, s47, 111616
    s_add_u32 s44, s42, 458752
    buffer_load_dwordx4 v3, s[4:7], s44 offen sc1 lds
    s_add_u32 m0, s47, 112640
    s_add_u32 s44, s42, 524288
    buffer_load_dwordx4 v2, s[4:7], s44 offen sc1 lds
    s_add_u32 s43, s43, 1
    s_and_b32 s43, s43, 31
    s_waitcnt vmcnt(18)
    s_barrier
    s_mov_b32 s43, 4
    s_lshl_b32 s42, s43, 7
    s_add_u32 s42, s42, s46
    s_add_u32 m0, s47, 0
    s_add_u32 s44, s42, 0
    buffer_load_dwordx4 v2, s[4:7], s44 offen sc1 lds
    s_add_u32 m0, s47, 1024
    s_add_u32 s44, s42, 65536
    buffer_load_dwordx4 v3, s[4:7], s44 offen sc1 lds
    s_add_u32 m0, s47, 2048
    s_add_u32 s44, s42, 131072
    buffer_load_dwordx4 v2, s[4:7], s44 offen sc1 lds
    s_add_u32 m0, s47, 3072
    s_add_u32 s44, s42, 196608
    buffer_load_dwordx4 v3, s[4:7], s44 offen sc1 lds
    s_add_u32 m0, s47, 4096
    s_add_u32 s44, s42, 262144
    buffer_load_dwordx4 v2, s[4:7], s44 offen sc1 lds
    s_add_u32 m0, s47, 5120
    s_add_u32 s44, s42, 327680
    buffer_load_dwordx4 v3, s[4:7], s44 offen sc1 lds
    s_add_u32 m0, s47, 6144
    s_add_u32 s44, s42, 393216
    buffer_load_dwordx4 v2, s[4:7], s44 offen sc1 lds
    s_add_u32 m0, s47, 7168
    s_add_u32 s44, s42, 458752
    buffer_load_dwordx4 v3, s[4:7], s44 offen sc1 lds
    s_add_u32 m0, s47, 8192
    s_add_u32 s44, s42, 524288
    buffer_load_dwordx4 v2, s[4:7], s44 offen sc1 lds
    s_add_u32 s43, s43, 1
    s_and_b32 s43, s43, 31
    s_waitcnt vmcnt(18)
    s_barrier
    s_mov_b32 s43, 5
    s_lshl_b32 s42, s43, 7
    s_add_u32 s42, s42, s46
    s_add_u32 m0, s47, 34816
    s_add_u32 s44, s42, 0
    buffer_load_dwordx4 v2, s[4:7], s44 offen sc1 lds
    s_add_u32 m0, s47, 35840
    s_add_u32 s44, s42, 65536
    buffer_load_dwordx4 v3, s[4:7], s44 offen sc1 lds
    s_add_u32 m0, s47, 36864
    s_add_u32 s44, s42, 131072
    buffer_load_dwordx4 v2, s[4:7], s44 offen sc1 lds
    s_add_u32 m0, s47, 37888
    s_add_u32 s44, s42, 196608
    buffer_load_dwordx4 v3, s[4:7], s44 offen sc1 lds
    s_add_u32 m0, s47, 38912
    s_add_u32 s44, s42, 262144
    buffer_load_dwordx4 v2, s[4:7], s44 offen sc1 lds
    s_add_u32 m0, s47, 39936
    s_add_u32 s44, s42, 327680
    buffer_load_dwordx4 v3, s[4:7], s44 offen sc1 lds
    s_add_u32 m0, s47, 40960
    s_add_u32 s44, s42, 393216
    buffer_load_dwordx4 v2, s[4:7], s44 offen sc1 lds
    s_add_u32 m0, s47, 41984
    s_add_u32 s44, s42, 458752
    buffer_load_dwordx4 v3, s[4:7], s44 offen sc1 lds
    s_add_u32 m0, s47, 43008
    s_add_u32 s44, s42, 524288
    buffer_load_dwordx4 v2, s[4:7], s44 offen sc1 lds
    s_add_u32 s43, s43, 1
    s_and_b32 s43, s43, 31
    s_waitcnt vmcnt(18)
    s_barrier
    s_mov_b32 s43, 6
    s_lshl_b32 s42, s43, 7
    s_add_u32 s42, s42, s46
    s_add_u32 m0, s47, 69632
    s_add_u32 s44, s42, 0
    buffer_load_dwordx4 v2, s[4:7], s44 offen sc1 lds
    s_add_u32 m0, s47, 70656
    s_add_u32 s44, s42, 65536
    buffer_load_dwordx4 v3, s[4:7], s44 offen sc1 lds
    s_add_u32 m0, s47, 71680
    s_add_u32 s44, s42, 131072
    buffer_load_dwordx4 v2, s[4:7], s44 offen sc1 lds
    s_add_u32 m0, s47, 72704
    s_add_u32 s44, s42, 196608
    buffer_load_dwordx4 v3, s[4:7], s44 offen sc1 lds
    s_add_u32 m0, s47, 73728
    s_add_u32 s44, s42, 262144
    buffer_load_dwordx4 v2, s[4:7], s44 offen sc1 lds
    s_add_u32 m0, s47, 74752
    s_add_u32 s44, s42, 327680
    buffer_load_dwordx4 v3, s[4:7], s44 offen sc1 lds
    s_add_u32 m0, s47, 75776
    s_add_u32 s44, s42, 393216
    buffer_load_dwordx4 v2, s[4:7], s44 offen sc1 lds
    s_add_u32 m0, s47, 76800
    s_add_u32 s44, s42, 458752
    buffer_load_dwordx4 v3, s[4:7], s44 offen sc1 lds
    s_add_u32 m0, s47, 77824
    s_add_u32 s44, s42, 524288
    buffer_load_dwordx4 v2, s[4:7], s44 offen sc1 lds
    s_add_u32 s43, s43, 1
    s_and_b32 s43, s43, 31
    s_waitcnt vmcnt(18)
    s_barrier
    s_mov_b32 s43, 7
    s_lshl_b32 s42, s43, 7
    s_add_u32 s42, s42, s46
    s_add_u32 m0, s47, 104448
    s_add_u32 s44, s42, 0
    buffer_load_dwordx4 v2, s[4:7], s44 offen sc1 lds
    s_add_u32 m0, s47, 105472
    s_add_u32 s44, s42, 65536
    buffer_load_dwordx4 v3, s[4:7], s44 offen sc1 lds
    s_add_u32 m0, s47, 106496
    s_add_u32 s44, s42, 131072
    buffer_load_dwordx4 v2, s[4:7], s44 offen sc1 lds
    s_add_u32 m0, s47, 107520
    s_add_u32 s44, s42, 196608
    buffer_load_dwordx4 v3, s[4:7], s44 offen sc1 lds
    s_add_u32 m0, s47, 108544
    s_add_u32 s44, s42, 262144
    buffer_load_dwordx4 v2, s[4:7], s44 offen sc1 lds
    s_add_u32 m0, s47, 109568
    s_add_u32 s44, s42, 327680
    buffer_load_dwordx4 v3, s[4:7], s44 offen sc1 lds
    s_add_u32 m0, s47, 110592
    s_add_u32 s44, s42, 393216
    buffer_load_dwordx4 v2, s[4:7], s44 offen sc1 lds
    s_add_u32 m0, s47, 111616
    s_add_u32 s44, s42, 458752
    buffer_load_dwordx4 v3, s[4:7], s44 offen sc1 lds
    s_add_u32 m0, s47, 112640
    s_add_u32 s44, s42, 524288
    buffer_load_dwordx4 v2, s[4:7], s44 offen sc1 lds
    s_add_u32 s43, s43, 1
    s_and_b32 s43, s43, 31
    s_waitcnt vmcnt(18)
    s_barrier
    s_mov_b32 s43, 16
    s_lshl_b32 s42, s43, 7
    s_add_u32 s42, s42, s46
    s_add_u32 m0, s47, 0
    s_add_u32 s44, s42, 0
    buffer_load_dwordx4 v2, s[4:7], s44 offen sc1 lds
    s_add_u32 m0, s47, 1024
    s_add_u32 s44, s42, 65536
    buffer_load_dwordx4 v3, s[4:7], s44 offen sc1 lds
    s_add_u32 m0, s47, 2048
    s_add_u32 s44, s42, 131072
    buffer_load_dwordx4 v2, s[4:7], s44 offen sc1 lds
    s_add_u32 m0, s47, 3072
    s_add_u32 s44, s42, 196608
    buffer_load_dwordx4 v3, s[4:7], s44 offen sc1 lds
    s_add_u32 m0, s47, 4096
    s_add_u32 s44, s42, 262144
    buffer_load_dwordx4 v2, s[4:7], s44 offen sc1 lds
    s_add_u32 m0, s47, 5120
    s_add_u32 s44, s42, 327680
    buffer_load_dwordx4 v3, s[4:7], s44 offen sc1 lds
    s_add_u32 m0, s47, 6144
    s_add_u32 s44, s42, 393216
    buffer_load_dwordx4 v2, s[4:7], s44 offen sc1 lds
    s_add_u32 m0, s47, 7168
    s_add_u32 s44, s42, 458752
    buffer_load_dwordx4 v3, s[4:7], s44 offen sc1 lds
    s_add_u32 m0, s47, 8192
    s_add_u32 s44, s42, 524288
    buffer_load_dwordx4 v2, s[4:7], s44 offen sc1 lds
    s_add_u32 s43, s43, 1
    s_and_b32 s43, s43, 31
    s_waitcnt vmcnt(18)
    s_barrier
    s_mov_b32 s43, 17
    s_lshl_b32 s42, s43, 7
    s_add_u32 s42, s42, s46
    s_add_u32 m0, s47, 34816
    s_add_u32 s44, s42, 0
    buffer_load_dwordx4 v2, s[4:7], s44 offen sc1 lds
    s_add_u32 m0, s47, 35840
    s_add_u32 s44, s42, 65536
    buffer_load_dwordx4 v3, s[4:7], s44 offen sc1 lds
    s_add_u32 m0, s47, 36864
    s_add_u32 s44, s42, 131072
    buffer_load_dwordx4 v2, s[4:7], s44 offen sc1 lds
    s_add_u32 m0, s47, 37888
    s_add_u32 s44, s42, 196608
    buffer_load_dwordx4 v3, s[4:7], s44 offen sc1 lds
    s_add_u32 m0, s47, 38912
    s_add_u32 s44, s42, 262144
    buffer_load_dwordx4 v2, s[4:7], s44 offen sc1 lds
    s_add_u32 m0, s47, 39936
    s_add_u32 s44, s42, 327680
    buffer_load_dwordx4 v3, s[4:7], s44 offen sc1 lds
    s_add_u32 m0, s47, 40960
    s_add_u32 s44, s42, 393216
    buffer_load_dwordx4 v2, s[4:7], s44 offen sc1 lds
    s_add_u32 m0, s47, 41984
    s_add_u32 s44, s42, 458752
    buffer_load_dwordx4 v3, s[4:7], s44 offen sc1 lds
    s_add_u32 m0, s47, 43008
    s_add_u32 s44, s42, 524288
    buffer_load_dwordx4 v2, s[4:7], s44 offen sc1 lds
    s_add_u32 s43, s43, 1
    s_and_b32 s43, s43, 31
    s_waitcnt vmcnt(18)
    s_barrier
    s_mov_b32 s43, 18
    s_lshl_b32 s42, s43, 7
    s_add_u32 s42, s42, s46
    s_add_u32 m0, s47, 69632
    s_add_u32 s44, s42, 0
    buffer_load_dwordx4 v2, s[4:7], s44 offen sc1 lds
    s_add_u32 m0, s47, 70656
    s_add_u32 s44, s42, 65536
    buffer_load_dwordx4 v3, s[4:7], s44 offen sc1 lds
    s_add_u32 m0, s47, 71680
    s_add_u32 s44, s42, 131072
    buffer_load_dwordx4 v2, s[4:7], s44 offen sc1 lds
    s_add_u32 m0, s47, 72704
    s_add_u32 s44, s42, 196608
    buffer_load_dwordx4 v3, s[4:7], s44 offen sc1 lds
    s_add_u32 m0, s47, 73728
    s_add_u32 s44, s42, 262144
    buffer_load_dwordx4 v2, s[4:7], s44 offen sc1 lds
    s_add_u32 m0, s47, 74752
    s_add_u32 s44, s42, 327680
    buffer_load_dwordx4 v3, s[4:7], s44 offen sc1 lds
    s_add_u32 m0, s47, 75776
    s_add_u32 s44, s42, 393216
    buffer_load_dwordx4 v2, s[4:7], s44 offen sc1 lds
    s_add_u32 m0, s47, 76800
    s_add_u32 s44, s42, 458752
    buffer_load_dwordx4 v3, s[4:7], s44 offen sc1 lds
    s_add_u32 m0, s47, 77824
    s_add_u32 s44, s42, 524288
    buffer_load_dwordx4 v2, s[4:7], s44 offen sc1 lds
    s_add_u32 s43, s43, 1
    s_and_b32 s43, s43, 31
    s_waitcnt vmcnt(18)
    s_barrier
    s_mov_b32 s43, 19
    s_lshl_b32 s42, s43, 7
    s_add_u32 s42, s42, s46
    s_add_u32 m0, s47, 104448
    s_add_u32 s44, s42, 0
    buffer_load_dwordx4 v2, s[4:7], s44 offen sc1 lds
    s_add_u32 m0, s47, 105472
    s_add_u32 s44, s42, 65536
    buffer_load_dwordx4 v3, s[4:7], s44 offen sc1 lds
    s_add_u32 m0, s47, 106496
    s_add_u32 s44, s42, 131072
    buffer_load_dwordx4 v2, s[4:7], s44 offen sc1 lds
    s_add_u32 m0, s47, 107520
    s_add_u32 s44, s42, 196608
    buffer_load_dwordx4 v3, s[4:7], s44 offen sc1 lds
    s_add_u32 m0, s47, 108544
    s_add_u32 s44, s42, 262144
    buffer_load_dwordx4 v2, s[4:7], s44 offen sc1 lds
    s_add_u32 m0, s47, 109568
    s_add_u32 s44, s42, 327680
    buffer_load_dwordx4 v3, s[4:7], s44 offen sc1 lds
    s_add_u32 m0, s47, 110592
    s_add_u32 s44, s42, 393216
    buffer_load_dwordx4 v2, s[4:7], s44 offen sc1 lds
    s_add_u32 m0, s47, 111616
    s_add_u32 s44, s42, 458752
    buffer_load_dwordx4 v3, s[4:7], s44 offen sc1 lds
    s_add_u32 m0, s47, 112640
    s_add_u32 s44, s42, 524288
    buffer_load_dwordx4 v2, s[4:7], s44 offen sc1 lds
    s_add_u32 s43, s43, 1
    s_and_b32 s43, s43, 31
    s_waitcnt vmcnt(18)
    s_barrier
    s_mov_b32 s43, 20
    s_lshl_b32 s42, s43, 7
    s_add_u32 s42, s42, s46
    s_add_u32 m0, s47, 0
    s_add_u32 s44, s42, 0
    buffer_load_dwordx4 v2, s[4:7], s44 offen sc1 lds
    s_add_u32 m0, s47, 1024
    s_add_u32 s44, s42, 65536
    buffer_load_dwordx4 v3, s[4:7], s44 offen sc1 lds
    s_add_u32 m0, s47, 2048
    s_add_u32 s44, s42, 131072
    buffer_load_dwordx4 v2, s[4:7], s44 offen sc1 lds
    s_add_u32 m0, s47, 3072
    s_add_u32 s44, s42, 196608
    buffer_load_dwordx4 v3, s[4:7], s44 offen sc1 lds
    s_add_u32 m0, s47, 4096
    s_add_u32 s44, s42, 262144
    buffer_load_dwordx4 v2, s[4:7], s44 offen sc1 lds
    s_add_u32 m0, s47, 5120
    s_add_u32 s44, s42, 327680
    buffer_load_dwordx4 v3, s[4:7], s44 offen sc1 lds
    s_add_u32 m0, s47, 6144
    s_add_u32 s44, s42, 393216
    buffer_load_dwordx4 v2, s[4:7], s44 offen sc1 lds
    s_add_u32 m0, s47, 7168
    s_add_u32 s44, s42, 458752
    buffer_load_dwordx4 v3, s[4:7], s44 offen sc1 lds
    s_add_u32 m0, s47, 8192
    s_add_u32 s44, s42, 524288
    buffer_load_dwordx4 v2, s[4:7], s44 offen sc1 lds
    s_add_u32 s43, s43, 1
    s_and_b32 s43, s43, 31
    s_waitcnt vmcnt(18)
    s_barrier
    s_mov_b32 s43, 21
    s_lshl_b32 s42, s43, 7
    s_add_u32 s42, s42, s46
    s_add_u32 m0, s47, 34816
    s_add_u32 s44, s42, 0
    buffer_load_dwordx4 v2, s[4:7], s44 offen sc1 lds
    s_add_u32 m0, s47, 35840
    s_add_u32 s44, s42, 65536
    buffer_load_dwordx4 v3, s[4:7], s44 offen sc1 lds
    s_add_u32 m0, s47, 36864
    s_add_u32 s44, s42, 131072
    buffer_load_dwordx4 v2, s[4:7], s44 offen sc1 lds
    s_add_u32 m0, s47, 37888
    s_add_u32 s44, s42, 196608
    buffer_load_dwordx4 v3, s[4:7], s44 offen sc1 lds
    s_add_u32 m0, s47, 38912
    s_add_u32 s44, s42, 262144
    buffer_load_dwordx4 v2, s[4:7], s44 offen sc1 lds
    s_add_u32 m0, s47, 39936
    s_add_u32 s44, s42, 327680
    buffer_load_dwordx4 v3, s[4:7], s44 offen sc1 lds
    s_add_u32 m0, s47, 40960
    s_add_u32 s44, s42, 393216
    buffer_load_dwordx4 v2, s[4:7], s44 offen sc1 lds
    s_add_u32 m0, s47, 41984
    s_add_u32 s44, s42, 458752
    buffer_load_dwordx4 v3, s[4:7], s44 offen sc1 lds
    s_add_u32 m0, s47, 43008
    s_add_u32 s44, s42, 524288
    buffer_load_dwordx4 v2, s[4:7], s44 offen sc1 lds
    s_add_u32 s43, s43, 1
    s_and_b32 s43, s43, 31
    s_waitcnt vmcnt(18)
    s_barrier
    s_mov_b32 s43, 22
    s_lshl_b32 s42, s43, 7
    s_add_u32 s42, s42, s46
    s_add_u32 m0, s47, 69632
    s_add_u32 s44, s42, 0
    buffer_load_dwordx4 v2, s[4:7], s44 offen sc1 lds
    s_add_u32 m0, s47, 70656
    s_add_u32 s44, s42, 65536
    buffer_load_dwordx4 v3, s[4:7], s44 offen sc1 lds
    s_add_u32 m0, s47, 71680
    s_add_u32 s44, s42, 131072
    buffer_load_dwordx4 v2, s[4:7], s44 offen sc1 lds
    s_add_u32 m0, s47, 72704
    s_add_u32 s44, s42, 196608
    buffer_load_dwordx4 v3, s[4:7], s44 offen sc1 lds
    s_add_u32 m0, s47, 73728
    s_add_u32 s44, s42, 262144
    buffer_load_dwordx4 v2, s[4:7], s44 offen sc1 lds
    s_add_u32 m0, s47, 74752
    s_add_u32 s44, s42, 327680
    buffer_load_dwordx4 v3, s[4:7], s44 offen sc1 lds
    s_add_u32 m0, s47, 75776
    s_add_u32 s44, s42, 393216
    buffer_load_dwordx4 v2, s[4:7], s44 offen sc1 lds
    s_add_u32 m0, s47, 76800
    s_add_u32 s44, s42, 458752
    buffer_load_dwordx4 v3, s[4:7], s44 offen sc1 lds
    s_add_u32 m0, s47, 77824
    s_add_u32 s44, s42, 524288
    buffer_load_dwordx4 v2, s[4:7], s44 offen sc1 lds
    s_add_u32 s43, s43, 1
    s_and_b32 s43, s43, 31
    s_waitcnt vmcnt(18)
    s_barrier
    s_mov_b32 s43, 23
    s_lshl_b32 s42, s43, 7
    s_add_u32 s42, s42, s46
    s_add_u32 m0, s47, 104448
    s_add_u32 s44, s42, 0
    buffer_load_dwordx4 v2, s[4:7], s44 offen sc1 lds
    s_add_u32 m0, s47, 105472
    s_add_u32 s44, s42, 65536
    buffer_load_dwordx4 v3, s[4:7], s44 offen sc1 lds
    s_add_u32 m0, s47, 106496
    s_add_u32 s44, s42, 131072
    buffer_load_dwordx4 v2, s[4:7], s44 offen sc1 lds
    s_add_u32 m0, s47, 107520
    s_add_u32 s44, s42, 196608
    buffer_load_dwordx4 v3, s[4:7], s44 offen sc1 lds
    s_add_u32 m0, s47, 108544
    s_add_u32 s44, s42, 262144
    buffer_load_dwordx4 v2, s[4:7], s44 offen sc1 lds
    s_add_u32 m0, s47, 109568
    s_add_u32 s44, s42, 327680
    buffer_load_dwordx4 v3, s[4:7], s44 offen sc1 lds
    s_add_u32 m0, s47, 110592
    s_add_u32 s44, s42, 393216
    buffer_load_dwordx4 v2, s[4:7], s44 offen sc1 lds
    s_add_u32 m0, s47, 111616
    s_add_u32 s44, s42, 458752
    buffer_load_dwordx4 v3, s[4:7], s44 offen sc1 lds
    s_add_u32 m0, s47, 112640
    s_add_u32 s44, s42, 524288
    buffer_load_dwordx4 v2, s[4:7], s44 offen sc1 lds
    s_add_u32 s43, s43, 1
    s_and_b32 s43, s43, 31
    s_waitcnt vmcnt(18)
    s_barrier
    s_add_u32 s64, s40, 50339840
    s_addc_u32 s65, s41, 0
    s_mov_b32 s66, 2048
    s_mov_b32 s67, 0x20000
    s_lshl_b32 s44, s24, 3
    s_add_u32 s44, s44, s25
    s_lshl_b32 s44, s44, 1
    s_add_u32 s44, s44, s27
    s_lshl_b32 s44, s44, 6
    s_add_u32 s44, s44, 0
    v_lshlrev_b32 v14, 2, v1
    s_mov_b32 s49, 0
    s_mov_b64 exec, 0xff
L_ppoll_9:
    buffer_load_dword v15, v14, s[64:67], s44 offen sc1
    s_waitcnt vmcnt(0)
    v_cmp_ne_u32 vcc, s91, v15
    s_add_u32 s49, s49, 1
    s_cbranch_vccz L_pgot_10
    s_sleep 4
    s_cmp_lt_u32 s49, 300000
    s_cbranch_scc1 L_ppoll_9
L_pgot_10:
    s_mov_b64 exec, -1
    s_mov_b32 s43, 8
    s_lshl_b32 s42, s43, 7
    s_add_u32 s42, s42, s46
    s_add_u32 m0, s47, 0
    s_add_u32 s44, s42, 0
    buffer_load_dwordx4 v2, s[4:7], s44 offen sc1 lds
    s_add_u32 m0, s47, 1024
    s_add_u32 s44, s42, 65536
    buffer_load_dwordx4 v3, s[4:7], s44 offen sc1 lds
    s_add_u32 m0, s47, 2048
    s_add_u32 s44, s42, 131072
    buffer_load_dwordx4 v2, s[4:7], s44 offen sc1 lds
    s_add_u32 m0, s47, 3072
    s_add_u32 s44, s42, 196608
    buffer_load_dwordx4 v3, s[4:7], s44 offen sc1 lds
    s_add_u32 m0, s47, 4096
    s_add_u32 s44, s42, 262144
    buffer_load_dwordx4 v2, s[4:7], s44 offen sc1 lds
    s_add_u32 m0, s47, 5120
    s_add_u32 s44, s42, 327680
    buffer_load_dwordx4 v3, s[4:7], s44 offen sc1 lds
    s_add_u32 m0, s47, 6144
    s_add_u32 s44, s42, 393216
    buffer_load_dwordx4 v2, s[4:7], s44 offen sc1 lds
    s_add_u32 m0, s47, 7168
    s_add_u32 s44, s42, 458752
    buffer_load_dwordx4 v3, s[4:7], s44 offen sc1 lds
    s_add_u32 m0, s47, 8192
    s_add_u32 s44, s42, 524288
    buffer_load_dwordx4 v2, s[4:7], s44 offen sc1 lds
    s_add_u32 s43, s43, 1
    s_and_b32 s43, s43, 31
    s_waitcnt vmcnt(18)
    s_barrier
    s_mov_b32 s43, 9
    s_lshl_b32 s42, s43, 7
    s_add_u32 s42, s42, s46
    s_add_u32 m0, s47, 34816
    s_add_u32 s44, s42, 0
    buffer_load_dwordx4 v2, s[4:7], s44 offen sc1 lds
    s_add_u32 m0, s47, 35840
    s_add_u32 s44, s42, 65536
    buffer_load_dwordx4 v3, s[4:7], s44 offen sc1 lds
    s_add_u32 m0, s47, 36864
    s_add_u32 s44, s42, 131072
    buffer_load_dwordx4 v2, s[4:7], s44 offen sc1 lds
    s_add_u32 m0, s47, 37888
    s_add_u32 s44, s42, 196608
    buffer_load_dwordx4 v3, s[4:7], s44 offen sc1 lds
    s_add_u32 m0, s47, 38912
    s_add_u32 s44, s42, 262144
    buffer_load_dwordx4 v2, s[4:7], s44 offen sc1 lds
    s_add_u32 m0, s47, 39936
    s_add_u32 s44, s42, 327680
    buffer_load_dwordx4 v3, s[4:7], s44 offen sc1 lds
    s_add_u32 m0, s47, 40960
    s_add_u32 s44, s42, 393216
    buffer_load_dwordx4 v2, s[4:7], s44 offen sc1 lds
    s_add_u32 m0, s47, 41984
    s_add_u32 s44, s42, 458752
    buffer_load_dwordx4 v3, s[4:7], s44 offen sc1 lds
    s_add_u32 m0, s47, 43008
    s_add_u32 s44, s42, 524288
    buffer_load_dwordx4 v2, s[4:7], s44 offen sc1 lds
    s_add_u32 s43, s43, 1
    s_and_b32 s43, s43, 31
    s_waitcnt vmcnt(18)
    s_barrier
    s_mov_b32 s43, 10
    s_lshl_b32 s42, s43, 7
    s_add_u32 s42, s42, s46
    s_add_u32 m0, s47, 69632
    s_add_u32 s44, s42, 0
    buffer_load_dwordx4 v2, s[4:7], s44 offen sc1 lds
    s_add_u32 m0, s47, 70656
    s_add_u32 s44, s42, 65536
    buffer_load_dwordx4 v3, s[4:7], s44 offen sc1 lds
    s_add_u32 m0, s47, 71680
    s_add_u32 s44, s42, 131072
    buffer_load_dwordx4 v2, s[4:7], s44 offen sc1 lds
    s_add_u32 m0, s47, 72704
    s_add_u32 s44, s42, 196608
    buffer_load_dwordx4 v3, s[4:7], s44 offen sc1 lds
    s_add_u32 m0, s47, 73728
    s_add_u32 s44, s42, 262144
    buffer_load_dwordx4 v2, s[4:7], s44 offen sc1 lds
    s_add_u32 m0, s47, 74752
    s_add_u32 s44, s42, 327680
    buffer_load_dwordx4 v3, s[4:7], s44 offen sc1 lds
    s_add_u32 m0, s47, 75776
    s_add_u32 s44, s42, 393216
    buffer_load_dwordx4 v2, s[4:7], s44 offen sc1 lds
    s_add_u32 m0, s47, 76800
    s_add_u32 s44, s42, 458752
    buffer_load_dwordx4 v3, s[4:7], s44 offen sc1 lds
    s_add_u32 m0, s47, 77824
    s_add_u32 s44, s42, 524288
    buffer_load_dwordx4 v2, s[4:7], s44 offen sc1 lds
    s_add_u32 s43, s43, 1
    s_and_b32 s43, s43, 31
    s_waitcnt vmcnt(18)
    s_barrier
    s_mov_b32 s43, 11
    s_lshl_b32 s42, s43, 7
    s_add_u32 s42, s42, s46
    s_add_u32 m0, s47, 104448
    s_add_u32 s44, s42, 0
    buffer_load_dwordx4 v2, s[4:7], s44 offen sc1 lds
    s_add_u32 m0, s47, 105472
    s_add_u32 s44, s42, 65536
    buffer_load_dwordx4 v3, s[4:7], s44 offen sc1 lds
    s_add_u32 m0, s47, 106496
    s_add_u32 s44, s42, 131072
    buffer_load_dwordx4 v2, s[4:7], s44 offen sc1 lds
    s_add_u32 m0, s47, 107520
    s_add_u32 s44, s42, 196608
    buffer_load_dwordx4 v3, s[4:7], s44 offen sc1 lds
    s_add_u32 m0, s47, 108544
    s_add_u32 s44, s42, 262144
    buffer_load_dwordx4 v2, s[4:7], s44 offen sc1 lds
    s_add_u32 m0, s47, 109568
    s_add_u32 s44, s42, 327680
    buffer_load_dwordx4 v3, s[4:7], s44 offen sc1 lds
    s_add_u32 m0, s47, 110592
    s_add_u32 s44, s42, 393216
    buffer_load_dwordx4 v2, s[4:7], s44 offen sc1 lds
    s_add_u32 m0, s47, 111616
    s_add_u32 s44, s42, 458752
    buffer_load_dwordx4 v3, s[4:7], s44 offen sc1 lds
    s_add_u32 m0, s47, 112640
    s_add_u32 s44, s42, 524288
    buffer_load_dwordx4 v2, s[4:7], s44 offen sc1 lds
    s_add_u32 s43, s43, 1
    s_and_b32 s43, s43, 31
    s_waitcnt vmcnt(18)
    s_barrier
    s_mov_b32 s43, 12
    s_lshl_b32 s42, s43, 7
    s_add_u32 s42, s42, s46
    s_add_u32 m0, s47, 0
    s_add_u32 s44, s42, 0
    buffer_load_dwordx4 v2, s[4:7], s44 offen sc1 lds
    s_add_u32 m0, s47, 1024
    s_add_u32 s44, s42, 65536
    buffer_load_dwordx4 v3, s[4:7], s44 offen sc1 lds
    s_add_u32 m0, s47, 2048
    s_add_u32 s44, s42, 131072
    buffer_load_dwordx4 v2, s[4:7], s44 offen sc1 lds
    s_add_u32 m0, s47, 3072
    s_add_u32 s44, s42, 196608
    buffer_load_dwordx4 v3, s[4:7], s44 offen sc1 lds
    s_add_u32 m0, s47, 4096
    s_add_u32 s44, s42, 262144
    buffer_load_dwordx4 v2, s[4:7], s44 offen sc1 lds
    s_add_u32 m0, s47, 5120
    s_add_u32 s44, s42, 327680
    buffer_load_dwordx4 v3, s[4:7], s44 offen sc1 lds
    s_add_u32 m0, s47, 6144
    s_add_u32 s44, s42, 393216
    buffer_load_dwordx4 v2, s[4:7], s44 offen sc1 lds
    s_add_u32 m0, s47, 7168
    s_add_u32 s44, s42, 458752
    buffer_load_dwordx4 v3, s[4:7], s44 offen sc1 lds
    s_add_u32 m0, s47, 8192
    s_add_u32 s44, s42, 524288
    buffer_load_dwordx4 v2, s[4:7], s44 offen sc1 lds
    s_add_u32 s43, s43, 1
    s_and_b32 s43, s43, 31
    s_waitcnt vmcnt(18)
    s_barrier
    s_mov_b32 s43, 13
    s_lshl_b32 s42, s43, 7
    s_add_u32 s42, s42, s46
    s_add_u32 m0, s47, 34816
    s_add_u32 s44, s42, 0
    buffer_load_dwordx4 v2, s[4:7], s44 offen sc1 lds
    s_add_u32 m0, s47, 35840
    s_add_u32 s44, s42, 65536
    buffer_load_dwordx4 v3, s[4:7], s44 offen sc1 lds
    s_add_u32 m0, s47, 36864
    s_add_u32 s44, s42, 131072
    buffer_load_dwordx4 v2, s[4:7], s44 offen sc1 lds
    s_add_u32 m0, s47, 37888
    s_add_u32 s44, s42, 196608
    buffer_load_dwordx4 v3, s[4:7], s44 offen sc1 lds
    s_add_u32 m0, s47, 38912
    s_add_u32 s44, s42, 262144
    buffer_load_dwordx4 v2, s[4:7], s44 offen sc1 lds
    s_add_u32 m0, s47, 39936
    s_add_u32 s44, s42, 327680
    buffer_load_dwordx4 v3, s[4:7], s44 offen sc1 lds
    s_add_u32 m0, s47, 40960
    s_add_u32 s44, s42, 393216
    buffer_load_dwordx4 v2, s[4:7], s44 offen sc1 lds
    s_add_u32 m0, s47, 41984
    s_add_u32 s44, s42, 458752
    buffer_load_dwordx4 v3, s[4:7], s44 offen sc1 lds
    s_add_u32 m0, s47, 43008
    s_add_u32 s44, s42, 524288
    buffer_load_dwordx4 v2, s[4:7], s44 offen sc1 lds
    s_add_u32 s43, s43, 1
    s_and_b32 s43, s43, 31
    s_waitcnt vmcnt(18)
    s_barrier
    s_mov_b32 s43, 14
    s_lshl_b32 s42, s43, 7
    s_add_u32 s42, s42, s46
    s_add_u32 m0, s47, 69632
    s_add_u32 s44, s42, 0
    buffer_load_dwordx4 v2, s[4:7], s44 offen sc1 lds
    s_add_u32 m0, s47, 70656
    s_add_u32 s44, s42, 65536
    buffer_load_dwordx4 v3, s[4:7], s44 offen sc1 lds
    s_add_u32 m0, s47, 71680
    s_add_u32 s44, s42, 131072
    buffer_load_dwordx4 v2, s[4:7], s44 offen sc1 lds
    s_add_u32 m0, s47, 72704
    s_add_u32 s44, s42, 196608
    buffer_load_dwordx4 v3, s[4:7], s44 offen sc1 lds
    s_add_u32 m0, s47, 73728
    s_add_u32 s44, s42, 262144
    buffer_load_dwordx4 v2, s[4:7], s44 offen sc1 lds
    s_add_u32 m0, s47, 74752
    s_add_u32 s44, s42, 327680
    buffer_load_dwordx4 v3, s[4:7], s44 offen sc1 lds
    s_add_u32 m0, s47, 75776
    s_add_u32 s44, s42, 393216
    buffer_load_dwordx4 v2, s[4:7], s44 offen sc1 lds
    s_add_u32 m0, s47, 76800
    s_add_u32 s44, s42, 458752
    buffer_load_dwordx4 v3, s[4:7], s44 offen sc1 lds
    s_add_u32 m0, s47, 77824
    s_add_u32 s44, s42, 524288
    buffer_load_dwordx4 v2, s[4:7], s44 offen sc1 lds
    s_add_u32 s43, s43, 1
    s_and_b32 s43, s43, 31
    s_waitcnt vmcnt(18)
    s_barrier
    s_mov_b32 s43, 15
    s_lshl_b32 s42, s43, 7
    s_add_u32 s42, s42, s46
    s_add_u32 m0, s47, 104448
    s_add_u32 s44, s42, 0
    buffer_load_dwordx4 v2, s[4:7], s44 offen sc1 lds
    s_add_u32 m0, s47, 105472
    s_add_u32 s44, s42, 65536
    buffer_load_dwordx4 v3, s[4:7], s44 offen sc1 lds
    s_add_u32 m0, s47, 106496
    s_add_u32 s44, s42, 131072
    buffer_load_dwordx4 v2, s[4:7], s44 offen sc1 lds
    s_add_u32 m0, s47, 107520
    s_add_u32 s44, s42, 196608
    buffer_load_dwordx4 v3, s[4:7], s44 offen sc1 lds
    s_add_u32 m0, s47, 108544
    s_add_u32 s44, s42, 262144
    buffer_load_dwordx4 v2, s[4:7], s44 offen sc1 lds
    s_add_u32 m0, s47, 109568
    s_add_u32 s44, s42, 327680
    buffer_load_dwordx4 v3, s[4:7], s44 offen sc1 lds
    s_add_u32 m0, s47, 110592
    s_add_u32 s44, s42, 393216
    buffer_load_dwordx4 v2, s[4:7], s44 offen sc1 lds
    s_add_u32 m0, s47, 111616
    s_add_u32 s44, s42, 458752
    buffer_load_dwordx4 v3, s[4:7], s44 offen sc1 lds
    s_add_u32 m0, s47, 112640
    s_add_u32 s44, s42, 524288
    buffer_load_dwordx4 v2, s[4:7], s44 offen sc1 lds
    s_add_u32 s43, s43, 1
    s_and_b32 s43, s43, 31
    s_waitcnt vmcnt(18)
    s_barrier
    s_mov_b32 s43, 24
    s_lshl_b32 s42, s43, 7
    s_add_u32 s42, s42, s46
    s_add_u32 m0, s47, 0
    s_add_u32 s44, s42, 0
    buffer_load_dwordx4 v2, s[4:7], s44 offen sc1 lds
    s_add_u32 m0, s47, 1024
    s_add_u32 s44, s42, 65536
    buffer_load_dwordx4 v3, s[4:7], s44 offen sc1 lds
    s_add_u32 m0, s47, 2048
    s_add_u32 s44, s42, 131072
    buffer_load_dwordx4 v2, s[4:7], s44 offen sc1 lds
    s_add_u32 m0, s47, 3072
    s_add_u32 s44, s42, 196608
    buffer_load_dwordx4 v3, s[4:7], s44 offen sc1 lds
    s_add_u32 m0, s47, 4096
    s_add_u32 s44, s42, 262144
    buffer_load_dwordx4 v2, s[4:7], s44 offen sc1 lds
    s_add_u32 m0, s47, 5120
    s_add_u32 s44, s42, 327680
    buffer_load_dwordx4 v3, s[4:7], s44 offen sc1 lds
    s_add_u32 m0, s47, 6144
    s_add_u32 s44, s42, 393216
    buffer_load_dwordx4 v2, s[4:7], s44 offen sc1 lds
    s_add_u32 m0, s47, 7168
    s_add_u32 s44, s42, 458752
    buffer_load_dwordx4 v3, s[4:7], s44 offen sc1 lds
    s_add_u32 m0, s47, 8192
    s_add_u32 s44, s42, 524288
    buffer_load_dwordx4 v2, s[4:7], s44 offen sc1 lds
    s_add_u32 s43, s43, 1
    s_and_b32 s43, s43, 31
    s_waitcnt vmcnt(18)
    s_barrier
    s_mov_b32 s43, 25
    s_lshl_b32 s42, s43, 7
    s_add_u32 s42, s42, s46
    s_add_u32 m0, s47, 34816
    s_add_u32 s44, s42, 0
    buffer_load_dwordx4 v2, s[4:7], s44 offen sc1 lds
    s_add_u32 m0, s47, 35840
    s_add_u32 s44, s42, 65536
    buffer_load_dwordx4 v3, s[4:7], s44 offen sc1 lds
    s_add_u32 m0, s47, 36864
    s_add_u32 s44, s42, 131072
    buffer_load_dwordx4 v2, s[4:7], s44 offen sc1 lds
    s_add_u32 m0, s47, 37888
    s_add_u32 s44, s42, 196608
    buffer_load_dwordx4 v3, s[4:7], s44 offen sc1 lds
    s_add_u32 m0, s47, 38912
    s_add_u32 s44, s42, 262144
    buffer_load_dwordx4 v2, s[4:7], s44 offen sc1 lds
    s_add_u32 m0, s47, 39936
    s_add_u32 s44, s42, 327680
    buffer_load_dwordx4 v3, s[4:7], s44 offen sc1 lds
    s_add_u32 m0, s47, 40960
    s_add_u32 s44, s42, 393216
    buffer_load_dwordx4 v2, s[4:7], s44 offen sc1 lds
    s_add_u32 m0, s47, 41984
    s_add_u32 s44, s42, 458752
    buffer_load_dwordx4 v3, s[4:7], s44 offen sc1 lds
    s_add_u32 m0, s47, 43008
    s_add_u32 s44, s42, 524288
    buffer_load_dwordx4 v2, s[4:7], s44 offen sc1 lds
    s_add_u32 s43, s43, 1
    s_and_b32 s43, s43, 31
    s_waitcnt vmcnt(18)
    s_barrier
    s_mov_b32 s43, 26
    s_lshl_b32 s42, s43, 7
    s_add_u32 s42, s42, s46
    s_add_u32 m0, s47, 69632
    s_add_u32 s44, s42, 0
    buffer_load_dwordx4 v2, s[4:7], s44 offen sc1 lds
    s_add_u32 m0, s47, 70656
    s_add_u32 s44, s42, 65536
    buffer_load_dwordx4 v3, s[4:7], s44 offen sc1 lds
    s_add_u32 m0, s47, 71680
    s_add_u32 s44, s42, 131072
    buffer_load_dwordx4 v2, s[4:7], s44 offen sc1 lds
    s_add_u32 m0, s47, 72704
    s_add_u32 s44, s42, 196608
    buffer_load_dwordx4 v3, s[4:7], s44 offen sc1 lds
    s_add_u32 m0, s47, 73728
    s_add_u32 s44, s42, 262144
    buffer_load_dwordx4 v2, s[4:7], s44 offen sc1 lds
    s_add_u32 m0, s47, 74752
    s_add_u32 s44, s42, 327680
    buffer_load_dwordx4 v3, s[4:7], s44 offen sc1 lds
    s_add_u32 m0, s47, 75776
    s_add_u32 s44, s42, 393216
    buffer_load_dwordx4 v2, s[4:7], s44 offen sc1 lds
    s_add_u32 m0, s47, 76800
    s_add_u32 s44, s42, 458752
    buffer_load_dwordx4 v3, s[4:7], s44 offen sc1 lds
    s_add_u32 m0, s47, 77824
    s_add_u32 s44, s42, 524288
    buffer_load_dwordx4 v2, s[4:7], s44 offen sc1 lds
    s_add_u32 s43, s43, 1
    s_and_b32 s43, s43, 31
    s_waitcnt vmcnt(18)
    s_barrier
    s_mov_b32 s43, 27
    s_lshl_b32 s42, s43, 7
    s_add_u32 s42, s42, s46
    s_add_u32 m0, s47, 104448
    s_add_u32 s44, s42, 0
    buffer_load_dwordx4 v2, s[4:7], s44 offen sc1 lds
    s_add_u32 m0, s47, 105472
    s_add_u32 s44, s42, 65536
    buffer_load_dwordx4 v3, s[4:7], s44 offen sc1 lds
    s_add_u32 m0, s47, 106496
    s_add_u32 s44, s42, 131072
    buffer_load_dwordx4 v2, s[4:7], s44 offen sc1 lds
    s_add_u32 m0, s47, 107520
    s_add_u32 s44, s42, 196608
    buffer_load_dwordx4 v3, s[4:7], s44 offen sc1 lds
    s_add_u32 m0, s47, 108544
    s_add_u32 s44, s42, 262144
    buffer_load_dwordx4 v2, s[4:7], s44 offen sc1 lds
    s_add_u32 m0, s47, 109568
    s_add_u32 s44, s42, 327680
    buffer_load_dwordx4 v3, s[4:7], s44 offen sc1 lds
    s_add_u32 m0, s47, 110592
    s_add_u32 s44, s42, 393216
    buffer_load_dwordx4 v2, s[4:7], s44 offen sc1 lds
    s_add_u32 m0, s47, 111616
    s_add_u32 s44, s42, 458752
    buffer_load_dwordx4 v3, s[4:7], s44 offen sc1 lds
    s_add_u32 m0, s47, 112640
    s_add_u32 s44, s42, 524288
    buffer_load_dwordx4 v2, s[4:7], s44 offen sc1 lds
    s_add_u32 s43, s43, 1
    s_and_b32 s43, s43, 31
    s_waitcnt vmcnt(18)
    s_barrier
    s_mov_b32 s43, 28
    s_lshl_b32 s42, s43, 7
    s_add_u32 s42, s42, s46
    s_add_u32 m0, s47, 0
    s_add_u32 s44, s42, 0
    buffer_load_dwordx4 v2, s[4:7], s44 offen sc1 lds
    s_add_u32 m0, s47, 1024
    s_add_u32 s44, s42, 65536
    buffer_load_dwordx4 v3, s[4:7], s44 offen sc1 lds
    s_add_u32 m0, s47, 2048
    s_add_u32 s44, s42, 131072
    buffer_load_dwordx4 v2, s[4:7], s44 offen sc1 lds
    s_add_u32 m0, s47, 3072
    s_add_u32 s44, s42, 196608
    buffer_load_dwordx4 v3, s[4:7], s44 offen sc1 lds
    s_add_u32 m0, s47, 4096
    s_add_u32 s44, s42, 262144
    buffer_load_dwordx4 v2, s[4:7], s44 offen sc1 lds
    s_add_u32 m0, s47, 5120
    s_add_u32 s44, s42, 327680
    buffer_load_dwordx4 v3, s[4:7], s44 offen sc1 lds
    s_add_u32 m0, s47, 6144
    s_add_u32 s44, s42, 393216
    buffer_load_dwordx4 v2, s[4:7], s44 offen sc1 lds
    s_add_u32 m0, s47, 7168
    s_add_u32 s44, s42, 458752
    buffer_load_dwordx4 v3, s[4:7], s44 offen sc1 lds
    s_add_u32 m0, s47, 8192
    s_add_u32 s44, s42, 524288
    buffer_load_dwordx4 v2, s[4:7], s44 offen sc1 lds
    s_add_u32 s43, s43, 1
    s_and_b32 s43, s43, 31
    s_waitcnt vmcnt(18)
    s_barrier
    s_mov_b32 s43, 29
    s_lshl_b32 s42, s43, 7
    s_add_u32 s42, s42, s46
    s_add_u32 m0, s47, 34816
    s_add_u32 s44, s42, 0
    buffer_load_dwordx4 v2, s[4:7], s44 offen sc1 lds
    s_add_u32 m0, s47, 35840
    s_add_u32 s44, s42, 65536
    buffer_load_dwordx4 v3, s[4:7], s44 offen sc1 lds
    s_add_u32 m0, s47, 36864
    s_add_u32 s44, s42, 131072
    buffer_load_dwordx4 v2, s[4:7], s44 offen sc1 lds
    s_add_u32 m0, s47, 37888
    s_add_u32 s44, s42, 196608
    buffer_load_dwordx4 v3, s[4:7], s44 offen sc1 lds
    s_add_u32 m0, s47, 38912
    s_add_u32 s44, s42, 262144
    buffer_load_dwordx4 v2, s[4:7], s44 offen sc1 lds
    s_add_u32 m0, s47, 39936
    s_add_u32 s44, s42, 327680
    buffer_load_dwordx4 v3, s[4:7], s44 offen sc1 lds
    s_add_u32 m0, s47, 40960
    s_add_u32 s44, s42, 393216
    buffer_load_dwordx4 v2, s[4:7], s44 offen sc1 lds
    s_add_u32 m0, s47, 41984
    s_add_u32 s44, s42, 458752
    buffer_load_dwordx4 v3, s[4:7], s44 offen sc1 lds
    s_add_u32 m0, s47, 43008
    s_add_u32 s44, s42, 524288
    buffer_load_dwordx4 v2, s[4:7], s44 offen sc1 lds
    s_add_u32 s43, s43, 1
    s_and_b32 s43, s43, 31
    s_waitcnt vmcnt(18)
    s_barrier
    s_mov_b32 s43, 30
    s_lshl_b32 s42, s43, 7
    s_add_u32 s42, s42, s46
    s_add_u32 m0, s47, 69632
    s_add_u32 s44, s42, 0
    buffer_load_dwordx4 v2, s[4:7], s44 offen sc1 lds
    s_add_u32 m0, s47, 70656
    s_add_u32 s44, s42, 65536
    buffer_load_dwordx4 v3, s[4:7], s44 offen sc1 lds
    s_add_u32 m0, s47, 71680
    s_add_u32 s44, s42, 131072
    buffer_load_dwordx4 v2, s[4:7], s44 offen sc1 lds
    s_add_u32 m0, s47, 72704
    s_add_u32 s44, s42, 196608
    buffer_load_dwordx4 v3, s[4:7], s44 offen sc1 lds
    s_add_u32 m0, s47, 73728
    s_add_u32 s44, s42, 262144
    buffer_load_dwordx4 v2, s[4:7], s44 offen sc1 lds
    s_add_u32 m0, s47, 74752
    s_add_u32 s44, s42, 327680
    buffer_load_dwordx4 v3, s[4:7], s44 offen sc1 lds
    s_add_u32 m0, s47, 75776
    s_add_u32 s44, s42, 393216
    buffer_load_dwordx4 v2, s[4:7], s44 offen sc1 lds
    s_add_u32 m0, s47, 76800
    s_add_u32 s44, s42, 458752
    buffer_load_dwordx4 v3, s[4:7], s44 offen sc1 lds
    s_add_u32 m0, s47, 77824
    s_add_u32 s44, s42, 524288
    buffer_load_dwordx4 v2, s[4:7], s44 offen sc1 lds
    s_add_u32 s43, s43, 1
    s_and_b32 s43, s43, 31
    s_waitcnt vmcnt(18)
    s_barrier
    s_mov_b32 s43, 31
    s_lshl_b32 s42, s43, 7
    s_add_u32 s42, s42, s46
    s_add_u32 m0, s47, 104448
    s_add_u32 s44, s42, 0
    buffer_load_dwordx4 v2, s[4:7], s44 offen sc1 lds
    s_add_u32 m0, s47, 105472
    s_add_u32 s44, s42, 65536
    buffer_load_dwordx4 v3, s[4:7], s44 offen sc1 lds
    s_add_u32 m0, s47, 106496
    s_add_u32 s44, s42, 131072
    buffer_load_dwordx4 v2, s[4:7], s44 offen sc1 lds
    s_add_u32 m0, s47, 107520
    s_add_u32 s44, s42, 196608
    buffer_load_dwordx4 v3, s[4:7], s44 offen sc1 lds
    s_add_u32 m0, s47, 108544
    s_add_u32 s44, s42, 262144
    buffer_load_dwordx4 v2, s[4:7], s44 offen sc1 lds
    s_add_u32 m0, s47, 109568
    s_add_u32 s44, s42, 327680
    buffer_load_dwordx4 v3, s[4:7], s44 offen sc1 lds
    s_add_u32 m0, s47, 110592
    s_add_u32 s44, s42, 393216
    buffer_load_dwordx4 v2, s[4:7], s44 offen sc1 lds
    s_add_u32 m0, s47, 111616
    s_add_u32 s44, s42, 458752
    buffer_load_dwordx4 v3, s[4:7], s44 offen sc1 lds
    s_add_u32 m0, s47, 112640
    s_add_u32 s44, s42, 524288
    buffer_load_dwordx4 v2, s[4:7], s44 offen sc1 lds
    s_add_u32 s43, s43, 1
    s_and_b32 s43, s43, 31
    s_waitcnt vmcnt(18)
    s_barrier
    s_waitcnt vmcnt(9)
    s_barrier
    s_waitcnt vmcnt(0)
    s_barrier
    s_endpgm
L_k1_compute:
    s_mov_b32 s44, 0x3f803f80
    v_mov_b32 v24, s44
    v_mov_b32 v25, s44
    v_mov_b32 v26, s44
    v_mov_b32 v27, s44
    s_mov_b32 s80, 16384
    s_mov_b32 s81, 0xffff0000
    s_lshl_b32 s53, s3, 1
    s_cmp_eq_u32 s3, 4
    s_cbranch_scc1 L_k1_w4
    v_lshrrev_b32 v14, 4, v1
    v_and_b32 v15, 15, v1
    v_lshrrev_b32 v16, 1, v15
    v_xor_b32 v16, v16, v14
    v_lshlrev_b32 v16, 4, v16
    v_lshl_add_u32 v2, v15, 7, v16
    v_xor_b32 v3, 64, v2
    v_lshrrev_b32 v16, 2, v15
    v_and_b32 v17, 1, v14
    v_lshl_add_u32 v17, v17, 2, v16
    s_lshl_b32 s44, s3, 1
    v_xor_b32 v18, s44, v17
    v_lshlrev_b32 v18, 5, v18
    v_lshl_add_u32 v18, v14, 11, v18
    v_lshl_add_u32 v18, v16, 8, v18
    v_and_b32 v19, 3, v15
    v_lshl_add_u32 v18, v19, 3, v18
    s_mov_b32 s45, 18432
    v_add_u32 v4, s45, v18
    v_xor_b32 v5, 32, v4
    v_mov_b32 v28, 0
    v_mov_b32 v29, 0
    v_mov_b32 v30, 0
    v_mov_b32 v31, 0
    v_mov_b32 v32, 0
    v_mov_b32 v33, 0
    v_mov_b32 v34, 0
    v_mov_b32 v35, 0
    v_mov_b32 v36, 0
    v_mov_b32 v37, 0
    v_mov_b32 v38, 0
    v_mov_b32 v39, 0
    v_mov_b32 v40, 0
    v_mov_b32 v41, 0
    v_mov_b32 v42, 0
    v_mov_b32 v43, 0
    v_mov_b32 v44, 0
    v_mov_b32 v45, 0
    v_mov_b32 v46, 0
    v_mov_b32 v47, 0
    v_mov_b32 v48, 0
    v_mov_b32 v49, 0
    v_mov_b32 v50, 0
    v_mov_b32 v51, 0
    v_mov_b32 v52, 0
    v_mov_b32 v53, 0
    v_mov_b32 v54, 0
    v_mov_b32 v55, 0
    v_mov_b32 v56, 0
    v_mov_b32 v57, 0
    v_mov_b32 v58, 0
    v_mov_b32 v59, 0
    v_mov_b32 v60, 0
    v_mov_b32 v61, 0
    v_mov_b32 v62, 0
    v_mov_b32 v63, 0
    v_mov_b32 v64, 0
    v_mov_b32 v65, 0
    v_mov_b32 v66, 0
    v_mov_b32 v67, 0
    v_mov_b32 v68, 0
    v_mov_b32 v69, 0
    v_mov_b32 v70, 0
    v_mov_b32 v71, 0
    v_mov_b32 v72, 0
    v_mov_b32 v73, 0
    v_mov_b32 v74, 0
    v_mov_b32 v75, 0
    v_mov_b32 v76, 0
    v_mov_b32 v77, 0
    v_mov_b32 v78, 0
    v_mov_b32 v79, 0
    v_mov_b32 v80, 0
    v_mov_b32 v81, 0
    v_mov_b32 v82, 0
    v_mov_b32 v83, 0
    v_mov_b32 v84, 0
    v_mov_b32 v85, 0
    v_mov_b32 v86, 0
    v_mov_b32 v87, 0
    v_mov_b32 v88, 0
    v_mov_b32 v89, 0
    v_mov_b32 v90, 0
    v_mov_b32 v91, 0
    v_mov_b32 v92, 0
    v_mov_b32 v93, 0
    v_mov_b32 v94, 0
    v_mov_b32 v95, 0
    v_mov_b32 v96, 0
    v_mov_b32 v97, 0
    v_mov_b32 v98, 0
    v_mov_b32 v99, 0
    s_barrier
    ds_read_b128 v[172:175], v2 offset:0
    ds_read_b64_tr_b16 v[208:209], v4 offset:0
    ds_read_b64_tr_b16 v[210:211], v4 offset:1024
    ds_read_b128 v[176:179], v2 offset:2048
    ds_read_b64_tr_b16 v[212:213], v5 offset:0
    ds_read_b64_tr_b16 v[214:215], v5 offset:1024
    ds_read_b128 v[180:183], v2 offset:4096
    ds_read_b128 v[184:187], v2 offset:6144
    ds_read_b128 v[188:191], v2 offset:8192
    ds_read_b128 v[192:195], v2 offset:10240
    ds_read_b128 v[196:199], v2 offset:12288
    ds_read_b128 v[200:203], v2 offset:14336
    ds_read_b128 v[204:207], v2 offset:16384
    s_mov_b32 s49, 0
L_gloop_11:
    s_waitcnt lgkmcnt(7)
    v_mfma_f32_16x16x32_bf16 v[28:31], v[208:211], v[172:175], v[28:31]
    v_mfma_f32_16x16x32_bf16 v[64:67], v[212:215], v[172:175], v[64:67]
    ds_read_b128 v[172:175], v3 offset:0
    ds_read_b64_tr_b16 v[224:225], v4 offset:8192
    ds_read_b64_tr_b16 v[226:227], v4 offset:9216
    s_waitcnt lgkmcnt(12)
    v_mfma_f32_16x16x32_bf16 v[32:35], v[208:211], v[176:179], v[32:35]
    v_mfma_f32_16x16x32_bf16 v[68:71], v[212:215], v[176:179], v[68:71]
    ds_read_b128 v[176:179], v3 offset:2048
    ds_read_b64_tr_b16 v[228:229], v5 offset:8192
    ds_read_b64_tr_b16 v[230:231], v5 offset:9216
    s_waitcnt lgkmcnt(12)
    v_mfma_f32_16x16x32_bf16 v[36:39], v[208:211], v[180:183], v[36:39]
    v_mfma_f32_16x16x32_bf16 v[72:75], v[212:215], v[180:183], v[72:75]
    ds_read_b128 v[180:183], v3 offset:4096
    s_waitcnt lgkmcnt(12)
    v_mfma_f32_16x16x32_bf16 v[40:43], v[208:211], v[184:187], v[40:43]
    v_mfma_f32_16x16x32_bf16 v[76:79], v[212:215], v[184:187], v[76:79]
    ds_read_b128 v[184:187], v3 offset:6144
    s_waitcnt lgkmcnt(12)
    v_mfma_f32_16x16x32_bf16 v[44:47], v[208:211], v[188:191], v[44:47]
    v_mfma_f32_16x16x32_bf16 v[80:83], v[212:215], v[188:191], v[80:83]
    ds_read_b128 v[188:191], v3 offset:8192
    s_waitcnt lgkmcnt(12)
    v_mfma_f32_16x16x32_bf16 v[48:51], v[208:211], v[192:195], v[48:51]
    v_mfma_f32_16x16x32_bf16 v[84:87], v[212:215], v[192:195], v[84:87]
    ds_read_b128 v[192:195], v3 offset:10240
    s_waitcnt lgkmcnt(12)
    v_mfma_f32_16x16x32_bf16 v[52:55], v[208:211], v[196:199], v[52:55]
    v_mfma_f32_16x16x32_bf16 v[88:91], v[212:215], v[196:199], v[88:91]
    ds_read_b128 v[196:199], v3 offset:12288
    s_waitcnt lgkmcnt(12)
    v_mfma_f32_16x16x32_bf16 v[56:59], v[208:211], v[200:203], v[56:59]
    v_mfma_f32_16x16x32_bf16 v[92:95], v[212:215], v[200:203], v[92:95]
    ds_read_b128 v[200:203], v3 offset:14336
    s_waitcnt lgkmcnt(12)
    v_mfma_f32_16x16x32_bf16 v[60:63], v[208:211], v[204:207], v[60:63]
    v_mfma_f32_16x16x32_bf16 v[96:99], v[212:215], v[204:207], v[96:99]
    ds_read_b128 v[204:207], v3 offset:16384
    s_waitcnt lgkmcnt(7)
    v_mfma_f32_16x16x32_bf16 v[28:31], v[224:227], v[172:175], v[28:31]
    v_mfma_f32_16x16x32_bf16 v[64:67], v[228:231], v[172:175], v[64:67]
    s_waitcnt lgkmcnt(0)
    s_barrier
    v_add_u32 v2, 0x8800, v2
    v_add_u32 v3, 0x8800, v3
    v_add_u32 v4, 0x8800, v4
    v_add_u32 v5, 0x8800, v5
    ds_read_b128 v[172:175], v2 offset:0
    ds_read_b64_tr_b16 v[208:209], v4 offset:0
    ds_read_b64_tr_b16 v[210:211], v4 offset:1024
    v_mfma_f32_16x16x32_bf16 v[32:35], v[224:227], v[176:179], v[32:35]
    v_mfma_f32_16x16x32_bf16 v[68:71], v[228:231], v[176:179], v[68:71]
    ds_read_b128 v[176:179], v2 offset:2048
    ds_read_b64_tr_b16 v[212:213], v5 offset:0
    ds_read_b64_tr_b16 v[214:215], v5 offset:1024
    v_mfma_f32_16x16x32_bf16 v[36:39], v[224:227], v[180:183], v[36:39]
    v_mfma_f32_16x16x32_bf16 v[72:75], v[228:231], v[180:183], v[72:75]
    ds_read_b128 v[180:183], v2 offset:4096
    v_mfma_f32_16x16x32_bf16 v[40:43], v[224:227], v[184:187], v[40:43]
    v_mfma_f32_16x16x32_bf16 v[76:79], v[228:231], v[184:187], v[76:79]
    ds_read_b128 v[184:187], v2 offset:6144
    v_mfma_f32_16x16x32_bf16 v[44:47], v[224:227], v[188:191], v[44:47]
    v_mfma_f32_16x16x32_bf16 v[80:83], v[228:231], v[188:191], v[80:83]
    ds_read_b128 v[188:191], v2 offset:8192
    v_mfma_f32_16x16x32_bf16 v[48:51], v[224:227], v[192:195], v[48:51]
    v_mfma_f32_16x16x32_bf16 v[84:87], v[228:231], v[192:195], v[84:87]
    ds_read_b128 v[192:195], v2 offset:10240
    v_mfma_f32_16x16x32_bf16 v[52:55], v[224:227], v[196:199], v[52:55]
    v_mfma_f32_16x16x32_bf16 v[88:91], v[228:231], v[196:199], v[88:91]
    ds_read_b128 v[196:199], v2 offset:12288
    v_mfma_f32_16x16x32_bf16 v[56:59], v[224:227], v[200:203], v[56:59]
    v_mfma_f32_16x16x32_bf16 v[92:95], v[228:231], v[200:203], v[92:95]
    ds_read_b128 v[200:203], v2 offset:14336
    v_mfma_f32_16x16x32_bf16 v[60:63], v[224:227], v[204:207], v[60:63]
    v_mfma_f32_16x16x32_bf16 v[96:99], v[228:231], v[204:207], v[96:99]
    ds_read_b128 v[204:207], v2 offset:16384
    s_waitcnt lgkmcnt(7)
    v_mfma_f32_16x16x32_bf16 v[28:31], v[208:211], v[172:175], v[28:31]
    v_mfma_f32_16x16x32_bf16 v[64:67], v[212:215], v[172:175], v[64:67]
    ds_read_b128 v[172:175], v3 offset:0
    ds_read_b64_tr_b16 v[224:225], v4 offset:8192
    ds_read_b64_tr_b16 v[226:227], v4 offset:9216
    s_waitcnt lgkmcnt(12)
    v_mfma_f32_16x16x32_bf16 v[32:35], v[208:211], v[176:179], v[32:35]
    v_mfma_f32_16x16x32_bf16 v[68:71], v[212:215], v[176:179], v[68:71]
    ds_read_b128 v[176:179], v3 offset:2048
    ds_read_b64_tr_b16 v[228:229], v5 offset:8192
    ds_read_b64_tr_b16 v[230:231], v5 offset:9216
    s_waitcnt lgkmcnt(12)
    v_mfma_f32_16x16x32_bf16 v[36:39], v[208:211], v[180:183], v[36:39]
    v_mfma_f32_16x16x32_bf16 v[72:75], v[212:215], v[180:183], v[72:75]
    ds_read_b128 v[180:183], v3 offset:4096
    s_waitcnt lgkmcnt(12)
    v_mfma_f32_16x16x32_bf16 v[40:43], v[208:211], v[184:187], v[40:43]
    v_mfma_f32_16x16x32_bf16 v[76:79], v[212:215], v[184:187], v[76:79]
    ds_read_b128 v[184:187], v3 offset:6144
    s_waitcnt lgkmcnt(12)
    v_mfma_f32_16x16x32_bf16 v[44:47], v[208:211], v[188:191], v[44:47]
    v_mfma_f32_16x16x32_bf16 v[80:83], v[212:215], v[188:191], v[80:83]
    ds_read_b128 v[188:191], v3 offset:8192
    s_waitcnt lgkmcnt(12)
    v_mfma_f32_16x16x32_bf16 v[48:51], v[208:211], v[192:195], v[48:51]
    v_mfma_f32_16x16x32_bf16 v[84:87], v[212:215], v[192:195], v[84:87]
    ds_read_b128 v[192:195], v3 offset:10240
    s_waitcnt lgkmcnt(12)
    v_mfma_f32_16x16x32_bf16 v[52:55], v[208:211], v[196:199], v[52:55]
    v_mfma_f32_16x16x32_bf16 v[88:91], v[212:215], v[196:199], v[88:91]
    ds_read_b128 v[196:199], v3 offset:12288
    s_waitcnt lgkmcnt(12)
    v_mfma_f32_16x16x32_bf16 v[56:59], v[208:211], v[200:203], v[56:59]
    v_mfma_f32_16x16x32_bf16 v[92:95], v[212:215], v[200:203], v[92:95]
    ds_read_b128 v[200:203], v3 offset:14336
    s_waitcnt lgkmcnt(12)
    v_mfma_f32_16x16x32_bf16 v[60:63], v[208:211], v[204:207], v[60:63]
    v_mfma_f32_16x16x32_bf16 v[96:99], v[212:215], v[204:207], v[96:99]
    ds_read_b128 v[204:207], v3 offset:16384
    s_waitcnt lgkmcnt(7)
    v_mfma_f32_16x16x32_bf16 v[28:31], v[224:227], v[172:175], v[28:31]
    v_mfma_f32_16x16x32_bf16 v[64:67], v[228:231], v[172:175], v[64:67]
    s_waitcnt lgkmcnt(0)
    s_barrier
    v_add_u32 v2, 0x8800, v2
    v_add_u32 v3, 0x8800, v3
    v_add_u32 v4, 0x8800, v4
    v_add_u32 v5, 0x8800, v5
    ds_read_b128 v[172:175], v2 offset:0
    ds_read_b64_tr_b16 v[208:209], v4 offset:0
    ds_read_b64_tr_b16 v[210:211], v4 offset:1024
    v_mfma_f32_16x16x32_bf16 v[32:35], v[224:227], v[176:179], v[32:35]
    v_mfma_f32_16x16x32_bf16 v[68:71], v[228:231], v[176:179], v[68:71]
    ds_read_b128 v[176:179], v2 offset:2048
    ds_read_b64_tr_b16 v[212:213], v5 offset:0
    ds_read_b64_tr_b16 v[214:215], v5 offset:1024
    v_mfma_f32_16x16x32_bf16 v[36:39], v[224:227], v[180:183], v[36:39]
    v_mfma_f32_16x16x32_bf16 v[72:75], v[228:231], v[180:183], v[72:75]
    ds_read_b128 v[180:183], v2 offset:4096
    v_mfma_f32_16x16x32_bf16 v[40:43], v[224:227], v[184:187], v[40:43]
    v_mfma_f32_16x16x32_bf16 v[76:79], v[228:231], v[184:187], v[76:79]
    ds_read_b128 v[184:187], v2 offset:6144
    v_mfma_f32_16x16x32_bf16 v[44:47], v[224:227], v[188:191], v[44:47]
    v_mfma_f32_16x16x32_bf16 v[80:83], v[228:231], v[188:191], v[80:83]
    ds_read_b128 v[188:191], v2 offset:8192
    v_mfma_f32_16x16x32_bf16 v[48:51], v[224:227], v[192:195], v[48:51]
    v_mfma_f32_16x16x32_bf16 v[84:87], v[228:231], v[192:195], v[84:87]
    ds_read_b128 v[192:195], v2 offset:10240
    v_mfma_f32_16x16x32_bf16 v[52:55], v[224:227], v[196:199], v[52:55]
    v_mfma_f32_16x16x32_bf16 v[88:91], v[228:231], v[196:199], v[88:91]
    ds_read_b128 v[196:199], v2 offset:12288
    v_mfma_f32_16x16x32_bf16 v[56:59], v[224:227], v[200:203], v[56:59]
    v_mfma_f32_16x16x32_bf16 v[92:95], v[228:231], v[200:203], v[92:95]
    ds_read_b128 v[200:203], v2 offset:14336
    v_mfma_f32_16x16x32_bf16 v[60:63], v[224:227], v[204:207], v[60:63]
    v_mfma_f32_16x16x32_bf16 v[96:99], v[228:231], v[204:207], v[96:99]
    ds_read_b128 v[204:207], v2 offset:16384
    s_waitcnt lgkmcnt(7)
    v_mfma_f32_16x16x32_bf16 v[28:31], v[208:211], v[172:175], v[28:31]
    v_mfma_f32_16x16x32_bf16 v[64:67], v[212:215], v[172:175], v[64:67]
    ds_read_b128 v[172:175], v3 offset:0
    ds_read_b64_tr_b16 v[224:225], v4 offset:8192
    ds_read_b64_tr_b16 v[226:227], v4 offset:9216
    s_waitcnt lgkmcnt(12)
    v_mfma_f32_16x16x32_bf16 v[32:35], v[208:211], v[176:179], v[32:35]
    v_mfma_f32_16x16x32_bf16 v[68:71], v[212:215], v[176:179], v[68:71]
    ds_read_b128 v[176:179], v3 offset:2048
    ds_read_b64_tr_b16 v[228:229], v5 offset:8192
    ds_read_b64_tr_b16 v[230:231], v5 offset:9216
    s_waitcnt lgkmcnt(12)
    v_mfma_f32_16x16x32_bf16 v[36:39], v[208:211], v[180:183], v[36:39]
    v_mfma_f32_16x16x32_bf16 v[72:75], v[212:215], v[180:183], v[72:75]
    ds_read_b128 v[180:183], v3 offset:4096
    s_waitcnt lgkmcnt(12)
    v_mfma_f32_16x16x32_bf16 v[40:43], v[208:211], v[184:187], v[40:43]
    v_mfma_f32_16x16x32_bf16 v[76:79], v[212:215], v[184:187], v[76:79]
    ds_read_b128 v[184:187], v3 offset:6144
    s_waitcnt lgkmcnt(12)
    v_mfma_f32_16x16x32_bf16 v[44:47], v[208:211], v[188:191], v[44:47]
    v_mfma_f32_16x16x32_bf16 v[80:83], v[212:215], v[188:191], v[80:83]
    ds_read_b128 v[188:191], v3 offset:8192
    s_waitcnt lgkmcnt(12)
    v_mfma_f32_16x16x32_bf16 v[48:51], v[208:211], v[192:195], v[48:51]
    v_mfma_f32_16x16x32_bf16 v[84:87], v[212:215], v[192:195], v[84:87]
    ds_read_b128 v[192:195], v3 offset:10240
    s_waitcnt lgkmcnt(12)
    v_mfma_f32_16x16x32_bf16 v[52:55], v[208:211], v[196:199], v[52:55]
    v_mfma_f32_16x16x32_bf16 v[88:91], v[212:215], v[196:199], v[88:91]
    ds_read_b128 v[196:199], v3 offset:12288
    s_waitcnt lgkmcnt(12)
    v_mfma_f32_16x16x32_bf16 v[56:59], v[208:211], v[200:203], v[56:59]
    v_mfma_f32_16x16x32_bf16 v[92:95], v[212:215], v[200:203], v[92:95]
    ds_read_b128 v[200:203], v3 offset:14336
    s_waitcnt lgkmcnt(12)
    v_mfma_f32_16x16x32_bf16 v[60:63], v[208:211], v[204:207], v[60:63]
    v_mfma_f32_16x16x32_bf16 v[96:99], v[212:215], v[204:207], v[96:99]
    ds_read_b128 v[204:207], v3 offset:16384
    s_waitcnt lgkmcnt(7)
    v_mfma_f32_16x16x32_bf16 v[28:31], v[224:227], v[172:175], v[28:31]
    v_mfma_f32_16x16x32_bf16 v[64:67], v[228:231], v[172:175], v[64:67]
    s_waitcnt lgkmcnt(0)
    s_barrier
    v_add_u32 v2, 0xfffef000, v2
    v_add_u32 v3, 0xfffef000, v3
    v_add_u32 v4, 0xfffef000, v4
    v_add_u32 v5, 0xfffef000, v5
    ds_read_b128 v[172:175], v2 offset:0
    ds_read_b64_tr_b16 v[208:209], v4 offset:0
    ds_read_b64_tr_b16 v[210:211], v4 offset:1024
    v_mfma_f32_16x16x32_bf16 v[32:35], v[224:227], v[176:179], v[32:35]
    v_mfma_f32_16x16x32_bf16 v[68:71], v[228:231], v[176:179], v[68:71]
    ds_read_b128 v[176:179], v2 offset:2048
    ds_read_b64_tr_b16 v[212:213], v5 offset:0
    ds_read_b64_tr_b16 v[214:215], v5 offset:1024
    v_mfma_f32_16x16x32_bf16 v[36:39], v[224:227], v[180:183], v[36:39]
    v_mfma_f32_16x16x32_bf16 v[72:75], v[228:231], v[180:183], v[72:75]
    ds_read_b128 v[180:183], v2 offset:4096
    v_mfma_f32_16x16x32_bf16 v[40:43], v[224:227], v[184:187], v[40:43]
    v_mfma_f32_16x16x32_bf16 v[76:79], v[228:231], v[184:187], v[76:79]
    ds_read_b128 v[184:187], v2 offset:6144
    v_mfma_f32_16x16x32_bf16 v[44:47], v[224:227], v[188:191], v[44:47]
    v_mfma_f32_16x16x32_bf16 v[80:83], v[228:231], v[188:191], v[80:83]
    ds_read_b128 v[188:191], v2 offset:8192
    v_mfma_f32_16x16x32_bf16 v[48:51], v[224:227], v[192:195], v[48:51]
    v_mfma_f32_16x16x32_bf16 v[84:87], v[228:231], v[192:195], v[84:87]
    ds_read_b128 v[192:195], v2 offset:10240
    v_mfma_f32_16x16x32_bf16 v[52:55], v[224:227], v[196:199], v[52:55]
    v_mfma_f32_16x16x32_bf16 v[88:91], v[228:231], v[196:199], v[88:91]
    ds_read_b128 v[196:199], v2 offset:12288
    v_mfma_f32_16x16x32_bf16 v[56:59], v[224:227], v[200:203], v[56:59]
    v_mfma_f32_16x16x32_bf16 v[92:95], v[228:231], v[200:203], v[92:95]
    ds_read_b128 v[200:203], v2 offset:14336
    v_mfma_f32_16x16x32_bf16 v[60:63], v[224:227], v[204:207], v[60:63]
    v_mfma_f32_16x16x32_bf16 v[96:99], v[228:231], v[204:207], v[96:99]
    ds_read_b128 v[204:207], v2 offset:16384
    s_add_u32 s49, s49, 1
    s_cmp_lt_u32 s49, 5
    s_cbranch_scc1 L_gloop_11
    s_waitcnt lgkmcnt(7)
    v_mfma_f32_16x16x32_bf16 v[28:31], v[208:211], v[172:175], v[28:31]
    v_mfma_f32_16x16x32_bf16 v[64:67], v[212:215], v[172:175], v[64:67]
    ds_read_b128 v[172:175], v3 offset:0
    ds_read_b64_tr_b16 v[224:225], v4 offset:8192
    ds_read_b64_tr_b16 v[226:227], v4 offset:9216
    s_waitcnt lgkmcnt(12)
    v_mfma_f32_16x16x32_bf16 v[32:35], v[208:211], v[176:179], v[32:35]
    v_mfma_f32_16x16x32_bf16 v[68:71], v[212:215], v[176:179], v[68:71]
    ds_read_b128 v[176:179], v3 offset:2048
    ds_read_b64_tr_b16 v[228:229], v5 offset:8192
    ds_read_b64_tr_b16 v[230:231], v5 offset:9216
    s_waitcnt lgkmcnt(12)
    v_mfma_f32_16x16x32_bf16 v[36:39], v[208:211], v[180:183], v[36:39]
    v_mfma_f32_16x16x32_bf16 v[72:75], v[212:215], v[180:183], v[72:75]
    ds_read_b128 v[180:183], v3 offset:4096
    s_waitcnt lgkmcnt(12)
    v_mfma_f32_16x16x32_bf16 v[40:43], v[208:211], v[184:187], v[40:43]
    v_mfma_f32_16x16x32_bf16 v[76:79], v[212:215], v[184:187], v[76:79]
    ds_read_b128 v[184:187], v3 offset:6144
    s_waitcnt lgkmcnt(12)
    v_mfma_f32_16x16x32_bf16 v[44:47], v[208:211], v[188:191], v[44:47]
    v_mfma_f32_16x16x32_bf16 v[80:83], v[212:215], v[188:191], v[80:83]
    ds_read_b128 v[188:191], v3 offset:8192
    s_waitcnt lgkmcnt(12)
    v_mfma_f32_16x16x32_bf16 v[48:51], v[208:211], v[192:195], v[48:51]
    v_mfma_f32_16x16x32_bf16 v[84:87], v[212:215], v[192:195], v[84:87]
    ds_read_b128 v[192:195], v3 offset:10240
    s_waitcnt lgkmcnt(12)
    v_mfma_f32_16x16x32_bf16 v[52:55], v[208:211], v[196:199], v[52:55]
    v_mfma_f32_16x16x32_bf16 v[88:91], v[212:215], v[196:199], v[88:91]
    ds_read_b128 v[196:199], v3 offset:12288
    s_waitcnt lgkmcnt(12)
    v_mfma_f32_16x16x32_bf16 v[56:59], v[208:211], v[200:203], v[56:59]
    v_mfma_f32_16x16x32_bf16 v[92:95], v[212:215], v[200:203], v[92:95]
    ds_read_b128 v[200:203], v3 offset:14336
    s_waitcnt lgkmcnt(12)
    v_mfma_f32_16x16x32_bf16 v[60:63], v[208:211], v[204:207], v[60:63]
    v_mfma_f32_16x16x32_bf16 v[96:99], v[212:215], v[204:207], v[96:99]
    ds_read_b128 v[204:207], v3 offset:16384
    s_waitcnt lgkmcnt(7)
    v_mfma_f32_16x16x32_bf16 v[28:31], v[224:227], v[172:175], v[28:31]
    v_mfma_f32_16x16x32_bf16 v[64:67], v[228:231], v[172:175], v[64:67]
    s_waitcnt lgkmcnt(9)
    v_mfma_f32_16x16x32_bf16 v[32:35], v[224:227], v[176:179], v[32:35]
    v_mfma_f32_16x16x32_bf16 v[68:71], v[228:231], v[176:179], v[68:71]
    s_waitcnt lgkmcnt(6)
    v_mfma_f32_16x16x32_bf16 v[36:39], v[224:227], v[180:183], v[36:39]
    v_mfma_f32_16x16x32_bf16 v[72:75], v[228:231], v[180:183], v[72:75]
    s_waitcnt lgkmcnt(5)
    v_mfma_f32_16x16x32_bf16 v[40:43], v[224:227], v[184:187], v[40:43]
    v_mfma_f32_16x16x32_bf16 v[76:79], v[228:231], v[184:187], v[76:79]
    s_waitcnt lgkmcnt(4)
    v_mfma_f32_16x16x32_bf16 v[44:47], v[224:227], v[188:191], v[44:47]
    v_mfma_f32_16x16x32_bf16 v[80:83], v[228:231], v[188:191], v[80:83]
    s_waitcnt lgkmcnt(3)
    v_mfma_f32_16x16x32_bf16 v[48:51], v[224:227], v[192:195], v[48:51]
    v_mfma_f32_16x16x32_bf16 v[84:87], v[228:231], v[192:195], v[84:87]
    s_waitcnt lgkmcnt(2)
    v_mfma_f32_16x16x32_bf16 v[52:55], v[224:227], v[196:199], v[52:55]
    v_mfma_f32_16x16x32_bf16 v[88:91], v[228:231], v[196:199], v[88:91]
    s_waitcnt lgkmcnt(1)
    v_mfma_f32_16x16x32_bf16 v[56:59], v[224:227], v[200:203], v[56:59]
    v_mfma_f32_16x16x32_bf16 v[92:95], v[228:231], v[200:203], v[92:95]
    s_waitcnt lgkmcnt(0)
    v_mfma_f32_16x16x32_bf16 v[60:63], v[224:227], v[204:207], v[60:63]
    v_mfma_f32_16x16x32_bf16 v[96:99], v[228:231], v[204:207], v[96:99]
    s_nop 4
    v_lshrrev_b32 v14, 4, v1
    v_and_b32 v15, 15, v1
    s_lshl_b32 s44, s3, 2
    v_lshrrev_b32 v16, 1, v14
    v_add_u32 v16, s44, v16
    v_xor_b32 v16, v16, v15
    v_lshlrev_b32 v16, 4, v16
    v_lshl_add_u32 v16, v15, 8, v16
    v_and_b32 v17, 1, v14
    v_lshl_add_u32 v16, v17, 3, v16
    v_add_u32 v16, 69632, v16
    v_xor_b32 v17, 0, v16
    v_pk_mul_f32 v[28:29], v[28:29], s[92:93]
    v_pk_mul_f32 v[30:31], v[30:31], s[92:93]
    v_cvt_pk_bf16_f32 v28, v28, v29
    v_cvt_pk_bf16_f32 v29, v30, v31
    ds_write_b64 v17, v[28:29] offset:0
    v_pk_mul_f32 v[32:33], v[32:33], s[92:93]
    v_pk_mul_f32 v[34:35], v[34:35], s[92:93]
    v_cvt_pk_bf16_f32 v32, v32, v33
    v_cvt_pk_bf16_f32 v33, v34, v35
    ds_write_b64 v17, v[32:33] offset:4096
    v_pk_mul_f32 v[36:37], v[36:37], s[92:93]
    v_pk_mul_f32 v[38:39], v[38:39], s[92:93]
    v_cvt_pk_bf16_f32 v36, v36, v37
    v_cvt_pk_bf16_f32 v37, v38, v39
    ds_write_b64 v17, v[36:37] offset:8192
    v_pk_mul_f32 v[40:41], v[40:41], s[92:93]
    v_pk_mul_f32 v[42:43], v[42:43], s[92:93]
    v_cvt_pk_bf16_f32 v40, v40, v41
    v_cvt_pk_bf16_f32 v41, v42, v43
    ds_write_b64 v17, v[40:41] offset:12288
    v_pk_mul_f32 v[44:45], v[44:45], s[92:93]
    v_pk_mul_f32 v[46:47], v[46:47], s[92:93]
    v_cvt_pk_bf16_f32 v44, v44, v45
    v_cvt_pk_bf16_f32 v45, v46, v47
    ds_write_b64 v17, v[44:45] offset:16384
    v_pk_mul_f32 v[48:49], v[48:49], s[92:93]
    v_pk_mul_f32 v[50:51], v[50:51], s[92:93]
    v_cvt_pk_bf16_f32 v48, v48, v49
    v_cvt_pk_bf16_f32 v49, v50, v51
    ds_write_b64 v17, v[48:49] offset:20480
    v_pk_mul_f32 v[52:53], v[52:53], s[92:93]
    v_pk_mul_f32 v[54:55], v[54:55], s[92:93]
    v_cvt_pk_bf16_f32 v52, v52, v53
    v_cvt_pk_bf16_f32 v53, v54, v55
    ds_write_b64 v17, v[52:53] offset:24576
    v_pk_mul_f32 v[56:57], v[56:57], s[92:93]
    v_pk_mul_f32 v[58:59], v[58:59], s[92:93]
    v_cvt_pk_bf16_f32 v56, v56, v57
    v_cvt_pk_bf16_f32 v57, v58, v59
    ds_write_b64 v17, v[56:57] offset:28672
    v_pk_mul_f32 v[60:61], v[60:61], s[92:93]
    v_pk_mul_f32 v[62:63], v[62:63], s[92:93]
    v_cvt_pk_bf16_f32 v60, v60, v61
    v_cvt_pk_bf16_f32 v61, v62, v63
    ds_write_b64 v17, v[60:61] offset:32768
    v_xor_b32 v17, 32, v16
    v_pk_mul_f32 v[64:65], v[64:65], s[92:93]
    v_pk_mul_f32 v[66:67], v[66:67], s[92:93]
    v_cvt_pk_bf16_f32 v64, v64, v65
    v_cvt_pk_bf16_f32 v65, v66, v67
    ds_write_b64 v17, v[64:65] offset:0
    v_pk_mul_f32 v[68:69], v[68:69], s[92:93]
    v_pk_mul_f32 v[70:71], v[70:71], s[92:93]
    v_cvt_pk_bf16_f32 v68, v68, v69
    v_cvt_pk_bf16_f32 v69, v70, v71
    ds_write_b64 v17, v[68:69] offset:4096
    v_pk_mul_f32 v[72:73], v[72:73], s[92:93]
    v_pk_mul_f32 v[74:75], v[74:75], s[92:93]
    v_cvt_pk_bf16_f32 v72, v72, v73
    v_cvt_pk_bf16_f32 v73, v74, v75
    ds_write_b64 v17, v[72:73] offset:8192
    v_pk_mul_f32 v[76:77], v[76:77], s[92:93]
    v_pk_mul_f32 v[78:79], v[78:79], s[92:93]
    v_cvt_pk_bf16_f32 v76, v76, v77
    v_cvt_pk_bf16_f32 v77, v78, v79
    ds_write_b64 v17, v[76:77] offset:12288
    v_pk_mul_f32 v[80:81], v[80:81], s[92:93]
    v_pk_mul_f32 v[82:83], v[82:83], s[92:93]
    v_cvt_pk_bf16_f32 v80, v80, v81
    v_cvt_pk_bf16_f32 v81, v82, v83
    ds_write_b64 v17, v[80:81] offset:16384
    v_pk_mul_f32 v[84:85], v[84:85], s[92:93]
    v_pk_mul_f32 v[86:87], v[86:87], s[92:93]
    v_cvt_pk_bf16_f32 v84, v84, v85
    v_cvt_pk_bf16_f32 v85, v86, v87
    ds_write_b64 v17, v[84:85] offset:20480
    v_pk_mul_f32 v[88:89], v[88:89], s[92:93]
    v_pk_mul_f32 v[90:91], v[90:91], s[92:93]
    v_cvt_pk_bf16_f32 v88, v88, v89
    v_cvt_pk_bf16_f32 v89, v90, v91
    ds_write_b64 v17, v[88:89] offset:24576
    v_pk_mul_f32 v[92:93], v[92:93], s[92:93]
    v_pk_mul_f32 v[94:95], v[94:95], s[92:93]
    v_cvt_pk_bf16_f32 v92, v92, v93
    v_cvt_pk_bf16_f32 v93, v94, v95
    ds_write_b64 v17, v[92:93] offset:28672
    v_pk_mul_f32 v[96:97], v[96:97], s[92:93]
    v_pk_mul_f32 v[98:99], v[98:99], s[92:93]
    v_cvt_pk_bf16_f32 v96, v96, v97
    v_cvt_pk_bf16_f32 v97, v98, v99
    ds_write_b64 v17, v[96:97] offset:32768
    s_cmp_eq_u32 s27, 0
    s_cselect_b32 s76, 2, 4
    s_lshl_b32 s83, s76, 14
    s_add_u32 s83, s83, 81920
    s_mov_b32 s77, s76
    v_lshrrev_b32 v14, 4, v1
    v_and_b32 v15, 15, v1
    v_xor_b32 v16, v14, v15
    v_lshlrev_b32 v16, 4, v16
    v_lshl_add_u32 v16, v15, 8, v16
    v_add_u32 v2, s83, v16
    v_xor_b32 v3, 64, v2
    v_xor_b32 v4, 128, v2
    v_xor_b32 v5, 192, v2
    v_lshrrev_b32 v16, 2, v15
    v_and_b32 v17, 1, v14
    v_lshl_add_u32 v17, v17, 2, v16
    v_lshlrev_b32 v17, 5, v17
    v_lshl_add_u32 v17, v14, 10, v17
    v_lshl_add_u32 v17, v16, 8, v17
    v_and_b32 v18, 3, v15
    v_lshl_add_u32 v17, v18, 3, v17
    v_add_u32 v17, 8192, v17
    v_add_u32 v6, s83, v17
    v_xor_b32 v7, 32, v6
    v_xor_b32 v8, 64, v6
    v_xor_b32 v9, 96, v6
    v_xor_b32 v10, 128, v6
    v_xor_b32 v11, 160, v6
    v_xor_b32 v12, 192, v6
    v_xor_b32 v13, 224, v6
    s_waitcnt lgkmcnt(0)
    v_mov_b32 v28, 0
    v_mov_b32 v29, 0
    v_mov_b32 v30, 0
    v_mov_b32 v31, 0
    v_mov_b32 v32, 0
    v_mov_b32 v33, 0
    v_mov_b32 v34, 0
    v_mov_b32 v35, 0
    v_mov_b32 v36, 0
    v_mov_b32 v37, 0
    v_mov_b32 v38, 0
    v_mov_b32 v39, 0
    v_mov_b32 v40, 0
    v_mov_b32 v41, 0
    v_mov_b32 v42, 0
    v_mov_b32 v43, 0
    v_mov_b32 v44, 0
    v_mov_b32 v45, 0
    v_mov_b32 v46, 0
    v_mov_b32 v47, 0
    v_mov_b32 v48, 0
    v_mov_b32 v49, 0
    v_mov_b32 v50, 0
    v_mov_b32 v51, 0
    v_mov_b32 v52, 0
    v_mov_b32 v53, 0
    v_mov_b32 v54, 0
    v_mov_b32 v55, 0
    v_mov_b32 v56, 0
    v_mov_b32 v57, 0
    v_mov_b32 v58, 0
    v_mov_b32 v59, 0
    v_mov_b32 v92, 0
    v_mov_b32 v100, 0
    v_mov_b32 v93, 0
    v_mov_b32 v101, 0
    v_mov_b32 v94, 0
    v_mov_b32 v102, 0
    v_mov_b32 v95, 0
    v_mov_b32 v103, 0
    v_mov_b32 v60, 0
    v_mov_b32 v61, 0
    v_mov_b32 v62, 0
    v_mov_b32 v63, 0
    v_mov_b32 v64, 0
    v_mov_b32 v65, 0
    v_mov_b32 v66, 0
    v_mov_b32 v67, 0
    v_mov_b32 v68, 0
    v_mov_b32 v69, 0
    v_mov_b32 v70, 0
    v_mov_b32 v71, 0
    v_mov_b32 v72, 0
    v_mov_b32 v73, 0
    v_mov_b32 v74, 0
    v_mov_b32 v75, 0
    v_mov_b32 v76, 0
    v_mov_b32 v77, 0
    v_mov_b32 v78, 0
    v_mov_b32 v79, 0
    v_mov_b32 v80, 0
    v_mov_b32 v81, 0
    v_mov_b32 v82, 0
    v_mov_b32 v83, 0
    v_mov_b32 v84, 0
    v_mov_b32 v85, 0
    v_mov_b32 v86, 0
    v_mov_b32 v87, 0
    v_mov_b32 v88, 0
    v_mov_b32 v89, 0
    v_mov_b32 v90, 0
    v_mov_b32 v91, 0
    v_mov_b32 v96, 0
    v_mov_b32 v104, 0
    v_mov_b32 v97, 0
    v_mov_b32 v105, 0
    v_mov_b32 v98, 0
    v_mov_b32 v106, 0
    v_mov_b32 v99, 0
    v_mov_b32 v107, 0
    s_barrier
    s_lshl_b32 s52, s53, 12
    s_add_u32 s52, s52, 69632
    s_sub_u32 s52, s52, s83
    v_add_u32 v14, s52, v2
    v_add_u32 v15, s52, v3
    v_add_u32 v16, s52, v4
    v_add_u32 v17, s52, v5
    ds_read_b128 v[108:111], v14 offset:0
    ds_read_b128 v[112:115], v15 offset:0
    ds_read_b128 v[116:119], v16 offset:0
    ds_read_b128 v[120:123], v17 offset:0
    ds_read_b128 v[124:127], v14 offset:4096
    ds_read_b128 v[128:131], v15 offset:4096
    ds_read_b128 v[132:135], v16 offset:4096
    ds_read_b128 v[136:139], v17 offset:4096
    ds_read_b128 v[140:143], v2 offset:0
    ds_read_b128 v[156:159], v2 offset:4096
    ds_read_b128 v[144:147], v3 offset:0
    ds_read_b128 v[160:163], v3 offset:4096
    ds_read_b128 v[148:151], v4 offset:0
    ds_read_b128 v[164:167], v4 offset:4096
    ds_read_b128 v[152:155], v5 offset:0
    ds_read_b128 v[168:171], v5 offset:4096
    s_cmp_eq_u32 s77, 4
    s_cselect_b32 s79, s81, s80
    s_add_u32 s77, s77, 1
    s_cmp_eq_u32 s77, 5
    s_cselect_b32 s77, 0, s77
    v_add_u32 v2, s79, v2
    v_add_u32 v3, s79, v3
    v_add_u32 v4, s79, v4
    v_add_u32 v5, s79, v5
    s_waitcnt lgkmcnt(0)
    s_barrier
    s_mul_i32 s44, s24, 9437184
    s_mul_i32 s45, s25, 1179648
    s_add_u32 s44, s44, s45
    s_lshl_b32 s45, s26, 8
    s_add_u32 s44, s44, s45
    s_add_u32 s20, s40, s44
    s_addc_u32 s21, s41, 0
    s_mov_b32 s22, 1171712
    s_mov_b32 s23, 0x20000
    s_add_u32 s26, s26, 4
    s_mov_b32 s29, 0xff800000
    s_mov_b32 s30, 0xff800000
    s_waitcnt lgkmcnt(0)
    v_mfma_f32_16x16x32_bf16 v[204:207], v[140:143], v[108:111], v[100:103]
    v_mfma_f32_16x16x32_bf16 v[212:215], v[140:143], v[124:127], v[104:107]
    v_mfma_f32_16x16x32_bf16 v[208:211], v[156:159], v[108:111], v[100:103]
    v_mfma_f32_16x16x32_bf16 v[216:219], v[156:159], v[124:127], v[104:107]
    v_mfma_f32_16x16x32_bf16 v[204:207], v[144:147], v[112:115], v[204:207]
    v_mfma_f32_16x16x32_bf16 v[212:215], v[144:147], v[128:131], v[212:215]
    v_mfma_f32_16x16x32_bf16 v[208:211], v[160:163], v[112:115], v[208:211]
    v_mfma_f32_16x16x32_bf16 v[216:219], v[160:163], v[128:131], v[216:219]
    v_mfma_f32_16x16x32_bf16 v[204:207], v[148:151], v[116:119], v[204:207]
    v_mfma_f32_16x16x32_bf16 v[212:215], v[148:151], v[132:135], v[212:215]
    v_mfma_f32_16x16x32_bf16 v[208:211], v[164:167], v[116:119], v[208:211]
    v_mfma_f32_16x16x32_bf16 v[216:219], v[164:167], v[132:135], v[216:219]
    v_mfma_f32_16x16x32_bf16 v[204:207], v[152:155], v[120:123], v[204:207]
    v_mfma_f32_16x16x32_bf16 v[212:215], v[152:155], v[136:139], v[212:215]
    v_mfma_f32_16x16x32_bf16 v[208:211], v[168:171], v[120:123], v[208:211]
    v_mfma_f32_16x16x32_bf16 v[216:219], v[168:171], v[136:139], v[216:219]
    ds_read_b128 v[140:143], v2 offset:0
    ds_read_b128 v[156:159], v2 offset:4096
    ds_read_b128 v[144:147], v3 offset:0
    ds_read_b128 v[160:163], v3 offset:4096
    ds_read_b128 v[148:151], v4 offset:0
    ds_read_b128 v[164:167], v4 offset:4096
    ds_read_b128 v[152:155], v5 offset:0
    ds_read_b128 v[168:171], v5 offset:4096
    s_cmp_eq_u32 s77, 4
    s_cselect_b32 s79, s81, s80
    s_add_u32 s77, s77, 1
    s_cmp_eq_u32 s77, 5
    s_cselect_b32 s77, 0, s77
    v_add_u32 v2, s79, v2
    v_add_u32 v3, s79, v3
    v_add_u32 v4, s79, v4
    v_add_u32 v5, s79, v5
    s_nop 3
    v_max3_f32 v22, v204, v205, v206
    v_max3_f32 v23, v212, v213, v214
    v_max3_f32 v22, v22, v207, v208
    v_max3_f32 v23, v23, v215, v216
    v_max3_f32 v22, v22, v209, v210
    v_max3_f32 v23, v23, v217, v218
    v_max_f32 v22, v22, v211
    v_max_f32 v23, v23, v219
    v_max_f32 v14, v22, v23
    v_cmp_lt_f32 vcc, s29, v14
    s_call_b64 s[72:73], L_k1_rinitB
    s_mov_b32 s49, 0
L_attn_loop_12:
    s_waitcnt lgkmcnt(0)
    v_mfma_f32_16x16x32_bf16 v[220:223], v[140:143], v[108:111], v[100:103]
    v_exp_f32 v204, v204
    ds_read_b64_tr_b16 v[172:173], v6 offset:0
    v_exp_f32 v205, v205
    v_mfma_f32_16x16x32_bf16 v[228:231], v[140:143], v[124:127], v[104:107]
    ds_read_b64_tr_b16 v[174:175], v6 offset:4096
    v_exp_f32 v206, v206
    ds_read_b64_tr_b16 v[176:177], v7 offset:0
    v_mfma_f32_16x16x32_bf16 v[224:227], v[156:159], v[108:111], v[100:103]
    v_exp_f32 v207, v207
    ds_read_b64_tr_b16 v[178:179], v7 offset:4096
    v_mfma_f32_16x16x32_bf16 v[232:235], v[156:159], v[124:127], v[104:107]
    v_cvt_pk_bf16_f32 v236, v204, v205
    v_exp_f32 v208, v208
    ds_read_b64_tr_b16 v[180:181], v8 offset:0
    v_mfma_f32_16x16x32_bf16 v[220:223], v[144:147], v[112:115], v[220:223]
    v_exp_f32 v209, v209
    ds_read_b64_tr_b16 v[182:183], v8 offset:4096
    v_mfma_f32_16x16x32_bf16 v[228:231], v[144:147], v[128:131], v[228:231]
    v_cvt_pk_bf16_f32 v237, v206, v207
    v_exp_f32 v210, v210
    ds_read_b64_tr_b16 v[184:185], v9 offset:0
    v_mfma_f32_16x16x32_bf16 v[224:227], v[160:163], v[112:115], v[224:227]
    v_exp_f32 v211, v211
    ds_read_b64_tr_b16 v[186:187], v9 offset:4096
    v_mfma_f32_16x16x32_bf16 v[232:235], v[160:163], v[128:131], v[232:235]
    v_cvt_pk_bf16_f32 v238, v208, v209
    v_exp_f32 v212, v212
    ds_read_b64_tr_b16 v[188:189], v10 offset:0
    v_mfma_f32_16x16x32_bf16 v[220:223], v[148:151], v[116:119], v[220:223]
    v_exp_f32 v213, v213
    ds_read_b64_tr_b16 v[190:191], v10 offset:4096
    v_cvt_pk_bf16_f32 v239, v210, v211
    v_mfma_f32_16x16x32_bf16 v[228:231], v[148:151], v[132:135], v[228:231]
    v_exp_f32 v214, v214
    ds_read_b64_tr_b16 v[192:193], v11 offset:0
    v_mfma_f32_16x16x32_bf16 v[224:227], v[164:167], v[116:119], v[224:227]
    v_exp_f32 v215, v215
    ds_read_b64_tr_b16 v[194:195], v11 offset:4096
    v_cvt_pk_bf16_f32 v240, v212, v213
    v_mfma_f32_16x16x32_bf16 v[232:235], v[164:167], v[132:135], v[232:235]
    v_exp_f32 v216, v216
    ds_read_b64_tr_b16 v[196:197], v12 offset:0
    v_mfma_f32_16x16x32_bf16 v[220:223], v[152:155], v[120:123], v[220:223]
    v_exp_f32 v217, v217
    ds_read_b64_tr_b16 v[198:199], v12 offset:4096
    v_cvt_pk_bf16_f32 v241, v214, v215
    v_mfma_f32_16x16x32_bf16 v[228:231], v[152:155], v[136:139], v[228:231]
    v_exp_f32 v218, v218
    ds_read_b64_tr_b16 v[200:201], v13 offset:0
    v_mfma_f32_16x16x32_bf16 v[224:227], v[168:171], v[120:123], v[224:227]
    v_exp_f32 v219, v219
    ds_read_b64_tr_b16 v[202:203], v13 offset:4096
    v_cvt_pk_bf16_f32 v242, v216, v217
    v_mfma_f32_16x16x32_bf16 v[232:235], v[168:171], v[136:139], v[232:235]
    s_nop 0
    v_cvt_pk_bf16_f32 v243, v218, v219
    s_waitcnt lgkmcnt(0)
    s_barrier
    v_mfma_f32_16x16x32_bf16 v[28:31], v[172:175], v[236:239], v[28:31]
    ds_read_b128 v[140:143], v2 offset:0
    ds_read_b128 v[156:159], v2 offset:4096
    ds_read_b128 v[144:147], v3 offset:0
    v_mfma_f32_16x16x32_bf16 v[60:63], v[172:175], v[240:243], v[60:63]
    ds_read_b128 v[160:163], v3 offset:4096
    ds_read_b128 v[148:151], v4 offset:0
    v_mfma_f32_16x16x32_bf16 v[32:35], v[176:179], v[236:239], v[32:35]
    ds_read_b128 v[164:167], v4 offset:4096
    ds_read_b128 v[152:155], v5 offset:0
    v_mfma_f32_16x16x32_bf16 v[64:67], v[176:179], v[240:243], v[64:67]
    ds_read_b128 v[168:171], v5 offset:4096
    s_cmp_eq_u32 s76, 4
    v_mfma_f32_16x16x32_bf16 v[36:39], v[180:183], v[236:239], v[36:39]
    s_cselect_b32 s78, s81, s80
    s_add_u32 s76, s76, 1
    v_mfma_f32_16x16x32_bf16 v[68:71], v[180:183], v[240:243], v[68:71]
    s_cmp_eq_u32 s76, 5
    s_cselect_b32 s76, 0, s76
    v_mfma_f32_16x16x32_bf16 v[40:43], v[184:187], v[236:239], v[40:43]
    v_add_u32 v6, s78, v6
    v_add_u32 v7, s78, v7
    v_add_u32 v8, s78, v8
    v_mfma_f32_16x16x32_bf16 v[72:75], v[184:187], v[240:243], v[72:75]
    v_add_u32 v9, s78, v9
    v_add_u32 v10, s78, v10
    v_mfma_f32_16x16x32_bf16 v[92:95], v[24:27], v[236:239], v[92:95]
    v_add_u32 v11, s78, v11
    v_add_u32 v12, s78, v12
    v_mfma_f32_16x16x32_bf16 v[96:99], v[24:27], v[240:243], v[96:99]
    v_add_u32 v13, s78, v13
    s_cmp_eq_u32 s77, 4
    v_mfma_f32_16x16x32_bf16 v[44:47], v[188:191], v[236:239], v[44:47]
    s_cselect_b32 s79, s81, s80
    s_add_u32 s77, s77, 1
    v_mfma_f32_16x16x32_bf16 v[76:79], v[188:191], v[240:243], v[76:79]
    s_cmp_eq_u32 s77, 5
    s_cselect_b32 s77, 0, s77
    v_mfma_f32_16x16x32_bf16 v[48:51], v[192:195], v[236:239], v[48:51]
    v_add_u32 v2, s79, v2
    v_add_u32 v3, s79, v3
    v_add_u32 v4, s79, v4
    v_mfma_f32_16x16x32_bf16 v[80:83], v[192:195], v[240:243], v[80:83]
    v_add_u32 v5, s79, v5
    v_max3_f32 v22, v220, v221, v222
    v_mfma_f32_16x16x32_bf16 v[52:55], v[196:199], v[236:239], v[52:55]
    v_max3_f32 v23, v228, v229, v230
    v_max3_f32 v22, v22, v223, v224
    v_mfma_f32_16x16x32_bf16 v[84:87], v[196:199], v[240:243], v[84:87]
    v_max3_f32 v23, v23, v231, v232
    v_max3_f32 v22, v22, v225, v226
    v_mfma_f32_16x16x32_bf16 v[56:59], v[200:203], v[236:239], v[56:59]
    v_max3_f32 v23, v23, v233, v234
    v_max_f32 v22, v22, v227
    v_mfma_f32_16x16x32_bf16 v[88:91], v[200:203], v[240:243], v[88:91]
    v_max_f32 v23, v23, v235
    v_max_f32 v14, v22, v23
    v_cmp_lt_f32 vcc, s29, v14
    s_cbranch_vccnz L_rare_13
L_back_14:
    s_waitcnt lgkmcnt(0)
    v_mfma_f32_16x16x32_bf16 v[204:207], v[140:143], v[108:111], v[100:103]
    v_exp_f32 v220, v220
    ds_read_b64_tr_b16 v[172:173], v6 offset:0
    v_exp_f32 v221, v221
    v_mfma_f32_16x16x32_bf16 v[212:215], v[140:143], v[124:127], v[104:107]
    ds_read_b64_tr_b16 v[174:175], v6 offset:4096
    v_exp_f32 v222, v222
    ds_read_b64_tr_b16 v[176:177], v7 offset:0
    v_mfma_f32_16x16x32_bf16 v[208:211], v[156:159], v[108:111], v[100:103]
    v_exp_f32 v223, v223
    ds_read_b64_tr_b16 v[178:179], v7 offset:4096
    v_mfma_f32_16x16x32_bf16 v[216:219], v[156:159], v[124:127], v[104:107]
    v_cvt_pk_bf16_f32 v236, v220, v221
    v_exp_f32 v224, v224
    ds_read_b64_tr_b16 v[180:181], v8 offset:0
    v_mfma_f32_16x16x32_bf16 v[204:207], v[144:147], v[112:115], v[204:207]
    v_exp_f32 v225, v225
    ds_read_b64_tr_b16 v[182:183], v8 offset:4096
    v_mfma_f32_16x16x32_bf16 v[212:215], v[144:147], v[128:131], v[212:215]
    v_cvt_pk_bf16_f32 v237, v222, v223
    v_exp_f32 v226, v226
    ds_read_b64_tr_b16 v[184:185], v9 offset:0
    v_mfma_f32_16x16x32_bf16 v[208:211], v[160:163], v[112:115], v[208:211]
    v_exp_f32 v227, v227
    ds_read_b64_tr_b16 v[186:187], v9 offset:4096
    v_mfma_f32_16x16x32_bf16 v[216:219], v[160:163], v[128:131], v[216:219]
    v_cvt_pk_bf16_f32 v238, v224, v225
    v_exp_f32 v228, v228
    ds_read_b64_tr_b16 v[188:189], v10 offset:0
    v_mfma_f32_16x16x32_bf16 v[204:207], v[148:151], v[116:119], v[204:207]
    v_exp_f32 v229, v229
    ds_read_b64_tr_b16 v[190:191], v10 offset:4096
    v_cvt_pk_bf16_f32 v239, v226, v227
    v_mfma_f32_16x16x32_bf16 v[212:215], v[148:151], v[132:135], v[212:215]
    v_exp_f32 v230, v230
    ds_read_b64_tr_b16 v[192:193], v11 offset:0
    v_mfma_f32_16x16x32_bf16 v[208:211], v[164:167], v[116:119], v[208:211]
    v_exp_f32 v231, v231
    ds_read_b64_tr_b16 v[194:195], v11 offset:4096
    v_cvt_pk_bf16_f32 v240, v228, v229
    v_mfma_f32_16x16x32_bf16 v[216:219], v[164:167], v[132:135], v[216:219]
    v_exp_f32 v232, v232
    ds_read_b64_tr_b16 v[196:197], v12 offset:0
    v_mfma_f32_16x16x32_bf16 v[204:207], v[152:155], v[120:123], v[204:207]
    v_exp_f32 v233, v233
    ds_read_b64_tr_b16 v[198:199], v12 offset:4096
    v_cvt_pk_bf16_f32 v241, v230, v231
    v_mfma_f32_16x16x32_bf16 v[212:215], v[152:155], v[136:139], v[212:215]
    v_exp_f32 v234, v234
    ds_read_b64_tr_b16 v[200:201], v13 offset:0
    v_mfma_f32_16x16x32_bf16 v[208:211], v[168:171], v[120:123], v[208:211]
    v_exp_f32 v235, v235
    ds_read_b64_tr_b16 v[202:203], v13 offset:4096
    v_cvt_pk_bf16_f32 v242, v232, v233
    v_mfma_f32_16x16x32_bf16 v[216:219], v[168:171], v[136:139], v[216:219]
    s_nop 0
    v_cvt_pk_bf16_f32 v243, v234, v235
    s_waitcnt lgkmcnt(0)
    s_barrier
    s_cmp_eq_u32 s49, 15
    s_cselect_b32 s29, 0x7f800000, s29
    v_mfma_f32_16x16x32_bf16 v[28:31], v[172:175], v[236:239], v[28:31]
    ds_read_b128 v[140:143], v2 offset:0
    ds_read_b128 v[156:159], v2 offset:4096
    ds_read_b128 v[144:147], v3 offset:0
    v_mfma_f32_16x16x32_bf16 v[60:63], v[172:175], v[240:243], v[60:63]
    ds_read_b128 v[160:163], v3 offset:4096
    ds_read_b128 v[148:151], v4 offset:0
    v_mfma_f32_16x16x32_bf16 v[32:35], v[176:179], v[236:239], v[32:35]
    ds_read_b128 v[164:167], v4 offset:4096
    ds_read_b128 v[152:155], v5 offset:0
    v_mfma_f32_16x16x32_bf16 v[64:67], v[176:179], v[240:243], v[64:67]
    ds_read_b128 v[168:171], v5 offset:4096
    s_cmp_eq_u32 s76, 4
    v_mfma_f32_16x16x32_bf16 v[36:39], v[180:183], v[236:239], v[36:39]
    s_cselect_b32 s78, s81, s80
    s_add_u32 s76, s76, 1
    v_mfma_f32_16x16x32_bf16 v[68:71], v[180:183], v[240:243], v[68:71]
    s_cmp_eq_u32 s76, 5
    s_cselect_b32 s76, 0, s76
    v_mfma_f32_16x16x32_bf16 v[40:43], v[184:187], v[236:239], v[40:43]
    v_add_u32 v6, s78, v6
    v_add_u32 v7, s78, v7
    v_add_u32 v8, s78, v8
    v_mfma_f32_16x16x32_bf16 v[72:75], v[184:187], v[240:243], v[72:75]
    v_add_u32 v9, s78, v9
    v_add_u32 v10, s78, v10
    v_mfma_f32_16x16x32_bf16 v[92:95], v[24:27], v[236:239], v[92:95]
    v_add_u32 v11, s78, v11
    v_add_u32 v12, s78, v12
    v_mfma_f32_16x16x32_bf16 v[96:99], v[24:27], v[240:243], v[96:99]
    v_add_u32 v13, s78, v13
    s_cmp_eq_u32 s77, 4
    v_mfma_f32_16x16x32_bf16 v[44:47], v[188:191], v[236:239], v[44:47]
    s_cselect_b32 s79, s81, s80
    s_add_u32 s77, s77, 1
    v_mfma_f32_16x16x32_bf16 v[76:79], v[188:191], v[240:243], v[76:79]
    s_cmp_eq_u32 s77, 5
    s_cselect_b32 s77, 0, s77
    v_mfma_f32_16x16x32_bf16 v[48:51], v[192:195], v[236:239], v[48:51]
    v_add_u32 v2, s79, v2
    v_add_u32 v3, s79, v3
    v_add_u32 v4, s79, v4
    v_mfma_f32_16x16x32_bf16 v[80:83], v[192:195], v[240:243], v[80:83]
    v_add_u32 v5, s79, v5
    v_max3_f32 v22, v204, v205, v206
    v_mfma_f32_16x16x32_bf16 v[52:55], v[196:199], v[236:239], v[52:55]
    v_max3_f32 v23, v212, v213, v214
    v_max3_f32 v22, v22, v207, v208
    v_mfma_f32_16x16x32_bf16 v[84:87], v[196:199], v[240:243], v[84:87]
    v_max3_f32 v23, v23, v215, v216
    v_max3_f32 v22, v22, v209, v210
    v_mfma_f32_16x16x32_bf16 v[56:59], v[200:203], v[236:239], v[56:59]
    v_max3_f32 v23, v23, v217, v218
    v_max_f32 v22, v22, v211
    v_mfma_f32_16x16x32_bf16 v[88:91], v[200:203], v[240:243], v[88:91]
    v_max_f32 v23, v23, v219
    v_max_f32 v14, v22, v23
    v_cmp_lt_f32 vcc, s29, v14
    s_cbranch_vccnz L_rare_15
L_back_16:
    s_add_u32 s49, s49, 1
    s_cmp_lt_u32 s49, 16
    s_cbranch_scc1 L_attn_loop_12
    s_mov_b32 s27, 1
    s_cmp_eq_u32 s27, 0
    s_cselect_b32 s76, 2, 4
    s_lshl_b32 s83, s76, 14
    s_add_u32 s83, s83, 81920
    s_mov_b32 s77, s76
    v_lshrrev_b32 v14, 4, v1
    v_and_b32 v15, 15, v1
    v_xor_b32 v16, v14, v15
    v_lshlrev_b32 v16, 4, v16
    v_lshl_add_u32 v16, v15, 8, v16
    v_add_u32 v2, s83, v16
    v_xor_b32 v3, 64, v2
    v_xor_b32 v4, 128, v2
    v_xor_b32 v5, 192, v2
    v_lshrrev_b32 v16, 2, v15
    v_and_b32 v17, 1, v14
    v_lshl_add_u32 v17, v17, 2, v16
    v_lshlrev_b32 v17, 5, v17
    v_lshl_add_u32 v17, v14, 10, v17
    v_lshl_add_u32 v17, v16, 8, v17
    v_and_b32 v18, 3, v15
    v_lshl_add_u32 v17, v18, 3, v17
    v_add_u32 v17, 8192, v17
    v_add_u32 v6, s83, v17
    v_xor_b32 v7, 32, v6
    v_xor_b32 v8, 64, v6
    v_xor_b32 v9, 96, v6
    v_xor_b32 v10, 128, v6
    v_xor_b32 v11, 160, v6
    v_xor_b32 v12, 192, v6
    v_xor_b32 v13, 224, v6
    v_mov_b32 v100, 0
    v_mov_b32 v101, 0
    v_mov_b32 v102, 0
    v_mov_b32 v103, 0
    v_mov_b32 v104, 0
    v_mov_b32 v105, 0
    v_mov_b32 v106, 0
    v_mov_b32 v107, 0
    s_waitcnt lgkmcnt(0)
    s_barrier
    s_mov_b32 s64, s100
    s_mov_b32 s65, s101
    s_mov_b32 s66, 256
    s_mov_b32 s67, 0x20000
    v_mov_b32 v20, 0
    s_nop 0
    buffer_load_dword v20, v20, s[64:67], 0 offen sc1
    s_lshl_b32 s52, s53, 12
    s_add_u32 s52, s52, 0
    s_sub_u32 s52, s52, s83
    v_add_u32 v14, s52, v2
    v_add_u32 v15, s52, v3
    v_add_u32 v16, s52, v4
    v_add_u32 v17, s52, v5
    ds_read_b128 v[108:111], v14 offset:0
    ds_read_b128 v[112:115], v15 offset:0
    ds_read_b128 v[116:119], v16 offset:0
    ds_read_b128 v[120:123], v17 offset:0
    ds_read_b128 v[124:127], v14 offset:4096
    ds_read_b128 v[128:131], v15 offset:4096
    ds_read_b128 v[132:135], v16 offset:4096
    ds_read_b128 v[136:139], v17 offset:4096
    ds_read_b128 v[140:143], v2 offset:0
    ds_read_b128 v[156:159], v2 offset:4096
    ds_read_b128 v[144:147], v3 offset:0
    ds_read_b128 v[160:163], v3 offset:4096
    ds_read_b128 v[148:151], v4 offset:0
    ds_read_b128 v[164:167], v4 offset:4096
    ds_read_b128 v[152:155], v5 offset:0
    ds_read_b128 v[168:171], v5 offset:4096
    s_cmp_eq_u32 s77, 4
    s_cselect_b32 s79, s81, s80
    s_add_u32 s77, s77, 1
    s_cmp_eq_u32 s77, 5
    s_cselect_b32 s77, 0, s77
    v_add_u32 v2, s79, v2
    v_add_u32 v3, s79, v3
    v_add_u32 v4, s79, v4
    v_add_u32 v5, s79, v5
    s_mov_b32 s29, 0xff800000
    s_mov_b32 s30, 0xff800000
    s_waitcnt lgkmcnt(0)
    v_mfma_f32_16x16x32_bf16 v[204:207], v[140:143], v[108:111], v[100:103]
    v_mfma_f32_16x16x32_bf16 v[212:215], v[140:143], v[124:127], v[104:107]
    v_mfma_f32_16x16x32_bf16 v[208:211], v[156:159], v[108:111], v[100:103]
    v_mfma_f32_16x16x32_bf16 v[216:219], v[156:159], v[124:127], v[104:107]
    v_mfma_f32_16x16x32_bf16 v[204:207], v[144:147], v[112:115], v[204:207]
    v_mfma_f32_16x16x32_bf16 v[212:215], v[144:147], v[128:131], v[212:215]
    v_mfma_f32_16x16x32_bf16 v[208:211], v[160:163], v[112:115], v[208:211]
    v_mfma_f32_16x16x32_bf16 v[216:219], v[160:163], v[128:131], v[216:219]
    v_mfma_f32_16x16x32_bf16 v[204:207], v[148:151], v[116:119], v[204:207]
    v_mfma_f32_16x16x32_bf16 v[212:215], v[148:151], v[132:135], v[212:215]
    v_mfma_f32_16x16x32_bf16 v[208:211], v[164:167], v[116:119], v[208:211]
    v_mfma_f32_16x16x32_bf16 v[216:219], v[164:167], v[132:135], v[216:219]
    v_mfma_f32_16x16x32_bf16 v[204:207], v[152:155], v[120:123], v[204:207]
    v_mfma_f32_16x16x32_bf16 v[212:215], v[152:155], v[136:139], v[212:215]
    v_mfma_f32_16x16x32_bf16 v[208:211], v[168:171], v[120:123], v[208:211]
    v_mfma_f32_16x16x32_bf16 v[216:219], v[168:171], v[136:139], v[216:219]
    ds_read_b128 v[140:143], v2 offset:0
    ds_read_b128 v[156:159], v2 offset:4096
    ds_read_b128 v[144:147], v3 offset:0
    ds_read_b128 v[160:163], v3 offset:4096
    ds_read_b128 v[148:151], v4 offset:0
    ds_read_b128 v[164:167], v4 offset:4096
    ds_read_b128 v[152:155], v5 offset:0
    ds_read_b128 v[168:171], v5 offset:4096
    s_cmp_eq_u32 s77, 4
    s_cselect_b32 s79, s81, s80
    s_add_u32 s77, s77, 1
    s_cmp_eq_u32 s77, 5
    s_cselect_b32 s77, 0, s77
    v_add_u32 v2, s79, v2
    v_add_u32 v3, s79, v3
    v_add_u32 v4, s79, v4
    v_add_u32 v5, s79, v5
    v_lshrrev_b32 v14, 4, v1
    v_and_b32 v15, 15, v1
    v_and_b32 v16, 1, v14
    v_lshlrev_b32 v16, 5, v16
    v_lshrrev_b32 v14, 1, v14
    v_lshl_add_u32 v16, v14, 4, v16
    v_lshl_add_u32 v15, v15, 13, v16
    s_mul_i32 s44, s53, 131072
    v_rcp_f32 v22, v92
    v_rcp_f32 v23, v96
    s_nop 0
    v_mul_f32 v28, v28, v22
    v_mul_f32 v29, v29, v22
    v_mul_f32 v30, v30, v22
    v_mul_f32 v31, v31, v22
    v_mul_f32 v32, v32, v22
    v_mul_f32 v33, v33, v22
    v_mul_f32 v34, v34, v22
    v_mul_f32 v35, v35, v22
    v_cvt_pk_bf16_f32 v28, v28, v29
    v_cvt_pk_bf16_f32 v29, v30, v31
    v_cvt_pk_bf16_f32 v30, v32, v33
    v_cvt_pk_bf16_f32 v31, v34, v35
    s_nop 1
    v_permlane16_swap_b32 v28, v30
    v_permlane16_swap_b32 v29, v31
    buffer_store_dwordx4 v[28:31], v15, s[20:23], s44 offen offset:0 sc1
    v_mul_f32 v36, v36, v22
    v_mul_f32 v37, v37, v22
    v_mul_f32 v38, v38, v22
    v_mul_f32 v39, v39, v22
    v_mul_f32 v40, v40, v22
    v_mul_f32 v41, v41, v22
    v_mul_f32 v42, v42, v22
    v_mul_f32 v43, v43, v22
    v_cvt_pk_bf16_f32 v36, v36, v37
    v_cvt_pk_bf16_f32 v37, v38, v39
    v_cvt_pk_bf16_f32 v38, v40, v41
    v_cvt_pk_bf16_f32 v39, v42, v43
    s_nop 1
    v_permlane16_swap_b32 v36, v38
    v_permlane16_swap_b32 v37, v39
    buffer_store_dwordx4 v[36:39], v15, s[20:23], s44 offen offset:64 sc1
    v_mul_f32 v44, v44, v22
    v_mul_f32 v45, v45, v22
    v_mul_f32 v46, v46, v22
    v_mul_f32 v47, v47, v22
    v_mul_f32 v48, v48, v22
    v_mul_f32 v49, v49, v22
    v_mul_f32 v50, v50, v22
    v_mul_f32 v51, v51, v22
    v_cvt_pk_bf16_f32 v44, v44, v45
    v_cvt_pk_bf16_f32 v45, v46, v47
    v_cvt_pk_bf16_f32 v46, v48, v49
    v_cvt_pk_bf16_f32 v47, v50, v51
    s_nop 1
    v_permlane16_swap_b32 v44, v46
    v_permlane16_swap_b32 v45, v47
    buffer_store_dwordx4 v[44:47], v15, s[20:23], s44 offen offset:128 sc1
    v_mul_f32 v52, v52, v22
    v_mul_f32 v53, v53, v22
    v_mul_f32 v54, v54, v22
    v_mul_f32 v55, v55, v22
    v_mul_f32 v56, v56, v22
    v_mul_f32 v57, v57, v22
    v_mul_f32 v58, v58, v22
    v_mul_f32 v59, v59, v22
    v_cvt_pk_bf16_f32 v52, v52, v53
    v_cvt_pk_bf16_f32 v53, v54, v55
    v_cvt_pk_bf16_f32 v54, v56, v57
    v_cvt_pk_bf16_f32 v55, v58, v59
    s_nop 1
    v_permlane16_swap_b32 v52, v54
    v_permlane16_swap_b32 v53, v55
    buffer_store_dwordx4 v[52:55], v15, s[20:23], s44 offen offset:192 sc1
    s_add_u32 s44, s44, 131072
    v_mul_f32 v60, v60, v23
    v_mul_f32 v61, v61, v23
    v_mul_f32 v62, v62, v23
    v_mul_f32 v63, v63, v23
    v_mul_f32 v64, v64, v23
    v_mul_f32 v65, v65, v23
    v_mul_f32 v66, v66, v23
    v_mul_f32 v67, v67, v23
    v_cvt_pk_bf16_f32 v60, v60, v61
    v_cvt_pk_bf16_f32 v61, v62, v63
    v_cvt_pk_bf16_f32 v62, v64, v65
    v_cvt_pk_bf16_f32 v63, v66, v67
    s_nop 1
    v_permlane16_swap_b32 v60, v62
    v_permlane16_swap_b32 v61, v63
    buffer_store_dwordx4 v[60:63], v15, s[20:23], s44 offen offset:0 sc1
    v_mul_f32 v68, v68, v23
    v_mul_f32 v69, v69, v23
    v_mul_f32 v70, v70, v23
    v_mul_f32 v71, v71, v23
    v_mul_f32 v72, v72, v23
    v_mul_f32 v73, v73, v23
    v_mul_f32 v74, v74, v23
    v_mul_f32 v75, v75, v23
    v_cvt_pk_bf16_f32 v68, v68, v69
    v_cvt_pk_bf16_f32 v69, v70, v71
    v_cvt_pk_bf16_f32 v70, v72, v73
    v_cvt_pk_bf16_f32 v71, v74, v75
    s_nop 1
    v_permlane16_swap_b32 v68, v70
    v_permlane16_swap_b32 v69, v71
    buffer_store_dwordx4 v[68:71], v15, s[20:23], s44 offen offset:64 sc1
    v_mul_f32 v76, v76, v23
    v_mul_f32 v77, v77, v23
    v_mul_f32 v78, v78, v23
    v_mul_f32 v79, v79, v23
    v_mul_f32 v80, v80, v23
    v_mul_f32 v81, v81, v23
    v_mul_f32 v82, v82, v23
    v_mul_f32 v83, v83, v23
    v_cvt_pk_bf16_f32 v76, v76, v77
    v_cvt_pk_bf16_f32 v77, v78, v79
    v_cvt_pk_bf16_f32 v78, v80, v81
    v_cvt_pk_bf16_f32 v79, v82, v83
    s_nop 1
    v_permlane16_swap_b32 v76, v78
    v_permlane16_swap_b32 v77, v79
    buffer_store_dwordx4 v[76:79], v15, s[20:23], s44 offen offset:128 sc1
    v_mul_f32 v84, v84, v23
    v_mul_f32 v85, v85, v23
    v_mul_f32 v86, v86, v23
    v_mul_f32 v87, v87, v23
    v_mul_f32 v88, v88, v23
    v_mul_f32 v89, v89, v23
    v_mul_f32 v90, v90, v23
    v_mul_f32 v91, v91, v23
    v_cvt_pk_bf16_f32 v84, v84, v85
    v_cvt_pk_bf16_f32 v85, v86, v87
    v_cvt_pk_bf16_f32 v86, v88, v89
    v_cvt_pk_bf16_f32 v87, v90, v91
    s_nop 1
    v_permlane16_swap_b32 v84, v86
    v_permlane16_swap_b32 v85, v87
    buffer_store_dwordx4 v[84:87], v15, s[20:23], s44 offen offset:192 sc1
    s_mov_b32 s27, 0
    s_mov_b32 s27, 1
    s_mul_i32 s44, s24, 9437184
    s_mul_i32 s45, s25, 1179648
    s_add_u32 s44, s44, s45
    s_lshl_b32 s45, s26, 8
    s_add_u32 s44, s44, s45
    s_add_u32 s20, s40, s44
    s_addc_u32 s21, s41, 0
    s_mov_b32 s22, 1171712
    s_mov_b32 s23, 0x20000
    v_mov_b32 v28, 0
    v_mov_b32 v29, 0
    v_mov_b32 v30, 0
    v_mov_b32 v31, 0
    v_mov_b32 v32, 0
    v_mov_b32 v33, 0
    v_mov_b32 v34, 0
    v_mov_b32 v35, 0
    v_mov_b32 v36, 0
    v_mov_b32 v37, 0
    v_mov_b32 v38, 0
    v_mov_b32 v39, 0
    v_mov_b32 v40, 0
    v_mov_b32 v41, 0
    v_mov_b32 v42, 0
    v_mov_b32 v43, 0
    v_mov_b32 v44, 0
    v_mov_b32 v45, 0
    v_mov_b32 v46, 0
    v_mov_b32 v47, 0
    v_mov_b32 v48, 0
    v_mov_b32 v49, 0
    v_mov_b32 v50, 0
    v_mov_b32 v51, 0
    v_mov_b32 v52, 0
    v_mov_b32 v53, 0
    v_mov_b32 v54, 0
    v_mov_b32 v55, 0
    v_mov_b32 v56, 0
    v_mov_b32 v57, 0
    v_mov_b32 v58, 0
    v_mov_b32 v59, 0
    v_mov_b32 v92, 0
    v_mov_b32 v93, 0
    v_mov_b32 v94, 0
    v_mov_b32 v95, 0
    v_mov_b32 v60, 0
    v_mov_b32 v61, 0
    v_mov_b32 v62, 0
    v_mov_b32 v63, 0
    v_mov_b32 v64, 0
    v_mov_b32 v65, 0
    v_mov_b32 v66, 0
    v_mov_b32 v67, 0
    v_mov_b32 v68, 0
    v_mov_b32 v69, 0
    v_mov_b32 v70, 0
    v_mov_b32 v71, 0
    v_mov_b32 v72, 0
    v_mov_b32 v73, 0
    v_mov_b32 v74, 0
    v_mov_b32 v75, 0
    v_mov_b32 v76, 0
    v_mov_b32 v77, 0
    v_mov_b32 v78, 0
    v_mov_b32 v79, 0
    v_mov_b32 v80, 0
    v_mov_b32 v81, 0
    v_mov_b32 v82, 0
    v_mov_b32 v83, 0
    v_mov_b32 v84, 0
    v_mov_b32 v85, 0
    v_mov_b32 v86, 0
    v_mov_b32 v87, 0
    v_mov_b32 v88, 0
    v_mov_b32 v89, 0
    v_mov_b32 v90, 0
    v_mov_b32 v91, 0
    v_mov_b32 v96, 0
    v_mov_b32 v97, 0
    v_mov_b32 v98, 0
    v_mov_b32 v99, 0
    s_nop 3
    v_max3_f32 v22, v204, v205, v206
    v_max3_f32 v23, v212, v213, v214
    v_max3_f32 v22, v22, v207, v208
    v_max3_f32 v23, v23, v215, v216
    v_max3_f32 v22, v22, v209, v210
    v_max3_f32 v23, v23, v217, v218
    v_max_f32 v22, v22, v211
    v_max_f32 v23, v23, v219
    v_max_f32 v14, v22, v23
    v_cmp_lt_f32 vcc, s29, v14
    s_call_b64 s[72:73], L_k1_rinitB
    s_mov_b32 s49, 0
L_attn_loop_17:
    s_waitcnt lgkmcnt(0)
    v_mfma_f32_16x16x32_bf16 v[220:223], v[140:143], v[108:111], v[100:103]
    v_exp_f32 v204, v204
    ds_read_b64_tr_b16 v[172:173], v6 offset:0
    v_exp_f32 v205, v205
    v_mfma_f32_16x16x32_bf16 v[228:231], v[140:143], v[124:127], v[104:107]
    ds_read_b64_tr_b16 v[174:175], v6 offset:4096
    v_exp_f32 v206, v206
    ds_read_b64_tr_b16 v[176:177], v7 offset:0
    v_mfma_f32_16x16x32_bf16 v[224:227], v[156:159], v[108:111], v[100:103]
    v_exp_f32 v207, v207
    ds_read_b64_tr_b16 v[178:179], v7 offset:4096
    v_mfma_f32_16x16x32_bf16 v[232:235], v[156:159], v[124:127], v[104:107]
    v_cvt_pk_bf16_f32 v236, v204, v205
    v_exp_f32 v208, v208
    ds_read_b64_tr_b16 v[180:181], v8 offset:0
    v_mfma_f32_16x16x32_bf16 v[220:223], v[144:147], v[112:115], v[220:223]
    v_exp_f32 v209, v209
    ds_read_b64_tr_b16 v[182:183], v8 offset:4096
    v_mfma_f32_16x16x32_bf16 v[228:231], v[144:147], v[128:131], v[228:231]
    v_cvt_pk_bf16_f32 v237, v206, v207
    v_exp_f32 v210, v210
    ds_read_b64_tr_b16 v[184:185], v9 offset:0
    v_mfma_f32_16x16x32_bf16 v[224:227], v[160:163], v[112:115], v[224:227]
    v_exp_f32 v211, v211
    ds_read_b64_tr_b16 v[186:187], v9 offset:4096
    v_mfma_f32_16x16x32_bf16 v[232:235], v[160:163], v[128:131], v[232:235]
    v_cvt_pk_bf16_f32 v238, v208, v209
    v_exp_f32 v212, v212
    ds_read_b64_tr_b16 v[188:189], v10 offset:0
    v_mfma_f32_16x16x32_bf16 v[220:223], v[148:151], v[116:119], v[220:223]
    v_exp_f32 v213, v213
    ds_read_b64_tr_b16 v[190:191], v10 offset:4096
    v_cvt_pk_bf16_f32 v239, v210, v211
    v_mfma_f32_16x16x32_bf16 v[228:231], v[148:151], v[132:135], v[228:231]
    v_exp_f32 v214, v214
    ds_read_b64_tr_b16 v[192:193], v11 offset:0
    v_mfma_f32_16x16x32_bf16 v[224:227], v[164:167], v[116:119], v[224:227]
    v_exp_f32 v215, v215
    ds_read_b64_tr_b16 v[194:195], v11 offset:4096
    v_cvt_pk_bf16_f32 v240, v212, v213
    v_mfma_f32_16x16x32_bf16 v[232:235], v[164:167], v[132:135], v[232:235]
    v_exp_f32 v216, v216
    ds_read_b64_tr_b16 v[196:197], v12 offset:0
    v_mfma_f32_16x16x32_bf16 v[220:223], v[152:155], v[120:123], v[220:223]
    v_exp_f32 v217, v217
    ds_read_b64_tr_b16 v[198:199], v12 offset:4096
    v_cvt_pk_bf16_f32 v241, v214, v215
    v_mfma_f32_16x16x32_bf16 v[228:231], v[152:155], v[136:139], v[228:231]
    v_exp_f32 v218, v218
    ds_read_b64_tr_b16 v[200:201], v13 offset:0
    v_mfma_f32_16x16x32_bf16 v[224:227], v[168:171], v[120:123], v[224:227]
    v_exp_f32 v219, v219
    ds_read_b64_tr_b16 v[202:203], v13 offset:4096
    v_cvt_pk_bf16_f32 v242, v216, v217
    v_mfma_f32_16x16x32_bf16 v[232:235], v[168:171], v[136:139], v[232:235]
    s_nop 0
    v_cvt_pk_bf16_f32 v243, v218, v219
    s_waitcnt lgkmcnt(0)
    s_barrier
    v_mfma_f32_16x16x32_bf16 v[28:31], v[172:175], v[236:239], v[28:31]
    ds_read_b128 v[140:143], v2 offset:0
    ds_read_b128 v[156:159], v2 offset:4096
    ds_read_b128 v[144:147], v3 offset:0
    v_mfma_f32_16x16x32_bf16 v[60:63], v[172:175], v[240:243], v[60:63]
    ds_read_b128 v[160:163], v3 offset:4096
    ds_read_b128 v[148:151], v4 offset:0
    v_mfma_f32_16x16x32_bf16 v[32:35], v[176:179], v[236:239], v[32:35]
    ds_read_b128 v[164:167], v4 offset:4096
    ds_read_b128 v[152:155], v5 offset:0
    v_mfma_f32_16x16x32_bf16 v[64:67], v[176:179], v[240:243], v[64:67]
    ds_read_b128 v[168:171], v5 offset:4096
    s_cmp_eq_u32 s76, 4
    v_mfma_f32_16x16x32_bf16 v[36:39], v[180:183], v[236:239], v[36:39]
    s_cselect_b32 s78, s81, s80
    s_add_u32 s76, s76, 1
    v_mfma_f32_16x16x32_bf16 v[68:71], v[180:183], v[240:243], v[68:71]
    s_cmp_eq_u32 s76, 5
    s_cselect_b32 s76, 0, s76
    v_mfma_f32_16x16x32_bf16 v[40:43], v[184:187], v[236:239], v[40:43]
    v_add_u32 v6, s78, v6
    v_add_u32 v7, s78, v7
    v_add_u32 v8, s78, v8
    v_mfma_f32_16x16x32_bf16 v[72:75], v[184:187], v[240:243], v[72:75]
    v_add_u32 v9, s78, v9
    v_add_u32 v10, s78, v10
    v_mfma_f32_16x16x32_bf16 v[92:95], v[24:27], v[236:239], v[92:95]
    v_add_u32 v11, s78, v11
    v_add_u32 v12, s78, v12
    v_mfma_f32_16x16x32_bf16 v[96:99], v[24:27], v[240:243], v[96:99]
    v_add_u32 v13, s78, v13
    s_cmp_eq_u32 s77, 4
    v_mfma_f32_16x16x32_bf16 v[44:47], v[188:191], v[236:239], v[44:47]
    s_cselect_b32 s79, s81, s80
    s_add_u32 s77, s77, 1
    v_mfma_f32_16x16x32_bf16 v[76:79], v[188:191], v[240:243], v[76:79]
    s_cmp_eq_u32 s77, 5
    s_cselect_b32 s77, 0, s77
    v_mfma_f32_16x16x32_bf16 v[48:51], v[192:195], v[236:239], v[48:51]
    v_add_u32 v2, s79, v2
    v_add_u32 v3, s79, v3
    v_add_u32 v4, s79, v4
    v_mfma_f32_16x16x32_bf16 v[80:83], v[192:195], v[240:243], v[80:83]
    v_add_u32 v5, s79, v5
    v_max3_f32 v22, v220, v221, v222
    v_mfma_f32_16x16x32_bf16 v[52:55], v[196:199], v[236:239], v[52:55]
    v_max3_f32 v23, v228, v229, v230
    v_max3_f32 v22, v22, v223, v224
    v_mfma_f32_16x16x32_bf16 v[84:87], v[196:199], v[240:243], v[84:87]
    v_max3_f32 v23, v23, v231, v232
    v_max3_f32 v22, v22, v225, v226
    v_mfma_f32_16x16x32_bf16 v[56:59], v[200:203], v[236:239], v[56:59]
    v_max3_f32 v23, v23, v233, v234
    v_max_f32 v22, v22, v227
    v_mfma_f32_16x16x32_bf16 v[88:91], v[200:203], v[240:243], v[88:91]
    v_max_f32 v23, v23, v235
    v_max_f32 v14, v22, v23
    v_cmp_lt_f32 vcc, s29, v14
    s_cbranch_vccnz L_rare_18
L_back_19:
    s_waitcnt lgkmcnt(0)
    v_mfma_f32_16x16x32_bf16 v[204:207], v[140:143], v[108:111], v[100:103]
    v_exp_f32 v220, v220
    ds_read_b64_tr_b16 v[172:173], v6 offset:0
    v_exp_f32 v221, v221
    v_mfma_f32_16x16x32_bf16 v[212:215], v[140:143], v[124:127], v[104:107]
    ds_read_b64_tr_b16 v[174:175], v6 offset:4096
    v_exp_f32 v222, v222
    ds_read_b64_tr_b16 v[176:177], v7 offset:0
    v_mfma_f32_16x16x32_bf16 v[208:211], v[156:159], v[108:111], v[100:103]
    v_exp_f32 v223, v223
    ds_read_b64_tr_b16 v[178:179], v7 offset:4096
    v_mfma_f32_16x16x32_bf16 v[216:219], v[156:159], v[124:127], v[104:107]
    v_cvt_pk_bf16_f32 v236, v220, v221
    v_exp_f32 v224, v224
    ds_read_b64_tr_b16 v[180:181], v8 offset:0
    v_mfma_f32_16x16x32_bf16 v[204:207], v[144:147], v[112:115], v[204:207]
    v_exp_f32 v225, v225
    ds_read_b64_tr_b16 v[182:183], v8 offset:4096
    v_mfma_f32_16x16x32_bf16 v[212:215], v[144:147], v[128:131], v[212:215]
    v_cvt_pk_bf16_f32 v237, v222, v223
    v_exp_f32 v226, v226
    ds_read_b64_tr_b16 v[184:185], v9 offset:0
    v_mfma_f32_16x16x32_bf16 v[208:211], v[160:163], v[112:115], v[208:211]
    v_exp_f32 v227, v227
    ds_read_b64_tr_b16 v[186:187], v9 offset:4096
    v_mfma_f32_16x16x32_bf16 v[216:219], v[160:163], v[128:131], v[216:219]
    v_cvt_pk_bf16_f32 v238, v224, v225
    v_exp_f32 v228, v228
    ds_read_b64_tr_b16 v[188:189], v10 offset:0
    v_mfma_f32_16x16x32_bf16 v[204:207], v[148:151], v[116:119], v[204:207]
    v_exp_f32 v229, v229
    ds_read_b64_tr_b16 v[190:191], v10 offset:4096
    v_cvt_pk_bf16_f32 v239, v226, v227
    v_mfma_f32_16x16x32_bf16 v[212:215], v[148:151], v[132:135], v[212:215]
    v_exp_f32 v230, v230
    ds_read_b64_tr_b16 v[192:193], v11 offset:0
    v_mfma_f32_16x16x32_bf16 v[208:211], v[164:167], v[116:119], v[208:211]
    v_exp_f32 v231, v231
    ds_read_b64_tr_b16 v[194:195], v11 offset:4096
    v_cvt_pk_bf16_f32 v240, v228, v229
    v_mfma_f32_16x16x32_bf16 v[216:219], v[164:167], v[132:135], v[216:219]
    v_exp_f32 v232, v232
    ds_read_b64_tr_b16 v[196:197], v12 offset:0
    v_mfma_f32_16x16x32_bf16 v[204:207], v[152:155], v[120:123], v[204:207]
    v_exp_f32 v233, v233
    ds_read_b64_tr_b16 v[198:199], v12 offset:4096
    v_cvt_pk_bf16_f32 v241, v230, v231
    v_mfma_f32_16x16x32_bf16 v[212:215], v[152:155], v[136:139], v[212:215]
    v_exp_f32 v234, v234
    ds_read_b64_tr_b16 v[200:201], v13 offset:0
    v_mfma_f32_16x16x32_bf16 v[208:211], v[168:171], v[120:123], v[208:211]
    v_exp_f32 v235, v235
    ds_read_b64_tr_b16 v[202:203], v13 offset:4096
    v_cvt_pk_bf16_f32 v242, v232, v233
    v_mfma_f32_16x16x32_bf16 v[216:219], v[168:171], v[136:139], v[216:219]
    s_nop 0
    v_cvt_pk_bf16_f32 v243, v234, v235
    s_waitcnt lgkmcnt(0) vmcnt(0)
    s_barrier
    s_cmp_eq_u32 s49, 15
    s_cselect_b32 s29, 0x7f800000, s29
    v_mfma_f32_16x16x32_bf16 v[28:31], v[172:175], v[236:239], v[28:31]
    ds_read_b128 v[140:143], v2 offset:0
    ds_read_b128 v[156:159], v2 offset:4096
    ds_read_b128 v[144:147], v3 offset:0
    v_mfma_f32_16x16x32_bf16 v[60:63], v[172:175], v[240:243], v[60:63]
    ds_read_b128 v[160:163], v3 offset:4096
    ds_read_b128 v[148:151], v4 offset:0
    v_mfma_f32_16x16x32_bf16 v[32:35], v[176:179], v[236:239], v[32:35]
    ds_read_b128 v[164:167], v4 offset:4096
    ds_read_b128 v[152:155], v5 offset:0
    v_mfma_f32_16x16x32_bf16 v[64:67], v[176:179], v[240:243], v[64:67]
    ds_read_b128 v[168:171], v5 offset:4096
    s_cmp_eq_u32 s76, 4
    v_mfma_f32_16x16x32_bf16 v[36:39], v[180:183], v[236:239], v[36:39]
    s_cselect_b32 s78, s81, s80
    s_add_u32 s76, s76, 1
    v_mfma_f32_16x16x32_bf16 v[68:71], v[180:183], v[240:243], v[68:71]
    s_cmp_eq_u32 s76, 5
    s_cselect_b32 s76, 0, s76
    v_mfma_f32_16x16x32_bf16 v[40:43], v[184:187], v[236:239], v[40:43]
    v_add_u32 v6, s78, v6
    v_add_u32 v7, s78, v7
    v_add_u32 v8, s78, v8
    v_mfma_f32_16x16x32_bf16 v[72:75], v[184:187], v[240:243], v[72:75]
    v_add_u32 v9, s78, v9
    v_add_u32 v10, s78, v10
    v_mfma_f32_16x16x32_bf16 v[92:95], v[24:27], v[236:239], v[92:95]
    v_add_u32 v11, s78, v11
    v_add_u32 v12, s78, v12
    v_mfma_f32_16x16x32_bf16 v[96:99], v[24:27], v[240:243], v[96:99]
    v_add_u32 v13, s78, v13
    s_cmp_eq_u32 s77, 4
    v_mfma_f32_16x16x32_bf16 v[44:47], v[188:191], v[236:239], v[44:47]
    s_cselect_b32 s79, s81, s80
    s_add_u32 s77, s77, 1
    v_mfma_f32_16x16x32_bf16 v[76:79], v[188:191], v[240:243], v[76:79]
    s_cmp_eq_u32 s77, 5
    s_cselect_b32 s77, 0, s77
    v_mfma_f32_16x16x32_bf16 v[48:51], v[192:195], v[236:239], v[48:51]
    v_add_u32 v2, s79, v2
    v_add_u32 v3, s79, v3
    v_add_u32 v4, s79, v4
    v_mfma_f32_16x16x32_bf16 v[80:83], v[192:195], v[240:243], v[80:83]
    v_add_u32 v5, s79, v5
    v_max3_f32 v22, v204, v205, v206
    v_mfma_f32_16x16x32_bf16 v[52:55], v[196:199], v[236:239], v[52:55]
    v_max3_f32 v23, v212, v213, v214
    v_max3_f32 v22, v22, v207, v208
    v_mfma_f32_16x16x32_bf16 v[84:87], v[196:199], v[240:243], v[84:87]
    v_max3_f32 v23, v23, v215, v216
    v_max3_f32 v22, v22, v209, v210
    v_mfma_f32_16x16x32_bf16 v[56:59], v[200:203], v[236:239], v[56:59]
    v_max3_f32 v23, v23, v217, v218
    v_max_f32 v22, v22, v211
    v_mfma_f32_16x16x32_bf16 v[88:91], v[200:203], v[240:243], v[88:91]
    v_max_f32 v23, v23, v219
    v_max_f32 v14, v22, v23
    v_cmp_lt_f32 vcc, s29, v14
    s_cbranch_vccnz L_rare_20
L_back_21:
    s_add_u32 s49, s49, 1
    s_cmp_lt_u32 s49, 16
    s_cbranch_scc1 L_attn_loop_17
    v_lshrrev_b32 v14, 4, v1
    v_and_b32 v15, 15, v1
    v_and_b32 v16, 1, v14
    v_lshlrev_b32 v16, 5, v16
    v_lshrrev_b32 v14, 1, v14
    v_lshl_add_u32 v16, v14, 4, v16
    v_lshl_add_u32 v15, v15, 13, v16
    s_mul_i32 s44, s53, 131072
    v_rcp_f32 v22, v92
    v_rcp_f32 v23, v96
    s_nop 0
    v_mul_f32 v28, v28, v22
    v_mul_f32 v29, v29, v22
    v_mul_f32 v30, v30, v22
    v_mul_f32 v31, v31, v22
    v_mul_f32 v32, v32, v22
    v_mul_f32 v33, v33, v22
    v_mul_f32 v34, v34, v22
    v_mul_f32 v35, v35, v22
    v_cvt_pk_bf16_f32 v28, v28, v29
    v_cvt_pk_bf16_f32 v29, v30, v31
    v_cvt_pk_bf16_f32 v30, v32, v33
    v_cvt_pk_bf16_f32 v31, v34, v35
    s_nop 1
    v_permlane16_swap_b32 v28, v30
    v_permlane16_swap_b32 v29, v31
    buffer_store_dwordx4 v[28:31], v15, s[20:23], s44 offen offset:0 sc1
    v_mul_f32 v36, v36, v22
    v_mul_f32 v37, v37, v22
    v_mul_f32 v38, v38, v22
    v_mul_f32 v39, v39, v22
    v_mul_f32 v40, v40, v22
    v_mul_f32 v41, v41, v22
    v_mul_f32 v42, v42, v22
    v_mul_f32 v43, v43, v22
    v_cvt_pk_bf16_f32 v36, v36, v37
    v_cvt_pk_bf16_f32 v37, v38, v39
    v_cvt_pk_bf16_f32 v38, v40, v41
    v_cvt_pk_bf16_f32 v39, v42, v43
    s_nop 1
    v_permlane16_swap_b32 v36, v38
    v_permlane16_swap_b32 v37, v39
    buffer_store_dwordx4 v[36:39], v15, s[20:23], s44 offen offset:64 sc1
    v_mul_f32 v44, v44, v22
    v_mul_f32 v45, v45, v22
    v_mul_f32 v46, v46, v22
    v_mul_f32 v47, v47, v22
    v_mul_f32 v48, v48, v22
    v_mul_f32 v49, v49, v22
    v_mul_f32 v50, v50, v22
    v_mul_f32 v51, v51, v22
    v_cvt_pk_bf16_f32 v44, v44, v45
    v_cvt_pk_bf16_f32 v45, v46, v47
    v_cvt_pk_bf16_f32 v46, v48, v49
    v_cvt_pk_bf16_f32 v47, v50, v51
    s_nop 1
    v_permlane16_swap_b32 v44, v46
    v_permlane16_swap_b32 v45, v47
    buffer_store_dwordx4 v[44:47], v15, s[20:23], s44 offen offset:128 sc1
    v_mul_f32 v52, v52, v22
    v_mul_f32 v53, v53, v22
    v_mul_f32 v54, v54, v22
    v_mul_f32 v55, v55, v22
    v_mul_f32 v56, v56, v22
    v_mul_f32 v57, v57, v22
    v_mul_f32 v58, v58, v22
    v_mul_f32 v59, v59, v22
    v_cvt_pk_bf16_f32 v52, v52, v53
    v_cvt_pk_bf16_f32 v53, v54, v55
    v_cvt_pk_bf16_f32 v54, v56, v57
    v_cvt_pk_bf16_f32 v55, v58, v59
    s_nop 1
    v_permlane16_swap_b32 v52, v54
    v_permlane16_swap_b32 v53, v55
    buffer_store_dwordx4 v[52:55], v15, s[20:23], s44 offen offset:192 sc1
    s_add_u32 s44, s44, 131072
    v_mul_f32 v60, v60, v23
    v_mul_f32 v61, v61, v23
    v_mul_f32 v62, v62, v23
    v_mul_f32 v63, v63, v23
    v_mul_f32 v64, v64, v23
    v_mul_f32 v65, v65, v23
    v_mul_f32 v66, v66, v23
    v_mul_f32 v67, v67, v23
    v_cvt_pk_bf16_f32 v60, v60, v61
    v_cvt_pk_bf16_f32 v61, v62, v63
    v_cvt_pk_bf16_f32 v62, v64, v65
    v_cvt_pk_bf16_f32 v63, v66, v67
    s_nop 1
    v_permlane16_swap_b32 v60, v62
    v_permlane16_swap_b32 v61, v63
    buffer_store_dwordx4 v[60:63], v15, s[20:23], s44 offen offset:0 sc1
    v_mul_f32 v68, v68, v23
    v_mul_f32 v69, v69, v23
    v_mul_f32 v70, v70, v23
    v_mul_f32 v71, v71, v23
    v_mul_f32 v72, v72, v23
    v_mul_f32 v73, v73, v23
    v_mul_f32 v74, v74, v23
    v_mul_f32 v75, v75, v23
    v_cvt_pk_bf16_f32 v68, v68, v69
    v_cvt_pk_bf16_f32 v69, v70, v71
    v_cvt_pk_bf16_f32 v70, v72, v73
    v_cvt_pk_bf16_f32 v71, v74, v75
    s_nop 1
    v_permlane16_swap_b32 v68, v70
    v_permlane16_swap_b32 v69, v71
    buffer_store_dwordx4 v[68:71], v15, s[20:23], s44 offen offset:64 sc1
    v_mul_f32 v76, v76, v23
    v_mul_f32 v77, v77, v23
    v_mul_f32 v78, v78, v23
    v_mul_f32 v79, v79, v23
    v_mul_f32 v80, v80, v23
    v_mul_f32 v81, v81, v23
    v_mul_f32 v82, v82, v23
    v_mul_f32 v83, v83, v23
    v_cvt_pk_bf16_f32 v76, v76, v77
    v_cvt_pk_bf16_f32 v77, v78, v79
    v_cvt_pk_bf16_f32 v78, v80, v81
    v_cvt_pk_bf16_f32 v79, v82, v83
    s_nop 1
    v_permlane16_swap_b32 v76, v78
    v_permlane16_swap_b32 v77, v79
    buffer_store_dwordx4 v[76:79], v15, s[20:23], s44 offen offset:128 sc1
    v_mul_f32 v84, v84, v23
    v_mul_f32 v85, v85, v23
    v_mul_f32 v86, v86, v23
    v_mul_f32 v87, v87, v23
    v_mul_f32 v88, v88, v23
    v_mul_f32 v89, v89, v23
    v_mul_f32 v90, v90, v23
    v_mul_f32 v91, v91, v23
    v_cvt_pk_bf16_f32 v84, v84, v85
    v_cvt_pk_bf16_f32 v85, v86, v87
    v_cvt_pk_bf16_f32 v86, v88, v89
    v_cvt_pk_bf16_f32 v87, v90, v91
    s_nop 1
    v_permlane16_swap_b32 v84, v86
    v_permlane16_swap_b32 v85, v87
    buffer_store_dwordx4 v[84:87], v15, s[20:23], s44 offen offset:192 sc1
    s_and_b32 s44, s2, 7
    s_lshr_b32 s45, s2, 3
    s_lshr_b32 s24, s44, 2
    s_lshr_b32 s27, s44, 1
    s_and_b32 s27, s27, 1
    s_and_b32 s51, s44, 1
    s_lshl_b32 s51, s51, 2
    s_and_b32 s25, s45, 3
    s_add_u32 s25, s25, s51
    s_lshr_b32 s26, s45, 2
    s_mov_b32 s31, 0
    s_mov_b32 s32, s96
    s_mov_b32 s33, s97
    s_nop 0
    v_readfirstlane_b32 s91, v20
    s_nop 3
    v_lshrrev_b32 v14, 4, v1
    v_and_b32 v15, 15, v1
    v_lshrrev_b32 v16, 1, v15
    v_xor_b32 v16, v16, v14
    v_lshlrev_b32 v16, 4, v16
    v_lshl_add_u32 v2, v15, 7, v16
    s_lshr_b32 s45, s3, 1
    s_lshl_b32 s44, s45, 6
    v_xor_b32 v2, s44, v2
    v_lshrrev_b32 v16, 2, v15
    v_and_b32 v17, 1, v14
    v_lshl_add_u32 v17, v17, 2, v16
    s_and_b32 s44, s3, 1
    s_lshl_b32 s44, s44, 2
    v_xor_b32 v18, s44, v17
    v_lshlrev_b32 v18, 5, v18
    v_lshl_add_u32 v18, v14, 11, v18
    v_lshl_add_u32 v18, v16, 8, v18
    v_and_b32 v19, 3, v15
    v_lshl_add_u32 v18, v19, 3, v18
    s_lshl_b32 s45, s45, 13
    s_add_u32 s45, s45, 18432
    v_add_u32 v4, s45, v18
    v_xor_b32 v5, 32, v4
    v_xor_b32 v6, 64, v4
    v_xor_b32 v7, 96, v4
    s_mul_i32 s44, s25, 589824
    s_lshl_b32 s45, s24, 11
    s_add_u32 s44, s44, s45
    s_lshl_b32 s45, s26, 8
    s_add_u32 s44, s44, s45
    s_add_u32 s20, s54, s44
    s_addc_u32 s21, s55, 0
    s_mov_b32 s22, 585984
    s_mov_b32 s23, 0x20000
    s_lshl_b32 s51, s24, 3
    s_add_u32 s51, s51, s25
    s_lshl_b32 s51, s51, 3
    s_add_u32 s51, s51, s26
    s_lshl_b32 s51, s51, 1
    s_add_u32 s52, s51, s27
    s_lshl_b32 s52, s52, 2
    s_add_u32 s53, s52, s3
    s_xor_b32 s30, s53, 4
    s_add_u32 s68, s40, 33554432
    s_addc_u32 s69, s41, 0
    s_mov_b32 s70, 10485760
    s_mov_b32 s71, 0x20000
    s_add_u32 s64, s40, 50331648
    s_addc_u32 s65, s41, 0
    s_mov_b32 s66, 4096
    s_mov_b32 s67, 0x20000
    s_barrier
    ds_read_b128 v[172:175], v2 offset:0
    ds_read_b128 v[176:179], v2 offset:2048
    ds_read_b64_tr_b16 v[208:209], v4 offset:0
    ds_read_b64_tr_b16 v[210:211], v4 offset:1024
    ds_read_b64_tr_b16 v[212:213], v5 offset:0
    ds_read_b64_tr_b16 v[214:215], v5 offset:1024
    ds_read_b64_tr_b16 v[216:217], v6 offset:0
    ds_read_b64_tr_b16 v[218:219], v6 offset:1024
    ds_read_b64_tr_b16 v[220:221], v7 offset:0
    ds_read_b64_tr_b16 v[222:223], v7 offset:1024
    ds_read_b128 v[180:183], v2 offset:4096
    ds_read_b128 v[184:187], v2 offset:6144
    ds_read_b128 v[188:191], v2 offset:8192
    ds_read_b128 v[192:195], v2 offset:10240
    ds_read_b128 v[196:199], v2 offset:12288
    ds_read_b128 v[200:203], v2 offset:14336
    ds_read_b128 v[204:207], v2 offset:16384
    s_waitcnt lgkmcnt(7)
    v_mfma_f32_16x16x32_bf16 v[28:31], v[208:211], v[172:175], 0
    v_mfma_f32_16x16x32_bf16 v[64:67], v[212:215], v[172:175], 0
    v_mfma_f32_16x16x32_bf16 v[100:103], v[216:219], v[172:175], 0
    v_mfma_f32_16x16x32_bf16 v[136:139], v[220:223], v[172:175], 0
    s_waitcnt lgkmcnt(15)
    v_mfma_f32_16x16x32_bf16 v[32:35], v[208:211], v[176:179], 0
    v_mfma_f32_16x16x32_bf16 v[68:71], v[212:215], v[176:179], 0
    v_mfma_f32_16x16x32_bf16 v[104:107], v[216:219], v[176:179], 0
    v_mfma_f32_16x16x32_bf16 v[140:143], v[220:223], v[176:179], 0
    s_waitcnt lgkmcnt(0) vmcnt(0)
    s_barrier
    v_add_u32 v2, 0x8800, v2
    v_add_u32 v4, 0x8800, v4
    v_add_u32 v5, 0x8800, v5
    v_add_u32 v6, 0x8800, v6
    v_add_u32 v7, 0x8800, v7
    ds_read_b128 v[172:175], v2 offset:0
    ds_read_b128 v[176:179], v2 offset:2048
    ds_read_b64_tr_b16 v[224:225], v4 offset:0
    ds_read_b64_tr_b16 v[226:227], v4 offset:1024
    v_mfma_f32_16x16x32_bf16 v[36:39], v[208:211], v[180:183], 0
    v_mfma_f32_16x16x32_bf16 v[72:75], v[212:215], v[180:183], 0
    v_mfma_f32_16x16x32_bf16 v[108:111], v[216:219], v[180:183], 0
    v_mfma_f32_16x16x32_bf16 v[144:147], v[220:223], v[180:183], 0
    ds_read_b64_tr_b16 v[228:229], v5 offset:0
    ds_read_b64_tr_b16 v[230:231], v5 offset:1024
    ds_read_b128 v[180:183], v2 offset:4096
    v_mfma_f32_16x16x32_bf16 v[40:43], v[208:211], v[184:187], 0
    v_mfma_f32_16x16x32_bf16 v[76:79], v[212:215], v[184:187], 0
    v_mfma_f32_16x16x32_bf16 v[112:115], v[216:219], v[184:187], 0
    v_mfma_f32_16x16x32_bf16 v[148:151], v[220:223], v[184:187], 0
    ds_read_b64_tr_b16 v[232:233], v6 offset:0
    ds_read_b64_tr_b16 v[234:235], v6 offset:1024
    ds_read_b128 v[184:187], v2 offset:6144
    v_mfma_f32_16x16x32_bf16 v[44:47], v[208:211], v[188:191], 0
    v_mfma_f32_16x16x32_bf16 v[80:83], v[212:215], v[188:191], 0
    v_mfma_f32_16x16x32_bf16 v[116:119], v[216:219], v[188:191], 0
    v_mfma_f32_16x16x32_bf16 v[152:155], v[220:223], v[188:191], 0
    ds_read_b64_tr_b16 v[236:237], v7 offset:0
    ds_read_b64_tr_b16 v[238:239], v7 offset:1024
    ds_read_b128 v[188:191], v2 offset:8192
    v_mfma_f32_16x16x32_bf16 v[48:51], v[208:211], v[192:195], 0
    v_mfma_f32_16x16x32_bf16 v[84:87], v[212:215], v[192:195], 0
    v_mfma_f32_16x16x32_bf16 v[120:123], v[216:219], v[192:195], 0
    v_mfma_f32_16x16x32_bf16 v[156:159], v[220:223], v[192:195], 0
    ds_read_b128 v[192:195], v2 offset:10240
    v_mfma_f32_16x16x32_bf16 v[52:55], v[208:211], v[196:199], 0
    v_mfma_f32_16x16x32_bf16 v[88:91], v[212:215], v[196:199], 0
    v_mfma_f32_16x16x32_bf16 v[124:127], v[216:219], v[196:199], 0
    v_mfma_f32_16x16x32_bf16 v[160:163], v[220:223], v[196:199], 0
    ds_read_b128 v[196:199], v2 offset:12288
    v_mfma_f32_16x16x32_bf16 v[56:59], v[208:211], v[200:203], 0
    v_mfma_f32_16x16x32_bf16 v[92:95], v[212:215], v[200:203], 0
    v_mfma_f32_16x16x32_bf16 v[128:131], v[216:219], v[200:203], 0
    v_mfma_f32_16x16x32_bf16 v[164:167], v[220:223], v[200:203], 0
    ds_read_b128 v[200:203], v2 offset:14336
    v_mfma_f32_16x16x32_bf16 v[60:63], v[208:211], v[204:207], 0
    v_mfma_f32_16x16x32_bf16 v[96:99], v[212:215], v[204:207], 0
    v_mfma_f32_16x16x32_bf16 v[132:135], v[216:219], v[204:207], 0
    v_mfma_f32_16x16x32_bf16 v[168:171], v[220:223], v[204:207], 0
    ds_read_b128 v[204:207], v2 offset:16384
    s_mov_b32 s49, 0
L_gkloop_22:
    s_waitcnt lgkmcnt(5)
    v_mfma_f32_16x16x32_bf16 v[28:31], v[224:227], v[172:175], v[28:31]
    v_mfma_f32_16x16x32_bf16 v[64:67], v[228:231], v[172:175], v[64:67]
    v_mfma_f32_16x16x32_bf16 v[100:103], v[232:235], v[172:175], v[100:103]
    v_mfma_f32_16x16x32_bf16 v[136:139], v[236:239], v[172:175], v[136:139]
    s_waitcnt lgkmcnt(15)
    v_mfma_f32_16x16x32_bf16 v[32:35], v[224:227], v[176:179], v[32:35]
    v_mfma_f32_16x16x32_bf16 v[68:71], v[228:231], v[176:179], v[68:71]
    v_mfma_f32_16x16x32_bf16 v[104:107], v[232:235], v[176:179], v[104:107]
    v_mfma_f32_16x16x32_bf16 v[140:143], v[236:239], v[176:179], v[140:143]
    s_waitcnt lgkmcnt(0)
    s_barrier
    v_add_u32 v2, 0x8800, v2
    v_add_u32 v4, 0x8800, v4
    v_add_u32 v5, 0x8800, v5
    v_add_u32 v6, 0x8800, v6
    v_add_u32 v7, 0x8800, v7
    ds_read_b128 v[172:175], v2 offset:0
    ds_read_b128 v[176:179], v2 offset:2048
    ds_read_b64_tr_b16 v[208:209], v4 offset:0
    ds_read_b64_tr_b16 v[210:211], v4 offset:1024
    v_mfma_f32_16x16x32_bf16 v[36:39], v[224:227], v[180:183], v[36:39]
    v_mfma_f32_16x16x32_bf16 v[72:75], v[228:231], v[180:183], v[72:75]
    v_mfma_f32_16x16x32_bf16 v[108:111], v[232:235], v[180:183], v[108:111]
    v_mfma_f32_16x16x32_bf16 v[144:147], v[236:239], v[180:183], v[144:147]
    ds_read_b64_tr_b16 v[212:213], v5 offset:0
    ds_read_b64_tr_b16 v[214:215], v5 offset:1024
    ds_read_b128 v[180:183], v2 offset:4096
    v_mfma_f32_16x16x32_bf16 v[40:43], v[224:227], v[184:187], v[40:43]
    v_mfma_f32_16x16x32_bf16 v[76:79], v[228:231], v[184:187], v[76:79]
    v_mfma_f32_16x16x32_bf16 v[112:115], v[232:235], v[184:187], v[112:115]
    v_mfma_f32_16x16x32_bf16 v[148:151], v[236:239], v[184:187], v[148:151]
    ds_read_b64_tr_b16 v[216:217], v6 offset:0
    ds_read_b64_tr_b16 v[218:219], v6 offset:1024
    ds_read_b128 v[184:187], v2 offset:6144
    v_mfma_f32_16x16x32_bf16 v[44:47], v[224:227], v[188:191], v[44:47]
    v_mfma_f32_16x16x32_bf16 v[80:83], v[228:231], v[188:191], v[80:83]
    v_mfma_f32_16x16x32_bf16 v[116:119], v[232:235], v[188:191], v[116:119]
    v_mfma_f32_16x16x32_bf16 v[152:155], v[236:239], v[188:191], v[152:155]
    ds_read_b64_tr_b16 v[220:221], v7 offset:0
    ds_read_b64_tr_b16 v[222:223], v7 offset:1024
    ds_read_b128 v[188:191], v2 offset:8192
    v_mfma_f32_16x16x32_bf16 v[48:51], v[224:227], v[192:195], v[48:51]
    v_mfma_f32_16x16x32_bf16 v[84:87], v[228:231], v[192:195], v[84:87]
    v_mfma_f32_16x16x32_bf16 v[120:123], v[232:235], v[192:195], v[120:123]
    v_mfma_f32_16x16x32_bf16 v[156:159], v[236:239], v[192:195], v[156:159]
    ds_read_b128 v[192:195], v2 offset:10240
    v_mfma_f32_16x16x32_bf16 v[52:55], v[224:227], v[196:199], v[52:55]
    v_mfma_f32_16x16x32_bf16 v[88:91], v[228:231], v[196:199], v[88:91]
    v_mfma_f32_16x16x32_bf16 v[124:127], v[232:235], v[196:199], v[124:127]
    v_mfma_f32_16x16x32_bf16 v[160:163], v[236:239], v[196:199], v[160:163]
    ds_read_b128 v[196:199], v2 offset:12288
    v_mfma_f32_16x16x32_bf16 v[56:59], v[224:227], v[200:203], v[56:59]
    v_mfma_f32_16x16x32_bf16 v[92:95], v[228:231], v[200:203], v[92:95]
    v_mfma_f32_16x16x32_bf16 v[128:131], v[232:235], v[200:203], v[128:131]
    v_mfma_f32_16x16x32_bf16 v[164:167], v[236:239], v[200:203], v[164:167]
    ds_read_b128 v[200:203], v2 offset:14336
    v_mfma_f32_16x16x32_bf16 v[60:63], v[224:227], v[204:207], v[60:63]
    v_mfma_f32_16x16x32_bf16 v[96:99], v[228:231], v[204:207], v[96:99]
    v_mfma_f32_16x16x32_bf16 v[132:135], v[232:235], v[204:207], v[132:135]
    v_mfma_f32_16x16x32_bf16 v[168:171], v[236:239], v[204:207], v[168:171]
    ds_read_b128 v[204:207], v2 offset:16384
    s_waitcnt lgkmcnt(5)
    v_mfma_f32_16x16x32_bf16 v[28:31], v[208:211], v[172:175], v[28:31]
    v_mfma_f32_16x16x32_bf16 v[64:67], v[212:215], v[172:175], v[64:67]
    v_mfma_f32_16x16x32_bf16 v[100:103], v[216:219], v[172:175], v[100:103]
    v_mfma_f32_16x16x32_bf16 v[136:139], v[220:223], v[172:175], v[136:139]
    s_waitcnt lgkmcnt(15)
    v_mfma_f32_16x16x32_bf16 v[32:35], v[208:211], v[176:179], v[32:35]
    v_mfma_f32_16x16x32_bf16 v[68:71], v[212:215], v[176:179], v[68:71]
    v_mfma_f32_16x16x32_bf16 v[104:107], v[216:219], v[176:179], v[104:107]
    v_mfma_f32_16x16x32_bf16 v[140:143], v[220:223], v[176:179], v[140:143]
    s_waitcnt lgkmcnt(0)
    s_barrier
    v_add_u32 v2, 0x8800, v2
    v_add_u32 v4, 0x8800, v4
    v_add_u32 v5, 0x8800, v5
    v_add_u32 v6, 0x8800, v6
    v_add_u32 v7, 0x8800, v7
    ds_read_b128 v[172:175], v2 offset:0
    ds_read_b128 v[176:179], v2 offset:2048
    ds_read_b64_tr_b16 v[224:225], v4 offset:0
    ds_read_b64_tr_b16 v[226:227], v4 offset:1024
    v_mfma_f32_16x16x32_bf16 v[36:39], v[208:211], v[180:183], v[36:39]
    v_mfma_f32_16x16x32_bf16 v[72:75], v[212:215], v[180:183], v[72:75]
    v_mfma_f32_16x16x32_bf16 v[108:111], v[216:219], v[180:183], v[108:111]
    v_mfma_f32_16x16x32_bf16 v[144:147], v[220:223], v[180:183], v[144:147]
    ds_read_b64_tr_b16 v[228:229], v5 offset:0
    ds_read_b64_tr_b16 v[230:231], v5 offset:1024
    ds_read_b128 v[180:183], v2 offset:4096
    v_mfma_f32_16x16x32_bf16 v[40:43], v[208:211], v[184:187], v[40:43]
    v_mfma_f32_16x16x32_bf16 v[76:79], v[212:215], v[184:187], v[76:79]
    v_mfma_f32_16x16x32_bf16 v[112:115], v[216:219], v[184:187], v[112:115]
    v_mfma_f32_16x16x32_bf16 v[148:151], v[220:223], v[184:187], v[148:151]
    ds_read_b64_tr_b16 v[232:233], v6 offset:0
    ds_read_b64_tr_b16 v[234:235], v6 offset:1024
    ds_read_b128 v[184:187], v2 offset:6144
    v_mfma_f32_16x16x32_bf16 v[44:47], v[208:211], v[188:191], v[44:47]
    v_mfma_f32_16x16x32_bf16 v[80:83], v[212:215], v[188:191], v[80:83]
    v_mfma_f32_16x16x32_bf16 v[116:119], v[216:219], v[188:191], v[116:119]
    v_mfma_f32_16x16x32_bf16 v[152:155], v[220:223], v[188:191], v[152:155]
    ds_read_b64_tr_b16 v[236:237], v7 offset:0
    ds_read_b64_tr_b16 v[238:239], v7 offset:1024
    ds_read_b128 v[188:191], v2 offset:8192
    v_mfma_f32_16x16x32_bf16 v[48:51], v[208:211], v[192:195], v[48:51]
    v_mfma_f32_16x16x32_bf16 v[84:87], v[212:215], v[192:195], v[84:87]
    v_mfma_f32_16x16x32_bf16 v[120:123], v[216:219], v[192:195], v[120:123]
    v_mfma_f32_16x16x32_bf16 v[156:159], v[220:223], v[192:195], v[156:159]
    ds_read_b128 v[192:195], v2 offset:10240
    v_mfma_f32_16x16x32_bf16 v[52:55], v[208:211], v[196:199], v[52:55]
    v_mfma_f32_16x16x32_bf16 v[88:91], v[212:215], v[196:199], v[88:91]
    v_mfma_f32_16x16x32_bf16 v[124:127], v[216:219], v[196:199], v[124:127]
    v_mfma_f32_16x16x32_bf16 v[160:163], v[220:223], v[196:199], v[160:163]
    ds_read_b128 v[196:199], v2 offset:12288
    v_mfma_f32_16x16x32_bf16 v[56:59], v[208:211], v[200:203], v[56:59]
    v_mfma_f32_16x16x32_bf16 v[92:95], v[212:215], v[200:203], v[92:95]
    v_mfma_f32_16x16x32_bf16 v[128:131], v[216:219], v[200:203], v[128:131]
    v_mfma_f32_16x16x32_bf16 v[164:167], v[220:223], v[200:203], v[164:167]
    ds_read_b128 v[200:203], v2 offset:14336
    v_mfma_f32_16x16x32_bf16 v[60:63], v[208:211], v[204:207], v[60:63]
    v_mfma_f32_16x16x32_bf16 v[96:99], v[212:215], v[204:207], v[96:99]
    v_mfma_f32_16x16x32_bf16 v[132:135], v[216:219], v[204:207], v[132:135]
    v_mfma_f32_16x16x32_bf16 v[168:171], v[220:223], v[204:207], v[168:171]
    ds_read_b128 v[204:207], v2 offset:16384
    s_waitcnt lgkmcnt(5)
    v_mfma_f32_16x16x32_bf16 v[28:31], v[224:227], v[172:175], v[28:31]
    v_mfma_f32_16x16x32_bf16 v[64:67], v[228:231], v[172:175], v[64:67]
    v_mfma_f32_16x16x32_bf16 v[100:103], v[232:235], v[172:175], v[100:103]
    v_mfma_f32_16x16x32_bf16 v[136:139], v[236:239], v[172:175], v[136:139]
    s_waitcnt lgkmcnt(15)
    v_mfma_f32_16x16x32_bf16 v[32:35], v[224:227], v[176:179], v[32:35]
    v_mfma_f32_16x16x32_bf16 v[68:71], v[228:231], v[176:179], v[68:71]
    v_mfma_f32_16x16x32_bf16 v[104:107], v[232:235], v[176:179], v[104:107]
    v_mfma_f32_16x16x32_bf16 v[140:143], v[236:239], v[176:179], v[140:143]
    s_waitcnt lgkmcnt(0)
    s_barrier
    v_add_u32 v2, 0xfffe6800, v2
    v_add_u32 v4, 0xfffe6800, v4
    v_add_u32 v5, 0xfffe6800, v5
    v_add_u32 v6, 0xfffe6800, v6
    v_add_u32 v7, 0xfffe6800, v7
    ds_read_b128 v[172:175], v2 offset:0
    ds_read_b128 v[176:179], v2 offset:2048
    ds_read_b64_tr_b16 v[208:209], v4 offset:0
    ds_read_b64_tr_b16 v[210:211], v4 offset:1024
    v_mfma_f32_16x16x32_bf16 v[36:39], v[224:227], v[180:183], v[36:39]
    v_mfma_f32_16x16x32_bf16 v[72:75], v[228:231], v[180:183], v[72:75]
    v_mfma_f32_16x16x32_bf16 v[108:111], v[232:235], v[180:183], v[108:111]
    v_mfma_f32_16x16x32_bf16 v[144:147], v[236:239], v[180:183], v[144:147]
    ds_read_b64_tr_b16 v[212:213], v5 offset:0
    ds_read_b64_tr_b16 v[214:215], v5 offset:1024
    ds_read_b128 v[180:183], v2 offset:4096
    v_mfma_f32_16x16x32_bf16 v[40:43], v[224:227], v[184:187], v[40:43]
    v_mfma_f32_16x16x32_bf16 v[76:79], v[228:231], v[184:187], v[76:79]
    v_mfma_f32_16x16x32_bf16 v[112:115], v[232:235], v[184:187], v[112:115]
    v_mfma_f32_16x16x32_bf16 v[148:151], v[236:239], v[184:187], v[148:151]
    ds_read_b64_tr_b16 v[216:217], v6 offset:0
    ds_read_b64_tr_b16 v[218:219], v6 offset:1024
    ds_read_b128 v[184:187], v2 offset:6144
    v_mfma_f32_16x16x32_bf16 v[44:47], v[224:227], v[188:191], v[44:47]
    v_mfma_f32_16x16x32_bf16 v[80:83], v[228:231], v[188:191], v[80:83]
    v_mfma_f32_16x16x32_bf16 v[116:119], v[232:235], v[188:191], v[116:119]
    v_mfma_f32_16x16x32_bf16 v[152:155], v[236:239], v[188:191], v[152:155]
    ds_read_b64_tr_b16 v[220:221], v7 offset:0
    ds_read_b64_tr_b16 v[222:223], v7 offset:1024
    ds_read_b128 v[188:191], v2 offset:8192
    v_mfma_f32_16x16x32_bf16 v[48:51], v[224:227], v[192:195], v[48:51]
    v_mfma_f32_16x16x32_bf16 v[84:87], v[228:231], v[192:195], v[84:87]
    v_mfma_f32_16x16x32_bf16 v[120:123], v[232:235], v[192:195], v[120:123]
    v_mfma_f32_16x16x32_bf16 v[156:159], v[236:239], v[192:195], v[156:159]
    ds_read_b128 v[192:195], v2 offset:10240
    v_mfma_f32_16x16x32_bf16 v[52:55], v[224:227], v[196:199], v[52:55]
    v_mfma_f32_16x16x32_bf16 v[88:91], v[228:231], v[196:199], v[88:91]
    v_mfma_f32_16x16x32_bf16 v[124:127], v[232:235], v[196:199], v[124:127]
    v_mfma_f32_16x16x32_bf16 v[160:163], v[236:239], v[196:199], v[160:163]
    ds_read_b128 v[196:199], v2 offset:12288
    v_mfma_f32_16x16x32_bf16 v[56:59], v[224:227], v[200:203], v[56:59]
    v_mfma_f32_16x16x32_bf16 v[92:95], v[228:231], v[200:203], v[92:95]
    v_mfma_f32_16x16x32_bf16 v[128:131], v[232:235], v[200:203], v[128:131]
    v_mfma_f32_16x16x32_bf16 v[164:167], v[236:239], v[200:203], v[164:167]
    ds_read_b128 v[200:203], v2 offset:14336
    v_mfma_f32_16x16x32_bf16 v[60:63], v[224:227], v[204:207], v[60:63]
    v_mfma_f32_16x16x32_bf16 v[96:99], v[228:231], v[204:207], v[96:99]
    v_mfma_f32_16x16x32_bf16 v[132:135], v[232:235], v[204:207], v[132:135]
    v_mfma_f32_16x16x32_bf16 v[168:171], v[236:239], v[204:207], v[168:171]
    ds_read_b128 v[204:207], v2 offset:16384
    s_waitcnt lgkmcnt(5)
    v_mfma_f32_16x16x32_bf16 v[28:31], v[208:211], v[172:175], v[28:31]
    v_mfma_f32_16x16x32_bf16 v[64:67], v[212:215], v[172:175], v[64:67]
    v_mfma_f32_16x16x32_bf16 v[100:103], v[216:219], v[172:175], v[100:103]
    v_mfma_f32_16x16x32_bf16 v[136:139], v[220:223], v[172:175], v[136:139]
    s_waitcnt lgkmcnt(15)
    v_mfma_f32_16x16x32_bf16 v[32:35], v[208:211], v[176:179], v[32:35]
    v_mfma_f32_16x16x32_bf16 v[68:71], v[212:215], v[176:179], v[68:71]
    v_mfma_f32_16x16x32_bf16 v[104:107], v[216:219], v[176:179], v[104:107]
    v_mfma_f32_16x16x32_bf16 v[140:143], v[220:223], v[176:179], v[140:143]
    s_waitcnt lgkmcnt(0)
    s_barrier
    v_add_u32 v2, 0x8800, v2
    v_add_u32 v4, 0x8800, v4
    v_add_u32 v5, 0x8800, v5
    v_add_u32 v6, 0x8800, v6
    v_add_u32 v7, 0x8800, v7
    ds_read_b128 v[172:175], v2 offset:0
    ds_read_b128 v[176:179], v2 offset:2048
    ds_read_b64_tr_b16 v[224:225], v4 offset:0
    ds_read_b64_tr_b16 v[226:227], v4 offset:1024
    v_mfma_f32_16x16x32_bf16 v[36:39], v[208:211], v[180:183], v[36:39]
    v_mfma_f32_16x16x32_bf16 v[72:75], v[212:215], v[180:183], v[72:75]
    v_mfma_f32_16x16x32_bf16 v[108:111], v[216:219], v[180:183], v[108:111]
    v_mfma_f32_16x16x32_bf16 v[144:147], v[220:223], v[180:183], v[144:147]
    ds_read_b64_tr_b16 v[228:229], v5 offset:0
    ds_read_b64_tr_b16 v[230:231], v5 offset:1024
    ds_read_b128 v[180:183], v2 offset:4096
    v_mfma_f32_16x16x32_bf16 v[40:43], v[208:211], v[184:187], v[40:43]
    v_mfma_f32_16x16x32_bf16 v[76:79], v[212:215], v[184:187], v[76:79]
    v_mfma_f32_16x16x32_bf16 v[112:115], v[216:219], v[184:187], v[112:115]
    v_mfma_f32_16x16x32_bf16 v[148:151], v[220:223], v[184:187], v[148:151]
    ds_read_b64_tr_b16 v[232:233], v6 offset:0
    ds_read_b64_tr_b16 v[234:235], v6 offset:1024
    ds_read_b128 v[184:187], v2 offset:6144
    v_mfma_f32_16x16x32_bf16 v[44:47], v[208:211], v[188:191], v[44:47]
    v_mfma_f32_16x16x32_bf16 v[80:83], v[212:215], v[188:191], v[80:83]
    v_mfma_f32_16x16x32_bf16 v[116:119], v[216:219], v[188:191], v[116:119]
    v_mfma_f32_16x16x32_bf16 v[152:155], v[220:223], v[188:191], v[152:155]
    ds_read_b64_tr_b16 v[236:237], v7 offset:0
    ds_read_b64_tr_b16 v[238:239], v7 offset:1024
    ds_read_b128 v[188:191], v2 offset:8192
    v_mfma_f32_16x16x32_bf16 v[48:51], v[208:211], v[192:195], v[48:51]
    v_mfma_f32_16x16x32_bf16 v[84:87], v[212:215], v[192:195], v[84:87]
    v_mfma_f32_16x16x32_bf16 v[120:123], v[216:219], v[192:195], v[120:123]
    v_mfma_f32_16x16x32_bf16 v[156:159], v[220:223], v[192:195], v[156:159]
    ds_read_b128 v[192:195], v2 offset:10240
    v_mfma_f32_16x16x32_bf16 v[52:55], v[208:211], v[196:199], v[52:55]
    v_mfma_f32_16x16x32_bf16 v[88:91], v[212:215], v[196:199], v[88:91]
    v_mfma_f32_16x16x32_bf16 v[124:127], v[216:219], v[196:199], v[124:127]
    v_mfma_f32_16x16x32_bf16 v[160:163], v[220:223], v[196:199], v[160:163]
    ds_read_b128 v[196:199], v2 offset:12288
    v_mfma_f32_16x16x32_bf16 v[56:59], v[208:211], v[200:203], v[56:59]
    v_mfma_f32_16x16x32_bf16 v[92:95], v[212:215], v[200:203], v[92:95]
    v_mfma_f32_16x16x32_bf16 v[128:131], v[216:219], v[200:203], v[128:131]
    v_mfma_f32_16x16x32_bf16 v[164:167], v[220:223], v[200:203], v[164:167]
    ds_read_b128 v[200:203], v2 offset:14336
    v_mfma_f32_16x16x32_bf16 v[60:63], v[208:211], v[204:207], v[60:63]
    v_mfma_f32_16x16x32_bf16 v[96:99], v[212:215], v[204:207], v[96:99]
    v_mfma_f32_16x16x32_bf16 v[132:135], v[216:219], v[204:207], v[132:135]
    v_mfma_f32_16x16x32_bf16 v[168:171], v[220:223], v[204:207], v[168:171]
    ds_read_b128 v[204:207], v2 offset:16384
    s_add_u32 s49, s49, 1
    s_cmp_lt_u32 s49, 7
    s_cbranch_scc1 L_gkloop_22
    s_waitcnt lgkmcnt(5)
    v_mfma_f32_16x16x32_bf16 v[28:31], v[224:227], v[172:175], v[28:31]
    v_mfma_f32_16x16x32_bf16 v[64:67], v[228:231], v[172:175], v[64:67]
    v_mfma_f32_16x16x32_bf16 v[100:103], v[232:235], v[172:175], v[100:103]
    v_mfma_f32_16x16x32_bf16 v[136:139], v[236:239], v[172:175], v[136:139]
    s_waitcnt lgkmcnt(15)
    v_mfma_f32_16x16x32_bf16 v[32:35], v[224:227], v[176:179], v[32:35]
    v_mfma_f32_16x16x32_bf16 v[68:71], v[228:231], v[176:179], v[68:71]
    v_mfma_f32_16x16x32_bf16 v[104:107], v[232:235], v[176:179], v[104:107]
    v_mfma_f32_16x16x32_bf16 v[140:143], v[236:239], v[176:179], v[140:143]
    s_waitcnt lgkmcnt(0)
    s_barrier
    v_add_u32 v2, 0x8800, v2
    v_add_u32 v4, 0x8800, v4
    v_add_u32 v5, 0x8800, v5
    v_add_u32 v6, 0x8800, v6
    v_add_u32 v7, 0x8800, v7
    ds_read_b128 v[172:175], v2 offset:0
    ds_read_b128 v[176:179], v2 offset:2048
    ds_read_b64_tr_b16 v[208:209], v4 offset:0
    ds_read_b64_tr_b16 v[210:211], v4 offset:1024
    v_mfma_f32_16x16x32_bf16 v[36:39], v[224:227], v[180:183], v[36:39]
    v_mfma_f32_16x16x32_bf16 v[72:75], v[228:231], v[180:183], v[72:75]
    v_mfma_f32_16x16x32_bf16 v[108:111], v[232:235], v[180:183], v[108:111]
    v_mfma_f32_16x16x32_bf16 v[144:147], v[236:239], v[180:183], v[144:147]
    ds_read_b64_tr_b16 v[212:213], v5 offset:0
    ds_read_b64_tr_b16 v[214:215], v5 offset:1024
    ds_read_b128 v[180:183], v2 offset:4096
    v_mfma_f32_16x16x32_bf16 v[40:43], v[224:227], v[184:187], v[40:43]
    v_mfma_f32_16x16x32_bf16 v[76:79], v[228:231], v[184:187], v[76:79]
    v_mfma_f32_16x16x32_bf16 v[112:115], v[232:235], v[184:187], v[112:115]
    v_mfma_f32_16x16x32_bf16 v[148:151], v[236:239], v[184:187], v[148:151]
    ds_read_b64_tr_b16 v[216:217], v6 offset:0
    ds_read_b64_tr_b16 v[218:219], v6 offset:1024
    ds_read_b128 v[184:187], v2 offset:6144
    v_mfma_f32_16x16x32_bf16 v[44:47], v[224:227], v[188:191], v[44:47]
    v_mfma_f32_16x16x32_bf16 v[80:83], v[228:231], v[188:191], v[80:83]
    v_mfma_f32_16x16x32_bf16 v[116:119], v[232:235], v[188:191], v[116:119]
    v_mfma_f32_16x16x32_bf16 v[152:155], v[236:239], v[188:191], v[152:155]
    ds_read_b64_tr_b16 v[220:221], v7 offset:0
    ds_read_b64_tr_b16 v[222:223], v7 offset:1024
    ds_read_b128 v[188:191], v2 offset:8192
    v_mfma_f32_16x16x32_bf16 v[48:51], v[224:227], v[192:195], v[48:51]
    v_mfma_f32_16x16x32_bf16 v[84:87], v[228:231], v[192:195], v[84:87]
    v_mfma_f32_16x16x32_bf16 v[120:123], v[232:235], v[192:195], v[120:123]
    v_mfma_f32_16x16x32_bf16 v[156:159], v[236:239], v[192:195], v[156:159]
    ds_read_b128 v[192:195], v2 offset:10240
    v_mfma_f32_16x16x32_bf16 v[52:55], v[224:227], v[196:199], v[52:55]
    v_mfma_f32_16x16x32_bf16 v[88:91], v[228:231], v[196:199], v[88:91]
    v_mfma_f32_16x16x32_bf16 v[124:127], v[232:235], v[196:199], v[124:127]
    v_mfma_f32_16x16x32_bf16 v[160:163], v[236:239], v[196:199], v[160:163]
    ds_read_b128 v[196:199], v2 offset:12288
    v_mfma_f32_16x16x32_bf16 v[56:59], v[224:227], v[200:203], v[56:59]
    v_mfma_f32_16x16x32_bf16 v[92:95], v[228:231], v[200:203], v[92:95]
    v_mfma_f32_16x16x32_bf16 v[128:131], v[232:235], v[200:203], v[128:131]
    v_mfma_f32_16x16x32_bf16 v[164:167], v[236:239], v[200:203], v[164:167]
    ds_read_b128 v[200:203], v2 offset:14336
    v_mfma_f32_16x16x32_bf16 v[60:63], v[224:227], v[204:207], v[60:63]
    v_mfma_f32_16x16x32_bf16 v[96:99], v[228:231], v[204:207], v[96:99]
    v_mfma_f32_16x16x32_bf16 v[132:135], v[232:235], v[204:207], v[132:135]
    v_mfma_f32_16x16x32_bf16 v[168:171], v[236:239], v[204:207], v[168:171]
    ds_read_b128 v[204:207], v2 offset:16384
    s_waitcnt lgkmcnt(5)
    v_mfma_f32_16x16x32_bf16 v[28:31], v[208:211], v[172:175], v[28:31]
    v_mfma_f32_16x16x32_bf16 v[64:67], v[212:215], v[172:175], v[64:67]
    v_mfma_f32_16x16x32_bf16 v[100:103], v[216:219], v[172:175], v[100:103]
    v_mfma_f32_16x16x32_bf16 v[136:139], v[220:223], v[172:175], v[136:139]
    s_waitcnt lgkmcnt(15)
    v_mfma_f32_16x16x32_bf16 v[32:35], v[208:211], v[176:179], v[32:35]
    v_mfma_f32_16x16x32_bf16 v[68:71], v[212:215], v[176:179], v[68:71]
    v_mfma_f32_16x16x32_bf16 v[104:107], v[216:219], v[176:179], v[104:107]
    v_mfma_f32_16x16x32_bf16 v[140:143], v[220:223], v[176:179], v[140:143]
    s_waitcnt lgkmcnt(0)
    s_barrier
    v_add_u32 v2, 0x8800, v2
    v_add_u32 v4, 0x8800, v4
    v_add_u32 v5, 0x8800, v5
    v_add_u32 v6, 0x8800, v6
    v_add_u32 v7, 0x8800, v7
    ds_read_b128 v[172:175], v2 offset:0
    ds_read_b128 v[176:179], v2 offset:2048
    ds_read_b64_tr_b16 v[224:225], v4 offset:0
    ds_read_b64_tr_b16 v[226:227], v4 offset:1024
    v_mfma_f32_16x16x32_bf16 v[36:39], v[208:211], v[180:183], v[36:39]
    v_mfma_f32_16x16x32_bf16 v[72:75], v[212:215], v[180:183], v[72:75]
    v_mfma_f32_16x16x32_bf16 v[108:111], v[216:219], v[180:183], v[108:111]
    v_mfma_f32_16x16x32_bf16 v[144:147], v[220:223], v[180:183], v[144:147]
    ds_read_b64_tr_b16 v[228:229], v5 offset:0
    ds_read_b64_tr_b16 v[230:231], v5 offset:1024
    ds_read_b128 v[180:183], v2 offset:4096
    v_mfma_f32_16x16x32_bf16 v[40:43], v[208:211], v[184:187], v[40:43]
    v_mfma_f32_16x16x32_bf16 v[76:79], v[212:215], v[184:187], v[76:79]
    v_mfma_f32_16x16x32_bf16 v[112:115], v[216:219], v[184:187], v[112:115]
    v_mfma_f32_16x16x32_bf16 v[148:151], v[220:223], v[184:187], v[148:151]
    ds_read_b64_tr_b16 v[232:233], v6 offset:0
    ds_read_b64_tr_b16 v[234:235], v6 offset:1024
    ds_read_b128 v[184:187], v2 offset:6144
    v_mfma_f32_16x16x32_bf16 v[44:47], v[208:211], v[188:191], v[44:47]
    v_mfma_f32_16x16x32_bf16 v[80:83], v[212:215], v[188:191], v[80:83]
    v_mfma_f32_16x16x32_bf16 v[116:119], v[216:219], v[188:191], v[116:119]
    v_mfma_f32_16x16x32_bf16 v[152:155], v[220:223], v[188:191], v[152:155]
    ds_read_b64_tr_b16 v[236:237], v7 offset:0
    ds_read_b64_tr_b16 v[238:239], v7 offset:1024
    ds_read_b128 v[188:191], v2 offset:8192
    v_mfma_f32_16x16x32_bf16 v[48:51], v[208:211], v[192:195], v[48:51]
    v_mfma_f32_16x16x32_bf16 v[84:87], v[212:215], v[192:195], v[84:87]
    v_mfma_f32_16x16x32_bf16 v[120:123], v[216:219], v[192:195], v[120:123]
    v_mfma_f32_16x16x32_bf16 v[156:159], v[220:223], v[192:195], v[156:159]
    ds_read_b128 v[192:195], v2 offset:10240
    v_mfma_f32_16x16x32_bf16 v[52:55], v[208:211], v[196:199], v[52:55]
    v_mfma_f32_16x16x32_bf16 v[88:91], v[212:215], v[196:199], v[88:91]
    v_mfma_f32_16x16x32_bf16 v[124:127], v[216:219], v[196:199], v[124:127]
    v_mfma_f32_16x16x32_bf16 v[160:163], v[220:223], v[196:199], v[160:163]
    ds_read_b128 v[196:199], v2 offset:12288
    v_mfma_f32_16x16x32_bf16 v[56:59], v[208:211], v[200:203], v[56:59]
    v_mfma_f32_16x16x32_bf16 v[92:95], v[212:215], v[200:203], v[92:95]
    v_mfma_f32_16x16x32_bf16 v[128:131], v[216:219], v[200:203], v[128:131]
    v_mfma_f32_16x16x32_bf16 v[164:167], v[220:223], v[200:203], v[164:167]
    ds_read_b128 v[200:203], v2 offset:14336
    v_mfma_f32_16x16x32_bf16 v[60:63], v[208:211], v[204:207], v[60:63]
    v_mfma_f32_16x16x32_bf16 v[96:99], v[212:215], v[204:207], v[96:99]
    v_mfma_f32_16x16x32_bf16 v[132:135], v[216:219], v[204:207], v[132:135]
    v_mfma_f32_16x16x32_bf16 v[168:171], v[220:223], v[204:207], v[168:171]
    ds_read_b128 v[204:207], v2 offset:16384
    s_waitcnt lgkmcnt(5)
    v_mfma_f32_16x16x32_bf16 v[28:31], v[224:227], v[172:175], v[28:31]
    v_mfma_f32_16x16x32_bf16 v[64:67], v[228:231], v[172:175], v[64:67]
    v_mfma_f32_16x16x32_bf16 v[100:103], v[232:235], v[172:175], v[100:103]
    v_mfma_f32_16x16x32_bf16 v[136:139], v[236:239], v[172:175], v[136:139]
    s_waitcnt lgkmcnt(15)
    v_mfma_f32_16x16x32_bf16 v[32:35], v[224:227], v[176:179], v[32:35]
    v_mfma_f32_16x16x32_bf16 v[68:71], v[228:231], v[176:179], v[68:71]
    v_mfma_f32_16x16x32_bf16 v[104:107], v[232:235], v[176:179], v[104:107]
    v_mfma_f32_16x16x32_bf16 v[140:143], v[236:239], v[176:179], v[140:143]
    s_waitcnt lgkmcnt(10)
    v_mfma_f32_16x16x32_bf16 v[36:39], v[224:227], v[180:183], v[36:39]
    v_mfma_f32_16x16x32_bf16 v[72:75], v[228:231], v[180:183], v[72:75]
    v_mfma_f32_16x16x32_bf16 v[108:111], v[232:235], v[180:183], v[108:111]
    v_mfma_f32_16x16x32_bf16 v[144:147], v[236:239], v[180:183], v[144:147]
    s_waitcnt lgkmcnt(7)
    v_mfma_f32_16x16x32_bf16 v[40:43], v[224:227], v[184:187], v[40:43]
    v_mfma_f32_16x16x32_bf16 v[76:79], v[228:231], v[184:187], v[76:79]
    v_mfma_f32_16x16x32_bf16 v[112:115], v[232:235], v[184:187], v[112:115]
    v_mfma_f32_16x16x32_bf16 v[148:151], v[236:239], v[184:187], v[148:151]
    s_waitcnt lgkmcnt(4)
    v_mfma_f32_16x16x32_bf16 v[44:47], v[224:227], v[188:191], v[44:47]
    v_mfma_f32_16x16x32_bf16 v[80:83], v[228:231], v[188:191], v[80:83]
    v_mfma_f32_16x16x32_bf16 v[116:119], v[232:235], v[188:191], v[116:119]
    v_mfma_f32_16x16x32_bf16 v[152:155], v[236:239], v[188:191], v[152:155]
    s_waitcnt lgkmcnt(3)
    v_mfma_f32_16x16x32_bf16 v[48:51], v[224:227], v[192:195], v[48:51]
    v_mfma_f32_16x16x32_bf16 v[84:87], v[228:231], v[192:195], v[84:87]
    v_mfma_f32_16x16x32_bf16 v[120:123], v[232:235], v[192:195], v[120:123]
    v_mfma_f32_16x16x32_bf16 v[156:159], v[236:239], v[192:195], v[156:159]
    s_waitcnt lgkmcnt(2)
    v_mfma_f32_16x16x32_bf16 v[52:55], v[224:227], v[196:199], v[52:55]
    v_mfma_f32_16x16x32_bf16 v[88:91], v[228:231], v[196:199], v[88:91]
    v_mfma_f32_16x16x32_bf16 v[124:127], v[232:235], v[196:199], v[124:127]
    v_mfma_f32_16x16x32_bf16 v[160:163], v[236:239], v[196:199], v[160:163]
    s_waitcnt lgkmcnt(1)
    v_mfma_f32_16x16x32_bf16 v[56:59], v[224:227], v[200:203], v[56:59]
    v_mfma_f32_16x16x32_bf16 v[92:95], v[228:231], v[200:203], v[92:95]
    v_mfma_f32_16x16x32_bf16 v[128:131], v[232:235], v[200:203], v[128:131]
    v_mfma_f32_16x16x32_bf16 v[164:167], v[236:239], v[200:203], v[164:167]
    s_waitcnt lgkmcnt(0)
    v_mfma_f32_16x16x32_bf16 v[60:63], v[224:227], v[204:207], v[60:63]
    v_mfma_f32_16x16x32_bf16 v[96:99], v[228:231], v[204:207], v[96:99]
    v_mfma_f32_16x16x32_bf16 v[132:135], v[232:235], v[204:207], v[132:135]
    v_mfma_f32_16x16x32_bf16 v[168:171], v[236:239], v[204:207], v[168:171]
    v_lshlrev_b32 v10, 4, v1
    s_and_b32 s44, s3, 1
    s_mul_i32 s44, s44, 36864
    s_add_u32 s44, s44, 0
    v_add_u32 v10, s44, v10
    s_bitcmp1_b32 s3, 1
    s_cbranch_scc1 L_rd_23
    s_nop 4
    ds_write_b128 v10, v[48:51] offset:5120
    ds_write_b128 v10, v[52:55] offset:6144
    ds_write_b128 v10, v[56:59] offset:7168
    ds_write_b128 v10, v[60:63] offset:8192
    ds_write_b128 v10, v[84:87] offset:14336
    ds_write_b128 v10, v[88:91] offset:15360
    ds_write_b128 v10, v[92:95] offset:16384
    ds_write_b128 v10, v[96:99] offset:17408
    ds_write_b128 v10, v[120:123] offset:23552
    ds_write_b128 v10, v[124:127] offset:24576
    ds_write_b128 v10, v[128:131] offset:25600
    ds_write_b128 v10, v[132:135] offset:26624
    ds_write_b128 v10, v[156:159] offset:32768
    ds_write_b128 v10, v[160:163] offset:33792
    ds_write_b128 v10, v[164:167] offset:34816
    ds_write_b128 v10, v[168:171] offset:35840
    s_branch L_rd_24
L_rd_23:
    s_nop 4
    ds_write_b128 v10, v[28:31] offset:0
    ds_write_b128 v10, v[32:35] offset:1024
    ds_write_b128 v10, v[36:39] offset:2048
    ds_write_b128 v10, v[40:43] offset:3072
    ds_write_b128 v10, v[44:47] offset:4096
    ds_write_b128 v10, v[64:67] offset:9216
    ds_write_b128 v10, v[68:71] offset:10240
    ds_write_b128 v10, v[72:75] offset:11264
    ds_write_b128 v10, v[76:79] offset:12288
    ds_write_b128 v10, v[80:83] offset:13312
    ds_write_b128 v10, v[100:103] offset:18432
    ds_write_b128 v10, v[104:107] offset:19456
    ds_write_b128 v10, v[108:111] offset:20480
    ds_write_b128 v10, v[112:115] offset:21504
    ds_write_b128 v10, v[116:119] offset:22528
    ds_write_b128 v10, v[136:139] offset:27648
    ds_write_b128 v10, v[140:143] offset:28672
    ds_write_b128 v10, v[144:147] offset:29696
    ds_write_b128 v10, v[148:151] offset:30720
    ds_write_b128 v10, v[152:155] offset:31744
L_rd_24:
    s_waitcnt lgkmcnt(0)
    s_barrier
    v_lshlrev_b32 v14, 4, v1
    v_lshrrev_b32 v17, 4, v1
    v_and_b32 v18, 15, v1
    v_lshlrev_b32 v17, 3, v17
    v_lshl_add_u32 v17, v18, 12, v17
    s_and_b32 s44, s3, 1
    s_lshl_b32 s44, s44, 7
    v_add_u32 v17, s44, v17
    s_lshr_b32 s44, s3, 1
    s_lshl_b32 s44, s44, 1
    s_add_u32 s44, s44, s27
    s_cmp_eq_u32 s44, 1
    s_cbranch_scc1 L_x01_26
    s_cmp_eq_u32 s44, 2
    s_cbranch_scc1 L_x10_27
    s_cmp_eq_u32 s44, 3
    s_cbranch_scc1 L_x11_28
L_x00_25:
    s_mul_i32 s51, s53, 10240
    ds_read_b128 v[172:175], v10 offset:18432
    ds_read_b128 v[176:179], v10 offset:27648
    ds_read_b128 v[180:183], v10 offset:19456
    ds_read_b128 v[184:187], v10 offset:28672
    ds_read_b128 v[188:191], v10 offset:20480
    ds_read_b128 v[192:195], v10 offset:29696
    ds_read_b128 v[196:199], v10 offset:21504
    ds_read_b128 v[200:203], v10 offset:30720
    ds_read_b128 v[204:207], v10 offset:22528
    ds_read_b128 v[208:211], v10 offset:31744
    s_waitcnt lgkmcnt(9)
    v_add_f32 v100, v100, v172
    v_add_f32 v101, v101, v173
    v_add_f32 v102, v102, v174
    v_add_f32 v103, v103, v175
    s_waitcnt lgkmcnt(8)
    v_add_f32 v136, v136, v176
    v_add_f32 v137, v137, v177
    v_add_f32 v138, v138, v178
    v_add_f32 v139, v139, v179
    s_waitcnt lgkmcnt(7)
    v_add_f32 v104, v104, v180
    v_add_f32 v105, v105, v181
    v_add_f32 v106, v106, v182
    v_add_f32 v107, v107, v183
    s_waitcnt lgkmcnt(6)
    v_add_f32 v140, v140, v184
    v_add_f32 v141, v141, v185
    v_add_f32 v142, v142, v186
    v_add_f32 v143, v143, v187
    s_waitcnt lgkmcnt(5)
    v_add_f32 v108, v108, v188
    v_add_f32 v109, v109, v189
    v_add_f32 v110, v110, v190
    v_add_f32 v111, v111, v191
    s_waitcnt lgkmcnt(4)
    v_add_f32 v144, v144, v192
    v_add_f32 v145, v145, v193
    v_add_f32 v146, v146, v194
    v_add_f32 v147, v147, v195
    s_waitcnt lgkmcnt(3)
    v_add_f32 v112, v112, v196
    v_add_f32 v113, v113, v197
    v_add_f32 v114, v114, v198
    v_add_f32 v115, v115, v199
    s_waitcnt lgkmcnt(2)
    v_add_f32 v148, v148, v200
    v_add_f32 v149, v149, v201
    v_add_f32 v150, v150, v202
    v_add_f32 v151, v151, v203
    s_waitcnt lgkmcnt(1)
    v_add_f32 v116, v116, v204
    v_add_f32 v117, v117, v205
    v_add_f32 v118, v118, v206
    v_add_f32 v119, v119, v207
    s_waitcnt lgkmcnt(0)
    v_add_f32 v152, v152, v208
    v_add_f32 v153, v153, v209
    v_add_f32 v154, v154, v210
    v_add_f32 v155, v155, v211
    s_add_u32 s45, s51, 0
    buffer_store_dwordx4 v[100:103], v14, s[68:71], s45 offen sc1
    s_add_u32 s45, s51, 1024
    buffer_store_dwordx4 v[136:139], v14, s[68:71], s45 offen sc1
    s_add_u32 s45, s51, 2048
    buffer_store_dwordx4 v[104:107], v14, s[68:71], s45 offen sc1
    s_add_u32 s45, s51, 3072
    buffer_store_dwordx4 v[140:143], v14, s[68:71], s45 offen sc1
    s_add_u32 s45, s51, 4096
    buffer_store_dwordx4 v[108:111], v14, s[68:71], s45 offen sc1
    s_add_u32 s45, s51, 5120
    buffer_store_dwordx4 v[144:147], v14, s[68:71], s45 offen sc1
    s_add_u32 s45, s51, 6144
    buffer_store_dwordx4 v[112:115], v14, s[68:71], s45 offen sc1
    s_add_u32 s45, s51, 7168
    buffer_store_dwordx4 v[148:151], v14, s[68:71], s45 offen sc1
    s_add_u32 s45, s51, 8192
    buffer_store_dwordx4 v[116:119], v14, s[68:71], s45 offen sc1
    s_add_u32 s45, s51, 9216
    buffer_store_dwordx4 v[152:155], v14, s[68:71], s45 offen sc1
    ds_read_b128 v[172:175], v10 offset:0
    ds_read_b128 v[176:179], v10 offset:9216
    ds_read_b128 v[180:183], v10 offset:1024
    ds_read_b128 v[184:187], v10 offset:10240
    ds_read_b128 v[188:191], v10 offset:2048
    ds_read_b128 v[192:195], v10 offset:11264
    ds_read_b128 v[196:199], v10 offset:3072
    ds_read_b128 v[200:203], v10 offset:12288
    ds_read_b128 v[204:207], v10 offset:4096
    ds_read_b128 v[208:211], v10 offset:13312
    s_waitcnt lgkmcnt(9)
    v_add_f32 v28, v28, v172
    v_add_f32 v29, v29, v173
    v_add_f32 v30, v30, v174
    v_add_f32 v31, v31, v175
    s_waitcnt lgkmcnt(8)
    v_add_f32 v64, v64, v176
    v_add_f32 v65, v65, v177
    v_add_f32 v66, v66, v178
    v_add_f32 v67, v67, v179
    s_waitcnt lgkmcnt(7)
    v_add_f32 v32, v32, v180
    v_add_f32 v33, v33, v181
    v_add_f32 v34, v34, v182
    v_add_f32 v35, v35, v183
    s_waitcnt lgkmcnt(6)
    v_add_f32 v68, v68, v184
    v_add_f32 v69, v69, v185
    v_add_f32 v70, v70, v186
    v_add_f32 v71, v71, v187
    s_waitcnt lgkmcnt(5)
    v_add_f32 v36, v36, v188
    v_add_f32 v37, v37, v189
    v_add_f32 v38, v38, v190
    v_add_f32 v39, v39, v191
    s_waitcnt lgkmcnt(4)
    v_add_f32 v72, v72, v192
    v_add_f32 v73, v73, v193
    v_add_f32 v74, v74, v194
    v_add_f32 v75, v75, v195
    s_waitcnt lgkmcnt(3)
    v_add_f32 v40, v40, v196
    v_add_f32 v41, v41, v197
    v_add_f32 v42, v42, v198
    v_add_f32 v43, v43, v199
    s_waitcnt lgkmcnt(2)
    v_add_f32 v76, v76, v200
    v_add_f32 v77, v77, v201
    v_add_f32 v78, v78, v202
    v_add_f32 v79, v79, v203
    s_waitcnt lgkmcnt(1)
    v_add_f32 v44, v44, v204
    v_add_f32 v45, v45, v205
    v_add_f32 v46, v46, v206
    v_add_f32 v47, v47, v207
    s_waitcnt lgkmcnt(0)
    v_add_f32 v80, v80, v208
    v_add_f32 v81, v81, v209
    v_add_f32 v82, v82, v210
    v_add_f32 v83, v83, v211
    s_lshl_b32 s44, s53, 2
    v_mov_b32 v15, s44
    v_mov_b32 v16, s91
    s_waitcnt vmcnt(0)
    s_mov_b64 exec, 1
    buffer_store_dword v16, v15, s[64:67], 0 offen sc1
    s_mov_b64 exec, -1
    s_lshl_b32 s44, s30, 2
    v_mov_b32 v15, s44
    s_mov_b32 s49, 0
L_poll_30:
    buffer_load_dword v16, v15, s[64:67], 0 offen sc1
    s_waitcnt vmcnt(0)
    v_readfirstlane_b32 s44, v16
    s_add_u32 s49, s49, 1
    s_cmp_eq_u32 s44, s91
    s_cbranch_scc1 L_got_31
    s_cmp_lt_u32 s49, 300000
    s_cbranch_scc1 L_poll_30
L_got_31:
    s_mul_i32 s51, s30, 10240
    s_add_u32 s45, s51, 0
    buffer_load_dwordx4 v[172:175], v14, s[68:71], s45 offen sc1
    s_add_u32 s45, s51, 1024
    buffer_load_dwordx4 v[176:179], v14, s[68:71], s45 offen sc1
    s_add_u32 s45, s51, 2048
    buffer_load_dwordx4 v[180:183], v14, s[68:71], s45 offen sc1
    s_add_u32 s45, s51, 3072
    buffer_load_dwordx4 v[184:187], v14, s[68:71], s45 offen sc1
    s_add_u32 s45, s51, 4096
    buffer_load_dwordx4 v[188:191], v14, s[68:71], s45 offen sc1
    s_add_u32 s45, s51, 5120
    buffer_load_dwordx4 v[192:195], v14, s[68:71], s45 offen sc1
    s_add_u32 s45, s51, 6144
    buffer_load_dwordx4 v[196:199], v14, s[68:71], s45 offen sc1
    s_add_u32 s45, s51, 7168
    buffer_load_dwordx4 v[200:203], v14, s[68:71], s45 offen sc1
    s_add_u32 s45, s51, 8192
    buffer_load_dwordx4 v[204:207], v14, s[68:71], s45 offen sc1
    s_add_u32 s45, s51, 9216
    buffer_load_dwordx4 v[208:211], v14, s[68:71], s45 offen sc1
    s_waitcnt vmcnt(0)
    v_add_f32 v28, v28, v172
    v_add_f32 v29, v29, v173
    v_add_f32 v30, v30, v174
    v_add_f32 v31, v31, v175
    v_cvt_pk_bf16_f32 v28, v28, v29
    v_cvt_pk_bf16_f32 v29, v30, v31
    s_mov_b32 s45, 0
    buffer_store_dwordx2 v[28:29], v17, s[20:23], s45 offen offset:0
    v_add_f32 v64, v64, v176
    v_add_f32 v65, v65, v177
    v_add_f32 v66, v66, v178
    v_add_f32 v67, v67, v179
    v_cvt_pk_bf16_f32 v64, v64, v65
    v_cvt_pk_bf16_f32 v65, v66, v67
    s_mov_b32 s45, 0
    buffer_store_dwordx2 v[64:65], v17, s[20:23], s45 offen offset:32
    v_add_f32 v32, v32, v180
    v_add_f32 v33, v33, v181
    v_add_f32 v34, v34, v182
    v_add_f32 v35, v35, v183
    v_cvt_pk_bf16_f32 v32, v32, v33
    v_cvt_pk_bf16_f32 v33, v34, v35
    s_mov_b32 s45, 65536
    buffer_store_dwordx2 v[32:33], v17, s[20:23], s45 offen offset:0
    v_add_f32 v68, v68, v184
    v_add_f32 v69, v69, v185
    v_add_f32 v70, v70, v186
    v_add_f32 v71, v71, v187
    v_cvt_pk_bf16_f32 v68, v68, v69
    v_cvt_pk_bf16_f32 v69, v70, v71
    s_mov_b32 s45, 65536
    buffer_store_dwordx2 v[68:69], v17, s[20:23], s45 offen offset:32
    v_add_f32 v36, v36, v188
    v_add_f32 v37, v37, v189
    v_add_f32 v38, v38, v190
    v_add_f32 v39, v39, v191
    v_cvt_pk_bf16_f32 v36, v36, v37
    v_cvt_pk_bf16_f32 v37, v38, v39
    s_mov_b32 s45, 131072
    buffer_store_dwordx2 v[36:37], v17, s[20:23], s45 offen offset:0
    v_add_f32 v72, v72, v192
    v_add_f32 v73, v73, v193
    v_add_f32 v74, v74, v194
    v_add_f32 v75, v75, v195
    v_cvt_pk_bf16_f32 v72, v72, v73
    v_cvt_pk_bf16_f32 v73, v74, v75
    s_mov_b32 s45, 131072
    buffer_store_dwordx2 v[72:73], v17, s[20:23], s45 offen offset:32
    v_add_f32 v40, v40, v196
    v_add_f32 v41, v41, v197
    v_add_f32 v42, v42, v198
    v_add_f32 v43, v43, v199
    v_cvt_pk_bf16_f32 v40, v40, v41
    v_cvt_pk_bf16_f32 v41, v42, v43
    s_mov_b32 s45, 196608
    buffer_store_dwordx2 v[40:41], v17, s[20:23], s45 offen offset:0
    v_add_f32 v76, v76, v200
    v_add_f32 v77, v77, v201
    v_add_f32 v78, v78, v202
    v_add_f32 v79, v79, v203
    v_cvt_pk_bf16_f32 v76, v76, v77
    v_cvt_pk_bf16_f32 v77, v78, v79
    s_mov_b32 s45, 196608
    buffer_store_dwordx2 v[76:77], v17, s[20:23], s45 offen offset:32
    v_add_f32 v44, v44, v204
    v_add_f32 v45, v45, v205
    v_add_f32 v46, v46, v206
    v_add_f32 v47, v47, v207
    v_cvt_pk_bf16_f32 v44, v44, v45
    v_cvt_pk_bf16_f32 v45, v46, v47
    s_mov_b32 s45, 262144
    buffer_store_dwordx2 v[44:45], v17, s[20:23], s45 offen offset:0
    v_add_f32 v80, v80, v208
    v_add_f32 v81, v81, v209
    v_add_f32 v82, v82, v210
    v_add_f32 v83, v83, v211
    v_cvt_pk_bf16_f32 v80, v80, v81
    v_cvt_pk_bf16_f32 v81, v82, v83
    s_mov_b32 s45, 262144
    buffer_store_dwordx2 v[80:81], v17, s[20:23], s45 offen offset:32
    s_branch L_k2fin_29
L_x01_26:
    s_mul_i32 s51, s53, 10240
    ds_read_b128 v[172:175], v10 offset:0
    ds_read_b128 v[176:179], v10 offset:9216
    ds_read_b128 v[180:183], v10 offset:1024
    ds_read_b128 v[184:187], v10 offset:10240
    ds_read_b128 v[188:191], v10 offset:2048
    ds_read_b128 v[192:195], v10 offset:11264
    ds_read_b128 v[196:199], v10 offset:3072
    ds_read_b128 v[200:203], v10 offset:12288
    ds_read_b128 v[204:207], v10 offset:4096
    ds_read_b128 v[208:211], v10 offset:13312
    s_waitcnt lgkmcnt(9)
    v_add_f32 v28, v28, v172
    v_add_f32 v29, v29, v173
    v_add_f32 v30, v30, v174
    v_add_f32 v31, v31, v175
    s_waitcnt lgkmcnt(8)
    v_add_f32 v64, v64, v176
    v_add_f32 v65, v65, v177
    v_add_f32 v66, v66, v178
    v_add_f32 v67, v67, v179
    s_waitcnt lgkmcnt(7)
    v_add_f32 v32, v32, v180
    v_add_f32 v33, v33, v181
    v_add_f32 v34, v34, v182
    v_add_f32 v35, v35, v183
    s_waitcnt lgkmcnt(6)
    v_add_f32 v68, v68, v184
    v_add_f32 v69, v69, v185
    v_add_f32 v70, v70, v186
    v_add_f32 v71, v71, v187
    s_waitcnt lgkmcnt(5)
    v_add_f32 v36, v36, v188
    v_add_f32 v37, v37, v189
    v_add_f32 v38, v38, v190
    v_add_f32 v39, v39, v191
    s_waitcnt lgkmcnt(4)
    v_add_f32 v72, v72, v192
    v_add_f32 v73, v73, v193
    v_add_f32 v74, v74, v194
    v_add_f32 v75, v75, v195
    s_waitcnt lgkmcnt(3)
    v_add_f32 v40, v40, v196
    v_add_f32 v41, v41, v197
    v_add_f32 v42, v42, v198
    v_add_f32 v43, v43, v199
    s_waitcnt lgkmcnt(2)
    v_add_f32 v76, v76, v200
    v_add_f32 v77, v77, v201
    v_add_f32 v78, v78, v202
    v_add_f32 v79, v79, v203
    s_waitcnt lgkmcnt(1)
    v_add_f32 v44, v44, v204
    v_add_f32 v45, v45, v205
    v_add_f32 v46, v46, v206
    v_add_f32 v47, v47, v207
    s_waitcnt lgkmcnt(0)
    v_add_f32 v80, v80, v208
    v_add_f32 v81, v81, v209
    v_add_f32 v82, v82, v210
    v_add_f32 v83, v83, v211
    s_add_u32 s45, s51, 0
    buffer_store_dwordx4 v[28:31], v14, s[68:71], s45 offen sc1
    s_add_u32 s45, s51, 1024
    buffer_store_dwordx4 v[64:67], v14, s[68:71], s45 offen sc1
    s_add_u32 s45, s51, 2048
    buffer_store_dwordx4 v[32:35], v14, s[68:71], s45 offen sc1
    s_add_u32 s45, s51, 3072
    buffer_store_dwordx4 v[68:71], v14, s[68:71], s45 offen sc1
    s_add_u32 s45, s51, 4096
    buffer_store_dwordx4 v[36:39], v14, s[68:71], s45 offen sc1
    s_add_u32 s45, s51, 5120
    buffer_store_dwordx4 v[72:75], v14, s[68:71], s45 offen sc1
    s_add_u32 s45, s51, 6144
    buffer_store_dwordx4 v[40:43], v14, s[68:71], s45 offen sc1
    s_add_u32 s45, s51, 7168
    buffer_store_dwordx4 v[76:79], v14, s[68:71], s45 offen sc1
    s_add_u32 s45, s51, 8192
    buffer_store_dwordx4 v[44:47], v14, s[68:71], s45 offen sc1
    s_add_u32 s45, s51, 9216
    buffer_store_dwordx4 v[80:83], v14, s[68:71], s45 offen sc1
    ds_read_b128 v[172:175], v10 offset:18432
    ds_read_b128 v[176:179], v10 offset:27648
    ds_read_b128 v[180:183], v10 offset:19456
    ds_read_b128 v[184:187], v10 offset:28672
    ds_read_b128 v[188:191], v10 offset:20480
    ds_read_b128 v[192:195], v10 offset:29696
    ds_read_b128 v[196:199], v10 offset:21504
    ds_read_b128 v[200:203], v10 offset:30720
    ds_read_b128 v[204:207], v10 offset:22528
    ds_read_b128 v[208:211], v10 offset:31744
    s_waitcnt lgkmcnt(9)
    v_add_f32 v100, v100, v172
    v_add_f32 v101, v101, v173
    v_add_f32 v102, v102, v174
    v_add_f32 v103, v103, v175
    s_waitcnt lgkmcnt(8)
    v_add_f32 v136, v136, v176
    v_add_f32 v137, v137, v177
    v_add_f32 v138, v138, v178
    v_add_f32 v139, v139, v179
    s_waitcnt lgkmcnt(7)
    v_add_f32 v104, v104, v180
    v_add_f32 v105, v105, v181
    v_add_f32 v106, v106, v182
    v_add_f32 v107, v107, v183
    s_waitcnt lgkmcnt(6)
    v_add_f32 v140, v140, v184
    v_add_f32 v141, v141, v185
    v_add_f32 v142, v142, v186
    v_add_f32 v143, v143, v187
    s_waitcnt lgkmcnt(5)
    v_add_f32 v108, v108, v188
    v_add_f32 v109, v109, v189
    v_add_f32 v110, v110, v190
    v_add_f32 v111, v111, v191
    s_waitcnt lgkmcnt(4)
    v_add_f32 v144, v144, v192
    v_add_f32 v145, v145, v193
    v_add_f32 v146, v146, v194
    v_add_f32 v147, v147, v195
    s_waitcnt lgkmcnt(3)
    v_add_f32 v112, v112, v196
    v_add_f32 v113, v113, v197
    v_add_f32 v114, v114, v198
    v_add_f32 v115, v115, v199
    s_waitcnt lgkmcnt(2)
    v_add_f32 v148, v148, v200
    v_add_f32 v149, v149, v201
    v_add_f32 v150, v150, v202
    v_add_f32 v151, v151, v203
    s_waitcnt lgkmcnt(1)
    v_add_f32 v116, v116, v204
    v_add_f32 v117, v117, v205
    v_add_f32 v118, v118, v206
    v_add_f32 v119, v119, v207
    s_waitcnt lgkmcnt(0)
    v_add_f32 v152, v152, v208
    v_add_f32 v153, v153, v209
    v_add_f32 v154, v154, v210
    v_add_f32 v155, v155, v211
    s_lshl_b32 s44, s53, 2
    v_mov_b32 v15, s44
    v_mov_b32 v16, s91
    s_waitcnt vmcnt(0)
    s_mov_b64 exec, 1
    buffer_store_dword v16, v15, s[64:67], 0 offen sc1
    s_mov_b64 exec, -1
    s_lshl_b32 s44, s30, 2
    v_mov_b32 v15, s44
    s_mov_b32 s49, 0
L_poll_32:
    buffer_load_dword v16, v15, s[64:67], 0 offen sc1
    s_waitcnt vmcnt(0)
    v_readfirstlane_b32 s44, v16
    s_add_u32 s49, s49, 1
    s_cmp_eq_u32 s44, s91
    s_cbranch_scc1 L_got_33
    s_cmp_lt_u32 s49, 300000
    s_cbranch_scc1 L_poll_32
L_got_33:
    s_mul_i32 s51, s30, 10240
    s_add_u32 s45, s51, 0
    buffer_load_dwordx4 v[172:175], v14, s[68:71], s45 offen sc1
    s_add_u32 s45, s51, 1024
    buffer_load_dwordx4 v[176:179], v14, s[68:71], s45 offen sc1
    s_add_u32 s45, s51, 2048
    buffer_load_dwordx4 v[180:183], v14, s[68:71], s45 offen sc1
    s_add_u32 s45, s51, 3072
    buffer_load_dwordx4 v[184:187], v14, s[68:71], s45 offen sc1
    s_add_u32 s45, s51, 4096
    buffer_load_dwordx4 v[188:191], v14, s[68:71], s45 offen sc1
    s_add_u32 s45, s51, 5120
    buffer_load_dwordx4 v[192:195], v14, s[68:71], s45 offen sc1
    s_add_u32 s45, s51, 6144
    buffer_load_dwordx4 v[196:199], v14, s[68:71], s45 offen sc1
    s_add_u32 s45, s51, 7168
    buffer_load_dwordx4 v[200:203], v14, s[68:71], s45 offen sc1
    s_add_u32 s45, s51, 8192
    buffer_load_dwordx4 v[204:207], v14, s[68:71], s45 offen sc1
    s_add_u32 s45, s51, 9216
    buffer_load_dwordx4 v[208:211], v14, s[68:71], s45 offen sc1
    s_waitcnt vmcnt(0)
    v_add_f32 v100, v100, v172
    v_add_f32 v101, v101, v173
    v_add_f32 v102, v102, v174
    v_add_f32 v103, v103, v175
    v_cvt_pk_bf16_f32 v100, v100, v101
    v_cvt_pk_bf16_f32 v101, v102, v103
    s_mov_b32 s45, 0
    buffer_store_dwordx2 v[100:101], v17, s[20:23], s45 offen offset:64
    v_add_f32 v136, v136, v176
    v_add_f32 v137, v137, v177
    v_add_f32 v138, v138, v178
    v_add_f32 v139, v139, v179
    v_cvt_pk_bf16_f32 v136, v136, v137
    v_cvt_pk_bf16_f32 v137, v138, v139
    s_mov_b32 s45, 0
    buffer_store_dwordx2 v[136:137], v17, s[20:23], s45 offen offset:96
    v_add_f32 v104, v104, v180
    v_add_f32 v105, v105, v181
    v_add_f32 v106, v106, v182
    v_add_f32 v107, v107, v183
    v_cvt_pk_bf16_f32 v104, v104, v105
    v_cvt_pk_bf16_f32 v105, v106, v107
    s_mov_b32 s45, 65536
    buffer_store_dwordx2 v[104:105], v17, s[20:23], s45 offen offset:64
    v_add_f32 v140, v140, v184
    v_add_f32 v141, v141, v185
    v_add_f32 v142, v142, v186
    v_add_f32 v143, v143, v187
    v_cvt_pk_bf16_f32 v140, v140, v141
    v_cvt_pk_bf16_f32 v141, v142, v143
    s_mov_b32 s45, 65536
    buffer_store_dwordx2 v[140:141], v17, s[20:23], s45 offen offset:96
    v_add_f32 v108, v108, v188
    v_add_f32 v109, v109, v189
    v_add_f32 v110, v110, v190
    v_add_f32 v111, v111, v191
    v_cvt_pk_bf16_f32 v108, v108, v109
    v_cvt_pk_bf16_f32 v109, v110, v111
    s_mov_b32 s45, 131072
    buffer_store_dwordx2 v[108:109], v17, s[20:23], s45 offen offset:64
    v_add_f32 v144, v144, v192
    v_add_f32 v145, v145, v193
    v_add_f32 v146, v146, v194
    v_add_f32 v147, v147, v195
    v_cvt_pk_bf16_f32 v144, v144, v145
    v_cvt_pk_bf16_f32 v145, v146, v147
    s_mov_b32 s45, 131072
    buffer_store_dwordx2 v[144:145], v17, s[20:23], s45 offen offset:96
    v_add_f32 v112, v112, v196
    v_add_f32 v113, v113, v197
    v_add_f32 v114, v114, v198
    v_add_f32 v115, v115, v199
    v_cvt_pk_bf16_f32 v112, v112, v113
    v_cvt_pk_bf16_f32 v113, v114, v115
    s_mov_b32 s45, 196608
    buffer_store_dwordx2 v[112:113], v17, s[20:23], s45 offen offset:64
    v_add_f32 v148, v148, v200
    v_add_f32 v149, v149, v201
    v_add_f32 v150, v150, v202
    v_add_f32 v151, v151, v203
    v_cvt_pk_bf16_f32 v148, v148, v149
    v_cvt_pk_bf16_f32 v149, v150, v151
    s_mov_b32 s45, 196608
    buffer_store_dwordx2 v[148:149], v17, s[20:23], s45 offen offset:96
    v_add_f32 v116, v116, v204
    v_add_f32 v117, v117, v205
    v_add_f32 v118, v118, v206
    v_add_f32 v119, v119, v207
    v_cvt_pk_bf16_f32 v116, v116, v117
    v_cvt_pk_bf16_f32 v117, v118, v119
    s_mov_b32 s45, 262144
    buffer_store_dwordx2 v[116:117], v17, s[20:23], s45 offen offset:64
    v_add_f32 v152, v152, v208
    v_add_f32 v153, v153, v209
    v_add_f32 v154, v154, v210
    v_add_f32 v155, v155, v211
    v_cvt_pk_bf16_f32 v152, v152, v153
    v_cvt_pk_bf16_f32 v153, v154, v155
    s_mov_b32 s45, 262144
    buffer_store_dwordx2 v[152:153], v17, s[20:23], s45 offen offset:96
    s_branch L_k2fin_29
L_x10_27:
    s_mul_i32 s51, s53, 10240
    ds_read_b128 v[172:175], v10 offset:23552
    ds_read_b128 v[176:179], v10 offset:32768
    ds_read_b128 v[180:183], v10 offset:24576
    ds_read_b128 v[184:187], v10 offset:33792
    ds_read_b128 v[188:191], v10 offset:25600
    ds_read_b128 v[192:195], v10 offset:34816
    ds_read_b128 v[196:199], v10 offset:26624
    ds_read_b128 v[200:203], v10 offset:35840
    s_waitcnt lgkmcnt(7)
    v_add_f32 v120, v120, v172
    v_add_f32 v121, v121, v173
    v_add_f32 v122, v122, v174
    v_add_f32 v123, v123, v175
    s_waitcnt lgkmcnt(6)
    v_add_f32 v156, v156, v176
    v_add_f32 v157, v157, v177
    v_add_f32 v158, v158, v178
    v_add_f32 v159, v159, v179
    s_waitcnt lgkmcnt(5)
    v_add_f32 v124, v124, v180
    v_add_f32 v125, v125, v181
    v_add_f32 v126, v126, v182
    v_add_f32 v127, v127, v183
    s_waitcnt lgkmcnt(4)
    v_add_f32 v160, v160, v184
    v_add_f32 v161, v161, v185
    v_add_f32 v162, v162, v186
    v_add_f32 v163, v163, v187
    s_waitcnt lgkmcnt(3)
    v_add_f32 v128, v128, v188
    v_add_f32 v129, v129, v189
    v_add_f32 v130, v130, v190
    v_add_f32 v131, v131, v191
    s_waitcnt lgkmcnt(2)
    v_add_f32 v164, v164, v192
    v_add_f32 v165, v165, v193
    v_add_f32 v166, v166, v194
    v_add_f32 v167, v167, v195
    s_waitcnt lgkmcnt(1)
    v_add_f32 v132, v132, v196
    v_add_f32 v133, v133, v197
    v_add_f32 v134, v134, v198
    v_add_f32 v135, v135, v199
    s_waitcnt lgkmcnt(0)
    v_add_f32 v168, v168, v200
    v_add_f32 v169, v169, v201
    v_add_f32 v170, v170, v202
    v_add_f32 v171, v171, v203
    s_add_u32 s45, s51, 0
    buffer_store_dwordx4 v[120:123], v14, s[68:71], s45 offen sc1
    s_add_u32 s45, s51, 1024
    buffer_store_dwordx4 v[156:159], v14, s[68:71], s45 offen sc1
    s_add_u32 s45, s51, 2048
    buffer_store_dwordx4 v[124:127], v14, s[68:71], s45 offen sc1
    s_add_u32 s45, s51, 3072
    buffer_store_dwordx4 v[160:163], v14, s[68:71], s45 offen sc1
    s_add_u32 s45, s51, 4096
    buffer_store_dwordx4 v[128:131], v14, s[68:71], s45 offen sc1
    s_add_u32 s45, s51, 5120
    buffer_store_dwordx4 v[164:167], v14, s[68:71], s45 offen sc1
    s_add_u32 s45, s51, 6144
    buffer_store_dwordx4 v[132:135], v14, s[68:71], s45 offen sc1
    s_add_u32 s45, s51, 7168
    buffer_store_dwordx4 v[168:171], v14, s[68:71], s45 offen sc1
    ds_read_b128 v[172:175], v10 offset:5120
    ds_read_b128 v[176:179], v10 offset:14336
    ds_read_b128 v[180:183], v10 offset:6144
    ds_read_b128 v[184:187], v10 offset:15360
    ds_read_b128 v[188:191], v10 offset:7168
    ds_read_b128 v[192:195], v10 offset:16384
    ds_read_b128 v[196:199], v10 offset:8192
    ds_read_b128 v[200:203], v10 offset:17408
    s_waitcnt lgkmcnt(7)
    v_add_f32 v48, v48, v172
    v_add_f32 v49, v49, v173
    v_add_f32 v50, v50, v174
    v_add_f32 v51, v51, v175
    s_waitcnt lgkmcnt(6)
    v_add_f32 v84, v84, v176
    v_add_f32 v85, v85, v177
    v_add_f32 v86, v86, v178
    v_add_f32 v87, v87, v179
    s_waitcnt lgkmcnt(5)
    v_add_f32 v52, v52, v180
    v_add_f32 v53, v53, v181
    v_add_f32 v54, v54, v182
    v_add_f32 v55, v55, v183
    s_waitcnt lgkmcnt(4)
    v_add_f32 v88, v88, v184
    v_add_f32 v89, v89, v185
    v_add_f32 v90, v90, v186
    v_add_f32 v91, v91, v187
    s_waitcnt lgkmcnt(3)
    v_add_f32 v56, v56, v188
    v_add_f32 v57, v57, v189
    v_add_f32 v58, v58, v190
    v_add_f32 v59, v59, v191
    s_waitcnt lgkmcnt(2)
    v_add_f32 v92, v92, v192
    v_add_f32 v93, v93, v193
    v_add_f32 v94, v94, v194
    v_add_f32 v95, v95, v195
    s_waitcnt lgkmcnt(1)
    v_add_f32 v60, v60, v196
    v_add_f32 v61, v61, v197
    v_add_f32 v62, v62, v198
    v_add_f32 v63, v63, v199
    s_waitcnt lgkmcnt(0)
    v_add_f32 v96, v96, v200
    v_add_f32 v97, v97, v201
    v_add_f32 v98, v98, v202
    v_add_f32 v99, v99, v203
    s_lshl_b32 s44, s53, 2
    v_mov_b32 v15, s44
    v_mov_b32 v16, s91
    s_waitcnt vmcnt(0)
    s_mov_b64 exec, 1
    buffer_store_dword v16, v15, s[64:67], 0 offen sc1
    s_mov_b64 exec, -1
    s_lshl_b32 s44, s30, 2
    v_mov_b32 v15, s44
    s_mov_b32 s49, 0
L_poll_34:
    buffer_load_dword v16, v15, s[64:67], 0 offen sc1
    s_waitcnt vmcnt(0)
    v_readfirstlane_b32 s44, v16
    s_add_u32 s49, s49, 1
    s_cmp_eq_u32 s44, s91
    s_cbranch_scc1 L_got_35
    s_cmp_lt_u32 s49, 300000
    s_cbranch_scc1 L_poll_34
L_got_35:
    s_mul_i32 s51, s30, 10240
    s_add_u32 s45, s51, 0
    buffer_load_dwordx4 v[172:175], v14, s[68:71], s45 offen sc1
    s_add_u32 s45, s51, 1024
    buffer_load_dwordx4 v[176:179], v14, s[68:71], s45 offen sc1
    s_add_u32 s45, s51, 2048
    buffer_load_dwordx4 v[180:183], v14, s[68:71], s45 offen sc1
    s_add_u32 s45, s51, 3072
    buffer_load_dwordx4 v[184:187], v14, s[68:71], s45 offen sc1
    s_add_u32 s45, s51, 4096
    buffer_load_dwordx4 v[188:191], v14, s[68:71], s45 offen sc1
    s_add_u32 s45, s51, 5120
    buffer_load_dwordx4 v[192:195], v14, s[68:71], s45 offen sc1
    s_add_u32 s45, s51, 6144
    buffer_load_dwordx4 v[196:199], v14, s[68:71], s45 offen sc1
    s_add_u32 s45, s51, 7168
    buffer_load_dwordx4 v[200:203], v14, s[68:71], s45 offen sc1
    s_waitcnt vmcnt(0)
    v_add_f32 v48, v48, v172
    v_add_f32 v49, v49, v173
    v_add_f32 v50, v50, v174
    v_add_f32 v51, v51, v175
    v_cvt_pk_bf16_f32 v48, v48, v49
    v_cvt_pk_bf16_f32 v49, v50, v51
    s_mov_b32 s45, 327680
    buffer_store_dwordx2 v[48:49], v17, s[20:23], s45 offen offset:0
    v_add_f32 v84, v84, v176
    v_add_f32 v85, v85, v177
    v_add_f32 v86, v86, v178
    v_add_f32 v87, v87, v179
    v_cvt_pk_bf16_f32 v84, v84, v85
    v_cvt_pk_bf16_f32 v85, v86, v87
    s_mov_b32 s45, 327680
    buffer_store_dwordx2 v[84:85], v17, s[20:23], s45 offen offset:32
    v_add_f32 v52, v52, v180
    v_add_f32 v53, v53, v181
    v_add_f32 v54, v54, v182
    v_add_f32 v55, v55, v183
    v_cvt_pk_bf16_f32 v52, v52, v53
    v_cvt_pk_bf16_f32 v53, v54, v55
    s_mov_b32 s45, 393216
    buffer_store_dwordx2 v[52:53], v17, s[20:23], s45 offen offset:0
    v_add_f32 v88, v88, v184
    v_add_f32 v89, v89, v185
    v_add_f32 v90, v90, v186
    v_add_f32 v91, v91, v187
    v_cvt_pk_bf16_f32 v88, v88, v89
    v_cvt_pk_bf16_f32 v89, v90, v91
    s_mov_b32 s45, 393216
    buffer_store_dwordx2 v[88:89], v17, s[20:23], s45 offen offset:32
    v_add_f32 v56, v56, v188
    v_add_f32 v57, v57, v189
    v_add_f32 v58, v58, v190
    v_add_f32 v59, v59, v191
    v_cvt_pk_bf16_f32 v56, v56, v57
    v_cvt_pk_bf16_f32 v57, v58, v59
    s_mov_b32 s45, 458752
    buffer_store_dwordx2 v[56:57], v17, s[20:23], s45 offen offset:0
    v_add_f32 v92, v92, v192
    v_add_f32 v93, v93, v193
    v_add_f32 v94, v94, v194
    v_add_f32 v95, v95, v195
    v_cvt_pk_bf16_f32 v92, v92, v93
    v_cvt_pk_bf16_f32 v93, v94, v95
    s_mov_b32 s45, 458752
    buffer_store_dwordx2 v[92:93], v17, s[20:23], s45 offen offset:32
    v_add_f32 v60, v60, v196
    v_add_f32 v61, v61, v197
    v_add_f32 v62, v62, v198
    v_add_f32 v63, v63, v199
    v_cvt_pk_bf16_f32 v60, v60, v61
    v_cvt_pk_bf16_f32 v61, v62, v63
    s_mov_b32 s45, 524288
    buffer_store_dwordx2 v[60:61], v17, s[20:23], s45 offen offset:0
    v_add_f32 v96, v96, v200
    v_add_f32 v97, v97, v201
    v_add_f32 v98, v98, v202
    v_add_f32 v99, v99, v203
    v_cvt_pk_bf16_f32 v96, v96, v97
    v_cvt_pk_bf16_f32 v97, v98, v99
    s_mov_b32 s45, 524288
    buffer_store_dwordx2 v[96:97], v17, s[20:23], s45 offen offset:32
    s_branch L_k2fin_29
L_x11_28:
    s_mul_i32 s51, s53, 10240
    ds_read_b128 v[172:175], v10 offset:5120
    ds_read_b128 v[176:179], v10 offset:14336
    ds_read_b128 v[180:183], v10 offset:6144
    ds_read_b128 v[184:187], v10 offset:15360
    ds_read_b128 v[188:191], v10 offset:7168
    ds_read_b128 v[192:195], v10 offset:16384
    ds_read_b128 v[196:199], v10 offset:8192
    ds_read_b128 v[200:203], v10 offset:17408
    s_waitcnt lgkmcnt(7)
    v_add_f32 v48, v48, v172
    v_add_f32 v49, v49, v173
    v_add_f32 v50, v50, v174
    v_add_f32 v51, v51, v175
    s_waitcnt lgkmcnt(6)
    v_add_f32 v84, v84, v176
    v_add_f32 v85, v85, v177
    v_add_f32 v86, v86, v178
    v_add_f32 v87, v87, v179
    s_waitcnt lgkmcnt(5)
    v_add_f32 v52, v52, v180
    v_add_f32 v53, v53, v181
    v_add_f32 v54, v54, v182
    v_add_f32 v55, v55, v183
    s_waitcnt lgkmcnt(4)
    v_add_f32 v88, v88, v184
    v_add_f32 v89, v89, v185
    v_add_f32 v90, v90, v186
    v_add_f32 v91, v91, v187
    s_waitcnt lgkmcnt(3)
    v_add_f32 v56, v56, v188
    v_add_f32 v57, v57, v189
    v_add_f32 v58, v58, v190
    v_add_f32 v59, v59, v191
    s_waitcnt lgkmcnt(2)
    v_add_f32 v92, v92, v192
    v_add_f32 v93, v93, v193
    v_add_f32 v94, v94, v194
    v_add_f32 v95, v95, v195
    s_waitcnt lgkmcnt(1)
    v_add_f32 v60, v60, v196
    v_add_f32 v61, v61, v197
    v_add_f32 v62, v62, v198
    v_add_f32 v63, v63, v199
    s_waitcnt lgkmcnt(0)
    v_add_f32 v96, v96, v200
    v_add_f32 v97, v97, v201
    v_add_f32 v98, v98, v202
    v_add_f32 v99, v99, v203
    s_add_u32 s45, s51, 0
    buffer_store_dwordx4 v[48:51], v14, s[68:71], s45 offen sc1
    s_add_u32 s45, s51, 1024
    buffer_store_dwordx4 v[84:87], v14, s[68:71], s45 offen sc1
    s_add_u32 s45, s51, 2048
    buffer_store_dwordx4 v[52:55], v14, s[68:71], s45 offen sc1
    s_add_u32 s45, s51, 3072
    buffer_store_dwordx4 v[88:91], v14, s[68:71], s45 offen sc1
    s_add_u32 s45, s51, 4096
    buffer_store_dwordx4 v[56:59], v14, s[68:71], s45 offen sc1
    s_add_u32 s45, s51, 5120
    buffer_store_dwordx4 v[92:95], v14, s[68:71], s45 offen sc1
    s_add_u32 s45, s51, 6144
    buffer_store_dwordx4 v[60:63], v14, s[68:71], s45 offen sc1
    s_add_u32 s45, s51, 7168
    buffer_store_dwordx4 v[96:99], v14, s[68:71], s45 offen sc1
    ds_read_b128 v[172:175], v10 offset:23552
    ds_read_b128 v[176:179], v10 offset:32768
    ds_read_b128 v[180:183], v10 offset:24576
    ds_read_b128 v[184:187], v10 offset:33792
    ds_read_b128 v[188:191], v10 offset:25600
    ds_read_b128 v[192:195], v10 offset:34816
    ds_read_b128 v[196:199], v10 offset:26624
    ds_read_b128 v[200:203], v10 offset:35840
    s_waitcnt lgkmcnt(7)
    v_add_f32 v120, v120, v172
    v_add_f32 v121, v121, v173
    v_add_f32 v122, v122, v174
    v_add_f32 v123, v123, v175
    s_waitcnt lgkmcnt(6)
    v_add_f32 v156, v156, v176
    v_add_f32 v157, v157, v177
    v_add_f32 v158, v158, v178
    v_add_f32 v159, v159, v179
    s_waitcnt lgkmcnt(5)
    v_add_f32 v124, v124, v180
    v_add_f32 v125, v125, v181
    v_add_f32 v126, v126, v182
    v_add_f32 v127, v127, v183
    s_waitcnt lgkmcnt(4)
    v_add_f32 v160, v160, v184
    v_add_f32 v161, v161, v185
    v_add_f32 v162, v162, v186
    v_add_f32 v163, v163, v187
    s_waitcnt lgkmcnt(3)
    v_add_f32 v128, v128, v188
    v_add_f32 v129, v129, v189
    v_add_f32 v130, v130, v190
    v_add_f32 v131, v131, v191
    s_waitcnt lgkmcnt(2)
    v_add_f32 v164, v164, v192
    v_add_f32 v165, v165, v193
    v_add_f32 v166, v166, v194
    v_add_f32 v167, v167, v195
    s_waitcnt lgkmcnt(1)
    v_add_f32 v132, v132, v196
    v_add_f32 v133, v133, v197
    v_add_f32 v134, v134, v198
    v_add_f32 v135, v135, v199
    s_waitcnt lgkmcnt(0)
    v_add_f32 v168, v168, v200
    v_add_f32 v169, v169, v201
    v_add_f32 v170, v170, v202
    v_add_f32 v171, v171, v203
    s_lshl_b32 s44, s53, 2
    v_mov_b32 v15, s44
    v_mov_b32 v16, s91
    s_waitcnt vmcnt(0)
    s_mov_b64 exec, 1
    buffer_store_dword v16, v15, s[64:67], 0 offen sc1
    s_mov_b64 exec, -1
    s_lshl_b32 s44, s30, 2
    v_mov_b32 v15, s44
    s_mov_b32 s49, 0
L_poll_36:
    buffer_load_dword v16, v15, s[64:67], 0 offen sc1
    s_waitcnt vmcnt(0)
    v_readfirstlane_b32 s44, v16
    s_add_u32 s49, s49, 1
    s_cmp_eq_u32 s44, s91
    s_cbranch_scc1 L_got_37
    s_cmp_lt_u32 s49, 300000
    s_cbranch_scc1 L_poll_36
L_got_37:
    s_mul_i32 s51, s30, 10240
    s_add_u32 s45, s51, 0
    buffer_load_dwordx4 v[172:175], v14, s[68:71], s45 offen sc1
    s_add_u32 s45, s51, 1024
    buffer_load_dwordx4 v[176:179], v14, s[68:71], s45 offen sc1
    s_add_u32 s45, s51, 2048
    buffer_load_dwordx4 v[180:183], v14, s[68:71], s45 offen sc1
    s_add_u32 s45, s51, 3072
    buffer_load_dwordx4 v[184:187], v14, s[68:71], s45 offen sc1
    s_add_u32 s45, s51, 4096
    buffer_load_dwordx4 v[188:191], v14, s[68:71], s45 offen sc1
    s_add_u32 s45, s51, 5120
    buffer_load_dwordx4 v[192:195], v14, s[68:71], s45 offen sc1
    s_add_u32 s45, s51, 6144
    buffer_load_dwordx4 v[196:199], v14, s[68:71], s45 offen sc1
    s_add_u32 s45, s51, 7168
    buffer_load_dwordx4 v[200:203], v14, s[68:71], s45 offen sc1
    s_waitcnt vmcnt(0)
    v_add_f32 v120, v120, v172
    v_add_f32 v121, v121, v173
    v_add_f32 v122, v122, v174
    v_add_f32 v123, v123, v175
    v_cvt_pk_bf16_f32 v120, v120, v121
    v_cvt_pk_bf16_f32 v121, v122, v123
    s_mov_b32 s45, 327680
    buffer_store_dwordx2 v[120:121], v17, s[20:23], s45 offen offset:64
    v_add_f32 v156, v156, v176
    v_add_f32 v157, v157, v177
    v_add_f32 v158, v158, v178
    v_add_f32 v159, v159, v179
    v_cvt_pk_bf16_f32 v156, v156, v157
    v_cvt_pk_bf16_f32 v157, v158, v159
    s_mov_b32 s45, 327680
    buffer_store_dwordx2 v[156:157], v17, s[20:23], s45 offen offset:96
    v_add_f32 v124, v124, v180
    v_add_f32 v125, v125, v181
    v_add_f32 v126, v126, v182
    v_add_f32 v127, v127, v183
    v_cvt_pk_bf16_f32 v124, v124, v125
    v_cvt_pk_bf16_f32 v125, v126, v127
    s_mov_b32 s45, 393216
    buffer_store_dwordx2 v[124:125], v17, s[20:23], s45 offen offset:64
    v_add_f32 v160, v160, v184
    v_add_f32 v161, v161, v185
    v_add_f32 v162, v162, v186
    v_add_f32 v163, v163, v187
    v_cvt_pk_bf16_f32 v160, v160, v161
    v_cvt_pk_bf16_f32 v161, v162, v163
    s_mov_b32 s45, 393216
    buffer_store_dwordx2 v[160:161], v17, s[20:23], s45 offen offset:96
    v_add_f32 v128, v128, v188
    v_add_f32 v129, v129, v189
    v_add_f32 v130, v130, v190
    v_add_f32 v131, v131, v191
    v_cvt_pk_bf16_f32 v128, v128, v129
    v_cvt_pk_bf16_f32 v129, v130, v131
    s_mov_b32 s45, 458752
    buffer_store_dwordx2 v[128:129], v17, s[20:23], s45 offen offset:64
    v_add_f32 v164, v164, v192
    v_add_f32 v165, v165, v193
    v_add_f32 v166, v166, v194
    v_add_f32 v167, v167, v195
    v_cvt_pk_bf16_f32 v164, v164, v165
    v_cvt_pk_bf16_f32 v165, v166, v167
    s_mov_b32 s45, 458752
    buffer_store_dwordx2 v[164:165], v17, s[20:23], s45 offen offset:96
    v_add_f32 v132, v132, v196
    v_add_f32 v133, v133, v197
    v_add_f32 v134, v134, v198
    v_add_f32 v135, v135, v199
    v_cvt_pk_bf16_f32 v132, v132, v133
    v_cvt_pk_bf16_f32 v133, v134, v135
    s_mov_b32 s45, 524288
    buffer_store_dwordx2 v[132:133], v17, s[20:23], s45 offen offset:64
    v_add_f32 v168, v168, v200
    v_add_f32 v169, v169, v201
    v_add_f32 v170, v170, v202
    v_add_f32 v171, v171, v203
    v_cvt_pk_bf16_f32 v168, v168, v169
    v_cvt_pk_bf16_f32 v169, v170, v171
    s_mov_b32 s45, 524288
    buffer_store_dwordx2 v[168:169], v17, s[20:23], s45 offen offset:96
    s_branch L_k2fin_29
L_k2fin_29:
    s_endpgm
L_rare_13:
    s_call_b64 s[72:73], L_k1_rsubB_1
    s_branch L_back_14
L_rare_15:
    s_call_b64 s[72:73], L_k1_rsubB_0
    s_branch L_back_16
L_rare_18:
    s_call_b64 s[72:73], L_k1_rsubB_1
    s_branch L_back_19
L_rare_20:
    s_call_b64 s[72:73], L_k1_rsubB_0
    s_branch L_back_21
L_k1_rsubB_0:
    s_nop 7
    v_mov_b32 v14, v22
    v_mov_b32 v15, v23
    s_nop 1
    v_permlane16_swap_b32 v22, v14
    v_permlane16_swap_b32 v23, v15
    s_nop 1
    v_max_f32 v22, v22, v14
    v_max_f32 v23, v23, v15
    v_mov_b32 v14, v22
    v_mov_b32 v15, v23
    s_nop 1
    v_permlane32_swap_b32 v22, v14
    v_permlane32_swap_b32 v23, v15
    s_nop 1
    v_max_f32 v22, v22, v14
    v_max_f32 v23, v23, v15
    v_cmp_lt_f32 vcc, s30, v22
    s_nop 1
    v_cndmask_b32 v22, 0, v22, vcc
    v_sub_f32 v204, v204, v22
    v_sub_f32 v205, v205, v22
    v_sub_f32 v206, v206, v22
    v_sub_f32 v207, v207, v22
    v_sub_f32 v208, v208, v22
    v_sub_f32 v209, v209, v22
    v_sub_f32 v210, v210, v22
    v_sub_f32 v211, v211, v22
    v_sub_f32 v100, v100, v22
    v_sub_f32 v101, v101, v22
    v_sub_f32 v102, v102, v22
    v_sub_f32 v103, v103, v22
    v_sub_f32 v14, 0, v22
    v_exp_f32 v14, v14
    s_nop 0
    v_mul_f32 v92, v92, v14
    v_mul_f32 v93, v93, v14
    v_mul_f32 v94, v94, v14
    v_mul_f32 v95, v95, v14
    v_mul_f32 v28, v28, v14
    v_mul_f32 v29, v29, v14
    v_mul_f32 v30, v30, v14
    v_mul_f32 v31, v31, v14
    v_mul_f32 v32, v32, v14
    v_mul_f32 v33, v33, v14
    v_mul_f32 v34, v34, v14
    v_mul_f32 v35, v35, v14
    v_mul_f32 v36, v36, v14
    v_mul_f32 v37, v37, v14
    v_mul_f32 v38, v38, v14
    v_mul_f32 v39, v39, v14
    v_mul_f32 v40, v40, v14
    v_mul_f32 v41, v41, v14
    v_mul_f32 v42, v42, v14
    v_mul_f32 v43, v43, v14
    v_mul_f32 v44, v44, v14
    v_mul_f32 v45, v45, v14
    v_mul_f32 v46, v46, v14
    v_mul_f32 v47, v47, v14
    v_mul_f32 v48, v48, v14
    v_mul_f32 v49, v49, v14
    v_mul_f32 v50, v50, v14
    v_mul_f32 v51, v51, v14
    v_mul_f32 v52, v52, v14
    v_mul_f32 v53, v53, v14
    v_mul_f32 v54, v54, v14
    v_mul_f32 v55, v55, v14
    v_mul_f32 v56, v56, v14
    v_mul_f32 v57, v57, v14
    v_mul_f32 v58, v58, v14
    v_mul_f32 v59, v59, v14
    v_cmp_lt_f32 vcc, s30, v23
    s_nop 1
    v_cndmask_b32 v23, 0, v23, vcc
    v_sub_f32 v212, v212, v23
    v_sub_f32 v213, v213, v23
    v_sub_f32 v214, v214, v23
    v_sub_f32 v215, v215, v23
    v_sub_f32 v216, v216, v23
    v_sub_f32 v217, v217, v23
    v_sub_f32 v218, v218, v23
    v_sub_f32 v219, v219, v23
    v_sub_f32 v104, v104, v23
    v_sub_f32 v105, v105, v23
    v_sub_f32 v106, v106, v23
    v_sub_f32 v107, v107, v23
    v_sub_f32 v14, 0, v23
    v_exp_f32 v14, v14
    s_nop 0
    v_mul_f32 v96, v96, v14
    v_mul_f32 v97, v97, v14
    v_mul_f32 v98, v98, v14
    v_mul_f32 v99, v99, v14
    v_mul_f32 v60, v60, v14
    v_mul_f32 v61, v61, v14
    v_mul_f32 v62, v62, v14
    v_mul_f32 v63, v63, v14
    v_mul_f32 v64, v64, v14
    v_mul_f32 v65, v65, v14
    v_mul_f32 v66, v66, v14
    v_mul_f32 v67, v67, v14
    v_mul_f32 v68, v68, v14
    v_mul_f32 v69, v69, v14
    v_mul_f32 v70, v70, v14
    v_mul_f32 v71, v71, v14
    v_mul_f32 v72, v72, v14
    v_mul_f32 v73, v73, v14
    v_mul_f32 v74, v74, v14
    v_mul_f32 v75, v75, v14
    v_mul_f32 v76, v76, v14
    v_mul_f32 v77, v77, v14
    v_mul_f32 v78, v78, v14
    v_mul_f32 v79, v79, v14
    v_mul_f32 v80, v80, v14
    v_mul_f32 v81, v81, v14
    v_mul_f32 v82, v82, v14
    v_mul_f32 v83, v83, v14
    v_mul_f32 v84, v84, v14
    v_mul_f32 v85, v85, v14
    v_mul_f32 v86, v86, v14
    v_mul_f32 v87, v87, v14
    v_mul_f32 v88, v88, v14
    v_mul_f32 v89, v89, v14
    v_mul_f32 v90, v90, v14
    v_mul_f32 v91, v91, v14
    s_mov_b32 s29, 0x41000000
    s_mov_b32 s30, s29
    s_nop 1
    s_setpc_b64 s[72:73]
L_k1_rsubB_1:
    s_nop 7
    v_mov_b32 v14, v22
    v_mov_b32 v15, v23
    s_nop 1
    v_permlane16_swap_b32 v22, v14
    v_permlane16_swap_b32 v23, v15
    s_nop 1
    v_max_f32 v22, v22, v14
    v_max_f32 v23, v23, v15
    v_mov_b32 v14, v22
    v_mov_b32 v15, v23
    s_nop 1
    v_permlane32_swap_b32 v22, v14
    v_permlane32_swap_b32 v23, v15
    s_nop 1
    v_max_f32 v22, v22, v14
    v_max_f32 v23, v23, v15
    v_cmp_lt_f32 vcc, s30, v22
    s_nop 1
    v_cndmask_b32 v22, 0, v22, vcc
    v_sub_f32 v220, v220, v22
    v_sub_f32 v221, v221, v22
    v_sub_f32 v222, v222, v22
    v_sub_f32 v223, v223, v22
    v_sub_f32 v224, v224, v22
    v_sub_f32 v225, v225, v22
    v_sub_f32 v226, v226, v22
    v_sub_f32 v227, v227, v22
    v_sub_f32 v100, v100, v22
    v_sub_f32 v101, v101, v22
    v_sub_f32 v102, v102, v22
    v_sub_f32 v103, v103, v22
    v_sub_f32 v14, 0, v22
    v_exp_f32 v14, v14
    s_nop 0
    v_mul_f32 v92, v92, v14
    v_mul_f32 v93, v93, v14
    v_mul_f32 v94, v94, v14
    v_mul_f32 v95, v95, v14
    v_mul_f32 v28, v28, v14
    v_mul_f32 v29, v29, v14
    v_mul_f32 v30, v30, v14
    v_mul_f32 v31, v31, v14
    v_mul_f32 v32, v32, v14
    v_mul_f32 v33, v33, v14
    v_mul_f32 v34, v34, v14
    v_mul_f32 v35, v35, v14
    v_mul_f32 v36, v36, v14
    v_mul_f32 v37, v37, v14
    v_mul_f32 v38, v38, v14
    v_mul_f32 v39, v39, v14
    v_mul_f32 v40, v40, v14
    v_mul_f32 v41, v41, v14
    v_mul_f32 v42, v42, v14
    v_mul_f32 v43, v43, v14
    v_mul_f32 v44, v44, v14
    v_mul_f32 v45, v45, v14
    v_mul_f32 v46, v46, v14
    v_mul_f32 v47, v47, v14
    v_mul_f32 v48, v48, v14
    v_mul_f32 v49, v49, v14
    v_mul_f32 v50, v50, v14
    v_mul_f32 v51, v51, v14
    v_mul_f32 v52, v52, v14
    v_mul_f32 v53, v53, v14
    v_mul_f32 v54, v54, v14
    v_mul_f32 v55, v55, v14
    v_mul_f32 v56, v56, v14
    v_mul_f32 v57, v57, v14
    v_mul_f32 v58, v58, v14
    v_mul_f32 v59, v59, v14
    v_cmp_lt_f32 vcc, s30, v23
    s_nop 1
    v_cndmask_b32 v23, 0, v23, vcc
    v_sub_f32 v228, v228, v23
    v_sub_f32 v229, v229, v23
    v_sub_f32 v230, v230, v23
    v_sub_f32 v231, v231, v23
    v_sub_f32 v232, v232, v23
    v_sub_f32 v233, v233, v23
    v_sub_f32 v234, v234, v23
    v_sub_f32 v235, v235, v23
    v_sub_f32 v104, v104, v23
    v_sub_f32 v105, v105, v23
    v_sub_f32 v106, v106, v23
    v_sub_f32 v107, v107, v23
    v_sub_f32 v14, 0, v23
    v_exp_f32 v14, v14
    s_nop 0
    v_mul_f32 v96, v96, v14
    v_mul_f32 v97, v97, v14
    v_mul_f32 v98, v98, v14
    v_mul_f32 v99, v99, v14
    v_mul_f32 v60, v60, v14
    v_mul_f32 v61, v61, v14
    v_mul_f32 v62, v62, v14
    v_mul_f32 v63, v63, v14
    v_mul_f32 v64, v64, v14
    v_mul_f32 v65, v65, v14
    v_mul_f32 v66, v66, v14
    v_mul_f32 v67, v67, v14
    v_mul_f32 v68, v68, v14
    v_mul_f32 v69, v69, v14
    v_mul_f32 v70, v70, v14
    v_mul_f32 v71, v71, v14
    v_mul_f32 v72, v72, v14
    v_mul_f32 v73, v73, v14
    v_mul_f32 v74, v74, v14
    v_mul_f32 v75, v75, v14
    v_mul_f32 v76, v76, v14
    v_mul_f32 v77, v77, v14
    v_mul_f32 v78, v78, v14
    v_mul_f32 v79, v79, v14
    v_mul_f32 v80, v80, v14
    v_mul_f32 v81, v81, v14
    v_mul_f32 v82, v82, v14
    v_mul_f32 v83, v83, v14
    v_mul_f32 v84, v84, v14
    v_mul_f32 v85, v85, v14
    v_mul_f32 v86, v86, v14
    v_mul_f32 v87, v87, v14
    v_mul_f32 v88, v88, v14
    v_mul_f32 v89, v89, v14
    v_mul_f32 v90, v90, v14
    v_mul_f32 v91, v91, v14
    s_mov_b32 s29, 0x41000000
    s_mov_b32 s30, s29
    s_nop 1
    s_setpc_b64 s[72:73]
L_k1_rinitB:
    v_mov_b32 v14, v22
    v_mov_b32 v15, v23
    s_nop 1
    v_permlane16_swap_b32 v22, v14
    v_permlane16_swap_b32 v23, v15
    s_nop 1
    v_max_f32 v22, v22, v14
    v_max_f32 v23, v23, v15
    v_mov_b32 v14, v22
    v_mov_b32 v15, v23
    s_nop 1
    v_permlane32_swap_b32 v22, v14
    v_permlane32_swap_b32 v23, v15
    s_nop 1
    v_max_f32 v22, v22, v14
    v_max_f32 v23, v23, v15
    v_sub_f32 v204, v204, v22
    v_sub_f32 v205, v205, v22
    v_sub_f32 v206, v206, v22
    v_sub_f32 v207, v207, v22
    v_sub_f32 v208, v208, v22
    v_sub_f32 v209, v209, v22
    v_sub_f32 v210, v210, v22
    v_sub_f32 v211, v211, v22
    v_sub_f32 v100, v100, v22
    v_sub_f32 v101, v101, v22
    v_sub_f32 v102, v102, v22
    v_sub_f32 v103, v103, v22
    v_sub_f32 v212, v212, v23
    v_sub_f32 v213, v213, v23
    v_sub_f32 v214, v214, v23
    v_sub_f32 v215, v215, v23
    v_sub_f32 v216, v216, v23
    v_sub_f32 v217, v217, v23
    v_sub_f32 v218, v218, v23
    v_sub_f32 v219, v219, v23
    v_sub_f32 v104, v104, v23
    v_sub_f32 v105, v105, v23
    v_sub_f32 v106, v106, v23
    v_sub_f32 v107, v107, v23
    s_mov_b32 s29, 0x41000000
    s_mov_b32 s30, s29
    s_nop 1
    s_setpc_b64 s[72:73]
L_k1_w4:
    s_mov_b32 s64, s100
    s_mov_b32 s65, s101
    s_mov_b32 s66, 256
    s_mov_b32 s67, 0x20000
    s_memrealtime s[58:59]
    s_waitcnt lgkmcnt(0)
    s_or_b32 s44, s58, 1
    v_mov_b32 v16, s44
    v_mov_b32 v17, 0
    v_mov_b32 v14, 0
    s_mov_b64 exec, 1
    buffer_atomic_cmpswap v[16:17], v14, s[64:67], 0 offen sc0 sc1
    s_mov_b64 exec, -1
    s_barrier
    s_barrier
    s_barrier
    s_barrier
    s_barrier
    s_barrier
    s_barrier
    s_barrier
    s_barrier
    s_barrier
    s_waitcnt vmcnt(0)
    s_barrier
    s_barrier
    s_barrier
    s_barrier
    s_barrier
    s_barrier
    s_cmp_eq_u32 s27, 0
    s_cselect_b32 s76, 2, 4
    s_lshl_b32 s83, s76, 14
    s_add_u32 s83, s83, 81920
    s_mov_b32 s77, s76
    v_lshrrev_b32 v14, 4, v1
    v_and_b32 v15, 15, v1
    v_xor_b32 v16, v14, v15
    v_lshlrev_b32 v16, 4, v16
    v_lshl_add_u32 v16, v15, 8, v16
    v_add_u32 v2, s83, v16
    v_xor_b32 v3, 64, v2
    v_xor_b32 v4, 128, v2
    v_xor_b32 v5, 192, v2
    v_lshrrev_b32 v16, 2, v15
    v_and_b32 v17, 1, v14
    v_lshl_add_u32 v17, v17, 2, v16
    v_lshlrev_b32 v17, 5, v17
    v_lshl_add_u32 v17, v14, 10, v17
    v_lshl_add_u32 v17, v16, 8, v17
    v_and_b32 v18, 3, v15
    v_lshl_add_u32 v17, v18, 3, v17
    v_add_u32 v17, 8192, v17
    v_add_u32 v6, s83, v17
    v_xor_b32 v7, 32, v6
    v_xor_b32 v8, 64, v6
    v_xor_b32 v9, 96, v6
    v_xor_b32 v10, 128, v6
    v_xor_b32 v11, 160, v6
    v_xor_b32 v12, 192, v6
    v_xor_b32 v13, 224, v6
    s_waitcnt lgkmcnt(0)
    v_mov_b32 v28, 0
    v_mov_b32 v29, 0
    v_mov_b32 v30, 0
    v_mov_b32 v31, 0
    v_mov_b32 v32, 0
    v_mov_b32 v33, 0
    v_mov_b32 v34, 0
    v_mov_b32 v35, 0
    v_mov_b32 v36, 0
    v_mov_b32 v37, 0
    v_mov_b32 v38, 0
    v_mov_b32 v39, 0
    v_mov_b32 v40, 0
    v_mov_b32 v41, 0
    v_mov_b32 v42, 0
    v_mov_b32 v43, 0
    v_mov_b32 v44, 0
    v_mov_b32 v45, 0
    v_mov_b32 v46, 0
    v_mov_b32 v47, 0
    v_mov_b32 v48, 0
    v_mov_b32 v49, 0
    v_mov_b32 v50, 0
    v_mov_b32 v51, 0
    v_mov_b32 v52, 0
    v_mov_b32 v53, 0
    v_mov_b32 v54, 0
    v_mov_b32 v55, 0
    v_mov_b32 v56, 0
    v_mov_b32 v57, 0
    v_mov_b32 v58, 0
    v_mov_b32 v59, 0
    v_mov_b32 v92, 0
    v_mov_b32 v100, 0
    v_mov_b32 v93, 0
    v_mov_b32 v101, 0
    v_mov_b32 v94, 0
    v_mov_b32 v102, 0
    v_mov_b32 v95, 0
    v_mov_b32 v103, 0
    s_barrier
    s_lshl_b32 s52, s53, 12
    s_add_u32 s52, s52, 69632
    s_sub_u32 s52, s52, s83
    v_add_u32 v14, s52, v2
    v_add_u32 v15, s52, v3
    v_add_u32 v16, s52, v4
    v_add_u32 v17, s52, v5
    ds_read_b128 v[108:111], v14 offset:0
    ds_read_b128 v[112:115], v15 offset:0
    ds_read_b128 v[116:119], v16 offset:0
    ds_read_b128 v[120:123], v17 offset:0
    ds_read_b128 v[140:143], v2 offset:0
    ds_read_b128 v[156:159], v2 offset:4096
    ds_read_b128 v[144:147], v3 offset:0
    ds_read_b128 v[160:163], v3 offset:4096
    ds_read_b128 v[148:151], v4 offset:0
    ds_read_b128 v[164:167], v4 offset:4096
    ds_read_b128 v[152:155], v5 offset:0
    ds_read_b128 v[168:171], v5 offset:4096
    s_cmp_eq_u32 s77, 4
    s_cselect_b32 s79, s81, s80
    s_add_u32 s77, s77, 1
    s_cmp_eq_u32 s77, 5
    s_cselect_b32 s77, 0, s77
    v_add_u32 v2, s79, v2
    v_add_u32 v3, s79, v3
    v_add_u32 v4, s79, v4
    v_add_u32 v5, s79, v5
    s_waitcnt lgkmcnt(0)
    s_barrier
    s_mul_i32 s44, s24, 9437184
    s_mul_i32 s45, s25, 1179648
    s_add_u32 s44, s44, s45
    s_lshl_b32 s45, s26, 8
    s_add_u32 s44, s44, s45
    s_add_u32 s20, s40, s44
    s_addc_u32 s21, s41, 0
    s_mov_b32 s22, 1171712
    s_mov_b32 s23, 0x20000
    s_add_u32 s26, s26, 4
    s_mov_b32 s29, 0xff800000
    s_mov_b32 s30, 0xff800000
    s_waitcnt lgkmcnt(0)
    v_mfma_f32_16x16x32_bf16 v[204:207], v[140:143], v[108:111], v[100:103]
    v_mfma_f32_16x16x32_bf16 v[208:211], v[156:159], v[108:111], v[100:103]
    v_mfma_f32_16x16x32_bf16 v[204:207], v[144:147], v[112:115], v[204:207]
    v_mfma_f32_16x16x32_bf16 v[208:211], v[160:163], v[112:115], v[208:211]
    v_mfma_f32_16x16x32_bf16 v[204:207], v[148:151], v[116:119], v[204:207]
    v_mfma_f32_16x16x32_bf16 v[208:211], v[164:167], v[116:119], v[208:211]
    v_mfma_f32_16x16x32_bf16 v[204:207], v[152:155], v[120:123], v[204:207]
    v_mfma_f32_16x16x32_bf16 v[208:211], v[168:171], v[120:123], v[208:211]
    ds_read_b128 v[140:143], v2 offset:0
    ds_read_b128 v[156:159], v2 offset:4096
    ds_read_b128 v[144:147], v3 offset:0
    ds_read_b128 v[160:163], v3 offset:4096
    ds_read_b128 v[148:151], v4 offset:0
    ds_read_b128 v[164:167], v4 offset:4096
    ds_read_b128 v[152:155], v5 offset:0
    ds_read_b128 v[168:171], v5 offset:4096
    s_cmp_eq_u32 s77, 4
    s_cselect_b32 s79, s81, s80
    s_add_u32 s77, s77, 1
    s_cmp_eq_u32 s77, 5
    s_cselect_b32 s77, 0, s77
    v_add_u32 v2, s79, v2
    v_add_u32 v3, s79, v3
    v_add_u32 v4, s79, v4
    v_add_u32 v5, s79, v5
    s_nop 3
    v_max3_f32 v22, v204, v205, v206
    v_max3_f32 v22, v22, v207, v208
    v_max3_f32 v22, v22, v209, v210
    v_max_f32 v22, v22, v211
    v_cmp_lt_f32 vcc, s29, v22
    s_call_b64 s[72:73], L_k1_rinitS
    s_mov_b32 s49, 0
L_attn_loop_38:
    s_waitcnt lgkmcnt(0)
    v_mfma_f32_16x16x32_bf16 v[220:223], v[140:143], v[108:111], v[100:103]
    v_exp_f32 v204, v204
    ds_read_b64_tr_b16 v[172:173], v6 offset:0
    ds_read_b64_tr_b16 v[174:175], v6 offset:4096
    v_exp_f32 v205, v205
    v_mfma_f32_16x16x32_bf16 v[224:227], v[156:159], v[108:111], v[100:103]
    ds_read_b64_tr_b16 v[176:177], v7 offset:0
    ds_read_b64_tr_b16 v[178:179], v7 offset:4096
    v_exp_f32 v206, v206
    ds_read_b64_tr_b16 v[180:181], v8 offset:0
    v_mfma_f32_16x16x32_bf16 v[220:223], v[144:147], v[112:115], v[220:223]
    ds_read_b64_tr_b16 v[182:183], v8 offset:4096
    v_exp_f32 v207, v207
    ds_read_b64_tr_b16 v[184:185], v9 offset:0
    v_mfma_f32_16x16x32_bf16 v[224:227], v[160:163], v[112:115], v[224:227]
    ds_read_b64_tr_b16 v[186:187], v9 offset:4096
    v_cvt_pk_bf16_f32 v236, v204, v205
    v_exp_f32 v208, v208
    ds_read_b64_tr_b16 v[188:189], v10 offset:0
    v_mfma_f32_16x16x32_bf16 v[220:223], v[148:151], v[116:119], v[220:223]
    ds_read_b64_tr_b16 v[190:191], v10 offset:4096
    v_exp_f32 v209, v209
    ds_read_b64_tr_b16 v[192:193], v11 offset:0
    ds_read_b64_tr_b16 v[194:195], v11 offset:4096
    v_mfma_f32_16x16x32_bf16 v[224:227], v[164:167], v[116:119], v[224:227]
    v_cvt_pk_bf16_f32 v237, v206, v207
    v_exp_f32 v210, v210
    ds_read_b64_tr_b16 v[196:197], v12 offset:0
    v_mfma_f32_16x16x32_bf16 v[220:223], v[152:155], v[120:123], v[220:223]
    ds_read_b64_tr_b16 v[198:199], v12 offset:4096
    v_exp_f32 v211, v211
    ds_read_b64_tr_b16 v[200:201], v13 offset:0
    ds_read_b64_tr_b16 v[202:203], v13 offset:4096
    v_mfma_f32_16x16x32_bf16 v[224:227], v[168:171], v[120:123], v[224:227]
    v_cvt_pk_bf16_f32 v238, v208, v209
    s_nop 0
    v_cvt_pk_bf16_f32 v239, v210, v211
    s_waitcnt lgkmcnt(0)
    s_barrier
    v_mfma_f32_16x16x32_bf16 v[28:31], v[172:175], v[236:239], v[28:31]
    ds_read_b128 v[140:143], v2 offset:0
    ds_read_b128 v[156:159], v2 offset:4096
    ds_read_b128 v[144:147], v3 offset:0
    ds_read_b128 v[160:163], v3 offset:4096
    v_mfma_f32_16x16x32_bf16 v[32:35], v[176:179], v[236:239], v[32:35]
    ds_read_b128 v[148:151], v4 offset:0
    ds_read_b128 v[164:167], v4 offset:4096
    ds_read_b128 v[152:155], v5 offset:0
    ds_read_b128 v[168:171], v5 offset:4096
    v_mfma_f32_16x16x32_bf16 v[36:39], v[180:183], v[236:239], v[36:39]
    s_cmp_eq_u32 s76, 4
    s_cselect_b32 s78, s81, s80
    s_add_u32 s76, s76, 1
    s_cmp_eq_u32 s76, 5
    v_mfma_f32_16x16x32_bf16 v[40:43], v[184:187], v[236:239], v[40:43]
    s_cselect_b32 s76, 0, s76
    v_add_u32 v6, s78, v6
    v_add_u32 v7, s78, v7
    v_add_u32 v8, s78, v8
    v_mfma_f32_16x16x32_bf16 v[92:95], v[24:27], v[236:239], v[92:95]
    v_add_u32 v9, s78, v9
    v_add_u32 v10, s78, v10
    v_add_u32 v11, s78, v11
    v_mfma_f32_16x16x32_bf16 v[44:47], v[188:191], v[236:239], v[44:47]
    v_add_u32 v12, s78, v12
    v_add_u32 v13, s78, v13
    s_cmp_eq_u32 s77, 4
    s_cselect_b32 s79, s81, s80
    v_mfma_f32_16x16x32_bf16 v[48:51], v[192:195], v[236:239], v[48:51]
    s_add_u32 s77, s77, 1
    s_cmp_eq_u32 s77, 5
    s_cselect_b32 s77, 0, s77
    v_add_u32 v2, s79, v2
    v_mfma_f32_16x16x32_bf16 v[52:55], v[196:199], v[236:239], v[52:55]
    v_add_u32 v3, s79, v3
    v_add_u32 v4, s79, v4
    v_add_u32 v5, s79, v5
    v_max3_f32 v22, v220, v221, v222
    v_mfma_f32_16x16x32_bf16 v[56:59], v[200:203], v[236:239], v[56:59]
    v_max3_f32 v22, v22, v223, v224
    v_max3_f32 v22, v22, v225, v226
    v_max_f32 v22, v22, v227
    v_cmp_lt_f32 vcc, s29, v22
    s_cbranch_vccnz L_rare_39
L_back_40:
    s_waitcnt lgkmcnt(0)
    v_mfma_f32_16x16x32_bf16 v[204:207], v[140:143], v[108:111], v[100:103]
    v_exp_f32 v220, v220
    ds_read_b64_tr_b16 v[172:173], v6 offset:0
    ds_read_b64_tr_b16 v[174:175], v6 offset:4096
    v_exp_f32 v221, v221
    v_mfma_f32_16x16x32_bf16 v[208:211], v[156:159], v[108:111], v[100:103]
    ds_read_b64_tr_b16 v[176:177], v7 offset:0
    ds_read_b64_tr_b16 v[178:179], v7 offset:4096
    v_exp_f32 v222, v222
    ds_read_b64_tr_b16 v[180:181], v8 offset:0
    v_mfma_f32_16x16x32_bf16 v[204:207], v[144:147], v[112:115], v[204:207]
    ds_read_b64_tr_b16 v[182:183], v8 offset:4096
    v_exp_f32 v223, v223
    ds_read_b64_tr_b16 v[184:185], v9 offset:0
    v_mfma_f32_16x16x32_bf16 v[208:211], v[160:163], v[112:115], v[208:211]
    ds_read_b64_tr_b16 v[186:187], v9 offset:4096
    v_cvt_pk_bf16_f32 v236, v220, v221
    v_exp_f32 v224, v224
    ds_read_b64_tr_b16 v[188:189], v10 offset:0
    v_mfma_f32_16x16x32_bf16 v[204:207], v[148:151], v[116:119], v[204:207]
    ds_read_b64_tr_b16 v[190:191], v10 offset:4096
    v_exp_f32 v225, v225
    ds_read_b64_tr_b16 v[192:193], v11 offset:0
    ds_read_b64_tr_b16 v[194:195], v11 offset:4096
    v_mfma_f32_16x16x32_bf16 v[208:211], v[164:167], v[116:119], v[208:211]
    v_cvt_pk_bf16_f32 v237, v222, v223
    v_exp_f32 v226, v226
    ds_read_b64_tr_b16 v[196:197], v12 offset:0
    v_mfma_f32_16x16x32_bf16 v[204:207], v[152:155], v[120:123], v[204:207]
    ds_read_b64_tr_b16 v[198:199], v12 offset:4096
    v_exp_f32 v227, v227
    ds_read_b64_tr_b16 v[200:201], v13 offset:0
    ds_read_b64_tr_b16 v[202:203], v13 offset:4096
    v_mfma_f32_16x16x32_bf16 v[208:211], v[168:171], v[120:123], v[208:211]
    v_cvt_pk_bf16_f32 v238, v224, v225
    s_nop 0
    v_cvt_pk_bf16_f32 v239, v226, v227
    s_waitcnt lgkmcnt(0)
    s_barrier
    s_cmp_eq_u32 s49, 15
    s_cselect_b32 s29, 0x7f800000, s29
    v_mfma_f32_16x16x32_bf16 v[28:31], v[172:175], v[236:239], v[28:31]
    ds_read_b128 v[140:143], v2 offset:0
    ds_read_b128 v[156:159], v2 offset:4096
    ds_read_b128 v[144:147], v3 offset:0
    ds_read_b128 v[160:163], v3 offset:4096
    v_mfma_f32_16x16x32_bf16 v[32:35], v[176:179], v[236:239], v[32:35]
    ds_read_b128 v[148:151], v4 offset:0
    ds_read_b128 v[164:167], v4 offset:4096
    ds_read_b128 v[152:155], v5 offset:0
    ds_read_b128 v[168:171], v5 offset:4096
    v_mfma_f32_16x16x32_bf16 v[36:39], v[180:183], v[236:239], v[36:39]
    s_cmp_eq_u32 s76, 4
    s_cselect_b32 s78, s81, s80
    s_add_u32 s76, s76, 1
    s_cmp_eq_u32 s76, 5
    v_mfma_f32_16x16x32_bf16 v[40:43], v[184:187], v[236:239], v[40:43]
    s_cselect_b32 s76, 0, s76
    v_add_u32 v6, s78, v6
    v_add_u32 v7, s78, v7
    v_add_u32 v8, s78, v8
    v_mfma_f32_16x16x32_bf16 v[92:95], v[24:27], v[236:239], v[92:95]
    v_add_u32 v9, s78, v9
    v_add_u32 v10, s78, v10
    v_add_u32 v11, s78, v11
    v_mfma_f32_16x16x32_bf16 v[44:47], v[188:191], v[236:239], v[44:47]
    v_add_u32 v12, s78, v12
    v_add_u32 v13, s78, v13
    s_cmp_eq_u32 s77, 4
    s_cselect_b32 s79, s81, s80
    v_mfma_f32_16x16x32_bf16 v[48:51], v[192:195], v[236:239], v[48:51]
    s_add_u32 s77, s77, 1
    s_cmp_eq_u32 s77, 5
    s_cselect_b32 s77, 0, s77
    v_add_u32 v2, s79, v2
    v_mfma_f32_16x16x32_bf16 v[52:55], v[196:199], v[236:239], v[52:55]
    v_add_u32 v3, s79, v3
    v_add_u32 v4, s79, v4
    v_add_u32 v5, s79, v5
    v_max3_f32 v22, v204, v205, v206
    v_mfma_f32_16x16x32_bf16 v[56:59], v[200:203], v[236:239], v[56:59]
    v_max3_f32 v22, v22, v207, v208
    v_max3_f32 v22, v22, v209, v210
    v_max_f32 v22, v22, v211
    v_cmp_lt_f32 vcc, s29, v22
    s_cbranch_vccnz L_rare_41
L_back_42:
    s_add_u32 s49, s49, 1
    s_cmp_lt_u32 s49, 16
    s_cbranch_scc1 L_attn_loop_38
    s_mov_b32 s27, 1
    s_cmp_eq_u32 s27, 0
    s_cselect_b32 s76, 2, 4
    s_lshl_b32 s83, s76, 14
    s_add_u32 s83, s83, 81920
    s_mov_b32 s77, s76
    v_lshrrev_b32 v14, 4, v1
    v_and_b32 v15, 15, v1
    v_xor_b32 v16, v14, v15
    v_lshlrev_b32 v16, 4, v16
    v_lshl_add_u32 v16, v15, 8, v16
    v_add_u32 v2, s83, v16
    v_xor_b32 v3, 64, v2
    v_xor_b32 v4, 128, v2
    v_xor_b32 v5, 192, v2
    v_lshrrev_b32 v16, 2, v15
    v_and_b32 v17, 1, v14
    v_lshl_add_u32 v17, v17, 2, v16
    v_lshlrev_b32 v17, 5, v17
    v_lshl_add_u32 v17, v14, 10, v17
    v_lshl_add_u32 v17, v16, 8, v17
    v_and_b32 v18, 3, v15
    v_lshl_add_u32 v17, v18, 3, v17
    v_add_u32 v17, 8192, v17
    v_add_u32 v6, s83, v17
    v_xor_b32 v7, 32, v6
    v_xor_b32 v8, 64, v6
    v_xor_b32 v9, 96, v6
    v_xor_b32 v10, 128, v6
    v_xor_b32 v11, 160, v6
    v_xor_b32 v12, 192, v6
    v_xor_b32 v13, 224, v6
    v_mov_b32 v100, 0
    v_mov_b32 v101, 0
    v_mov_b32 v102, 0
    v_mov_b32 v103, 0
    s_waitcnt lgkmcnt(0)
    s_barrier
    s_mov_b32 s64, s100
    s_mov_b32 s65, s101
    s_mov_b32 s66, 256
    s_mov_b32 s67, 0x20000
    v_mov_b32 v20, 0
    s_nop 0
    buffer_load_dword v20, v20, s[64:67], 0 offen sc1
    s_lshl_b32 s52, s53, 12
    s_add_u32 s52, s52, 0
    s_sub_u32 s52, s52, s83
    v_add_u32 v14, s52, v2
    v_add_u32 v15, s52, v3
    v_add_u32 v16, s52, v4
    v_add_u32 v17, s52, v5
    ds_read_b128 v[108:111], v14 offset:0
    ds_read_b128 v[112:115], v15 offset:0
    ds_read_b128 v[116:119], v16 offset:0
    ds_read_b128 v[120:123], v17 offset:0
    ds_read_b128 v[140:143], v2 offset:0
    ds_read_b128 v[156:159], v2 offset:4096
    ds_read_b128 v[144:147], v3 offset:0
    ds_read_b128 v[160:163], v3 offset:4096
    ds_read_b128 v[148:151], v4 offset:0
    ds_read_b128 v[164:167], v4 offset:4096
    ds_read_b128 v[152:155], v5 offset:0
    ds_read_b128 v[168:171], v5 offset:4096
    s_cmp_eq_u32 s77, 4
    s_cselect_b32 s79, s81, s80
    s_add_u32 s77, s77, 1
    s_cmp_eq_u32 s77, 5
    s_cselect_b32 s77, 0, s77
    v_add_u32 v2, s79, v2
    v_add_u32 v3, s79, v3
    v_add_u32 v4, s79, v4
    v_add_u32 v5, s79, v5
    s_mov_b32 s29, 0xff800000
    s_mov_b32 s30, 0xff800000
    s_waitcnt lgkmcnt(0)
    v_mfma_f32_16x16x32_bf16 v[204:207], v[140:143], v[108:111], v[100:103]
    v_mfma_f32_16x16x32_bf16 v[208:211], v[156:159], v[108:111], v[100:103]
    v_mfma_f32_16x16x32_bf16 v[204:207], v[144:147], v[112:115], v[204:207]
    v_mfma_f32_16x16x32_bf16 v[208:211], v[160:163], v[112:115], v[208:211]
    v_mfma_f32_16x16x32_bf16 v[204:207], v[148:151], v[116:119], v[204:207]
    v_mfma_f32_16x16x32_bf16 v[208:211], v[164:167], v[116:119], v[208:211]
    v_mfma_f32_16x16x32_bf16 v[204:207], v[152:155], v[120:123], v[204:207]
    v_mfma_f32_16x16x32_bf16 v[208:211], v[168:171], v[120:123], v[208:211]
    ds_read_b128 v[140:143], v2 offset:0
    ds_read_b128 v[156:159], v2 offset:4096
    ds_read_b128 v[144:147], v3 offset:0
    ds_read_b128 v[160:163], v3 offset:4096
    ds_read_b128 v[148:151], v4 offset:0
    ds_read_b128 v[164:167], v4 offset:4096
    ds_read_b128 v[152:155], v5 offset:0
    ds_read_b128 v[168:171], v5 offset:4096
    s_cmp_eq_u32 s77, 4
    s_cselect_b32 s79, s81, s80
    s_add_u32 s77, s77, 1
    s_cmp_eq_u32 s77, 5
    s_cselect_b32 s77, 0, s77
    v_add_u32 v2, s79, v2
    v_add_u32 v3, s79, v3
    v_add_u32 v4, s79, v4
    v_add_u32 v5, s79, v5
    v_lshrrev_b32 v14, 4, v1
    v_and_b32 v15, 15, v1
    v_and_b32 v16, 1, v14
    v_lshlrev_b32 v16, 5, v16
    v_lshrrev_b32 v14, 1, v14
    v_lshl_add_u32 v16, v14, 4, v16
    v_lshl_add_u32 v15, v15, 13, v16
    s_mul_i32 s44, s53, 131072
    v_rcp_f32 v22, v92
    s_nop 0
    v_mul_f32 v28, v28, v22
    v_mul_f32 v29, v29, v22
    v_mul_f32 v30, v30, v22
    v_mul_f32 v31, v31, v22
    v_mul_f32 v32, v32, v22
    v_mul_f32 v33, v33, v22
    v_mul_f32 v34, v34, v22
    v_mul_f32 v35, v35, v22
    v_cvt_pk_bf16_f32 v28, v28, v29
    v_cvt_pk_bf16_f32 v29, v30, v31
    v_cvt_pk_bf16_f32 v30, v32, v33
    v_cvt_pk_bf16_f32 v31, v34, v35
    s_nop 1
    v_permlane16_swap_b32 v28, v30
    v_permlane16_swap_b32 v29, v31
    buffer_store_dwordx4 v[28:31], v15, s[20:23], s44 offen offset:0 sc1
    v_mul_f32 v36, v36, v22
    v_mul_f32 v37, v37, v22
    v_mul_f32 v38, v38, v22
    v_mul_f32 v39, v39, v22
    v_mul_f32 v40, v40, v22
    v_mul_f32 v41, v41, v22
    v_mul_f32 v42, v42, v22
    v_mul_f32 v43, v43, v22
    v_cvt_pk_bf16_f32 v36, v36, v37
    v_cvt_pk_bf16_f32 v37, v38, v39
    v_cvt_pk_bf16_f32 v38, v40, v41
    v_cvt_pk_bf16_f32 v39, v42, v43
    s_nop 1
    v_permlane16_swap_b32 v36, v38
    v_permlane16_swap_b32 v37, v39
    buffer_store_dwordx4 v[36:39], v15, s[20:23], s44 offen offset:64 sc1
    v_mul_f32 v44, v44, v22
    v_mul_f32 v45, v45, v22
    v_mul_f32 v46, v46, v22
    v_mul_f32 v47, v47, v22
    v_mul_f32 v48, v48, v22
    v_mul_f32 v49, v49, v22
    v_mul_f32 v50, v50, v22
    v_mul_f32 v51, v51, v22
    v_cvt_pk_bf16_f32 v44, v44, v45
    v_cvt_pk_bf16_f32 v45, v46, v47
    v_cvt_pk_bf16_f32 v46, v48, v49
    v_cvt_pk_bf16_f32 v47, v50, v51
    s_nop 1
    v_permlane16_swap_b32 v44, v46
    v_permlane16_swap_b32 v45, v47
    buffer_store_dwordx4 v[44:47], v15, s[20:23], s44 offen offset:128 sc1
    v_mul_f32 v52, v52, v22
    v_mul_f32 v53, v53, v22
    v_mul_f32 v54, v54, v22
    v_mul_f32 v55, v55, v22
    v_mul_f32 v56, v56, v22
    v_mul_f32 v57, v57, v22
    v_mul_f32 v58, v58, v22
    v_mul_f32 v59, v59, v22
    v_cvt_pk_bf16_f32 v52, v52, v53
    v_cvt_pk_bf16_f32 v53, v54, v55
    v_cvt_pk_bf16_f32 v54, v56, v57
    v_cvt_pk_bf16_f32 v55, v58, v59
    s_nop 1
    v_permlane16_swap_b32 v52, v54
    v_permlane16_swap_b32 v53, v55
    buffer_store_dwordx4 v[52:55], v15, s[20:23], s44 offen offset:192 sc1
    s_mov_b32 s27, 0
    s_mov_b32 s27, 1
    s_mul_i32 s44, s24, 9437184
    s_mul_i32 s45, s25, 1179648
    s_add_u32 s44, s44, s45
    s_lshl_b32 s45, s26, 8
    s_add_u32 s44, s44, s45
    s_add_u32 s20, s40, s44
    s_addc_u32 s21, s41, 0
    s_mov_b32 s22, 1171712
    s_mov_b32 s23, 0x20000
    v_mov_b32 v28, 0
    v_mov_b32 v29, 0
    v_mov_b32 v30, 0
    v_mov_b32 v31, 0
    v_mov_b32 v32, 0
    v_mov_b32 v33, 0
    v_mov_b32 v34, 0
    v_mov_b32 v35, 0
    v_mov_b32 v36, 0
    v_mov_b32 v37, 0
    v_mov_b32 v38, 0
    v_mov_b32 v39, 0
    v_mov_b32 v40, 0
    v_mov_b32 v41, 0
    v_mov_b32 v42, 0
    v_mov_b32 v43, 0
    v_mov_b32 v44, 0
    v_mov_b32 v45, 0
    v_mov_b32 v46, 0
    v_mov_b32 v47, 0
    v_mov_b32 v48, 0
    v_mov_b32 v49, 0
    v_mov_b32 v50, 0
    v_mov_b32 v51, 0
    v_mov_b32 v52, 0
    v_mov_b32 v53, 0
    v_mov_b32 v54, 0
    v_mov_b32 v55, 0
    v_mov_b32 v56, 0
    v_mov_b32 v57, 0
    v_mov_b32 v58, 0
    v_mov_b32 v59, 0
    v_mov_b32 v92, 0
    v_mov_b32 v93, 0
    v_mov_b32 v94, 0
    v_mov_b32 v95, 0
    s_nop 3
    v_max3_f32 v22, v204, v205, v206
    v_max3_f32 v22, v22, v207, v208
    v_max3_f32 v22, v22, v209, v210
    v_max_f32 v22, v22, v211
    v_cmp_lt_f32 vcc, s29, v22
    s_call_b64 s[72:73], L_k1_rinitS
    s_mov_b32 s49, 0
L_attn_loop_43:
    s_waitcnt lgkmcnt(0)
    v_mfma_f32_16x16x32_bf16 v[220:223], v[140:143], v[108:111], v[100:103]
    v_exp_f32 v204, v204
    ds_read_b64_tr_b16 v[172:173], v6 offset:0
    ds_read_b64_tr_b16 v[174:175], v6 offset:4096
    v_exp_f32 v205, v205
    v_mfma_f32_16x16x32_bf16 v[224:227], v[156:159], v[108:111], v[100:103]
    ds_read_b64_tr_b16 v[176:177], v7 offset:0
    ds_read_b64_tr_b16 v[178:179], v7 offset:4096
    v_exp_f32 v206, v206
    ds_read_b64_tr_b16 v[180:181], v8 offset:0
    v_mfma_f32_16x16x32_bf16 v[220:223], v[144:147], v[112:115], v[220:223]
    ds_read_b64_tr_b16 v[182:183], v8 offset:4096
    v_exp_f32 v207, v207
    ds_read_b64_tr_b16 v[184:185], v9 offset:0
    v_mfma_f32_16x16x32_bf16 v[224:227], v[160:163], v[112:115], v[224:227]
    ds_read_b64_tr_b16 v[186:187], v9 offset:4096
    v_cvt_pk_bf16_f32 v236, v204, v205
    v_exp_f32 v208, v208
    ds_read_b64_tr_b16 v[188:189], v10 offset:0
    v_mfma_f32_16x16x32_bf16 v[220:223], v[148:151], v[116:119], v[220:223]
    ds_read_b64_tr_b16 v[190:191], v10 offset:4096
    v_exp_f32 v209, v209
    ds_read_b64_tr_b16 v[192:193], v11 offset:0
    ds_read_b64_tr_b16 v[194:195], v11 offset:4096
    v_mfma_f32_16x16x32_bf16 v[224:227], v[164:167], v[116:119], v[224:227]
    v_cvt_pk_bf16_f32 v237, v206, v207
    v_exp_f32 v210, v210
    ds_read_b64_tr_b16 v[196:197], v12 offset:0
    v_mfma_f32_16x16x32_bf16 v[220:223], v[152:155], v[120:123], v[220:223]
    ds_read_b64_tr_b16 v[198:199], v12 offset:4096
    v_exp_f32 v211, v211
    ds_read_b64_tr_b16 v[200:201], v13 offset:0
    ds_read_b64_tr_b16 v[202:203], v13 offset:4096
    v_mfma_f32_16x16x32_bf16 v[224:227], v[168:171], v[120:123], v[224:227]
    v_cvt_pk_bf16_f32 v238, v208, v209
    s_nop 0
    v_cvt_pk_bf16_f32 v239, v210, v211
    s_waitcnt lgkmcnt(0)
    s_barrier
    v_mfma_f32_16x16x32_bf16 v[28:31], v[172:175], v[236:239], v[28:31]
    ds_read_b128 v[140:143], v2 offset:0
    ds_read_b128 v[156:159], v2 offset:4096
    ds_read_b128 v[144:147], v3 offset:0
    ds_read_b128 v[160:163], v3 offset:4096
    v_mfma_f32_16x16x32_bf16 v[32:35], v[176:179], v[236:239], v[32:35]
    ds_read_b128 v[148:151], v4 offset:0
    ds_read_b128 v[164:167], v4 offset:4096
    ds_read_b128 v[152:155], v5 offset:0
    ds_read_b128 v[168:171], v5 offset:4096
    v_mfma_f32_16x16x32_bf16 v[36:39], v[180:183], v[236:239], v[36:39]
    s_cmp_eq_u32 s76, 4
    s_cselect_b32 s78, s81, s80
    s_add_u32 s76, s76, 1
    s_cmp_eq_u32 s76, 5
    v_mfma_f32_16x16x32_bf16 v[40:43], v[184:187], v[236:239], v[40:43]
    s_cselect_b32 s76, 0, s76
    v_add_u32 v6, s78, v6
    v_add_u32 v7, s78, v7
    v_add_u32 v8, s78, v8
    v_mfma_f32_16x16x32_bf16 v[92:95], v[24:27], v[236:239], v[92:95]
    v_add_u32 v9, s78, v9
    v_add_u32 v10, s78, v10
    v_add_u32 v11, s78, v11
    v_mfma_f32_16x16x32_bf16 v[44:47], v[188:191], v[236:239], v[44:47]
    v_add_u32 v12, s78, v12
    v_add_u32 v13, s78, v13
    s_cmp_eq_u32 s77, 4
    s_cselect_b32 s79, s81, s80
    v_mfma_f32_16x16x32_bf16 v[48:51], v[192:195], v[236:239], v[48:51]
    s_add_u32 s77, s77, 1
    s_cmp_eq_u32 s77, 5
    s_cselect_b32 s77, 0, s77
    v_add_u32 v2, s79, v2
    v_mfma_f32_16x16x32_bf16 v[52:55], v[196:199], v[236:239], v[52:55]
    v_add_u32 v3, s79, v3
    v_add_u32 v4, s79, v4
    v_add_u32 v5, s79, v5
    v_max3_f32 v22, v220, v221, v222
    v_mfma_f32_16x16x32_bf16 v[56:59], v[200:203], v[236:239], v[56:59]
    v_max3_f32 v22, v22, v223, v224
    v_max3_f32 v22, v22, v225, v226
    v_max_f32 v22, v22, v227
    v_cmp_lt_f32 vcc, s29, v22
    s_cbranch_vccnz L_rare_44
L_back_45:
    s_waitcnt lgkmcnt(0)
    v_mfma_f32_16x16x32_bf16 v[204:207], v[140:143], v[108:111], v[100:103]
    v_exp_f32 v220, v220
    ds_read_b64_tr_b16 v[172:173], v6 offset:0
    ds_read_b64_tr_b16 v[174:175], v6 offset:4096
    v_exp_f32 v221, v221
    v_mfma_f32_16x16x32_bf16 v[208:211], v[156:159], v[108:111], v[100:103]
    ds_read_b64_tr_b16 v[176:177], v7 offset:0
    ds_read_b64_tr_b16 v[178:179], v7 offset:4096
    v_exp_f32 v222, v222
    ds_read_b64_tr_b16 v[180:181], v8 offset:0
    v_mfma_f32_16x16x32_bf16 v[204:207], v[144:147], v[112:115], v[204:207]
    ds_read_b64_tr_b16 v[182:183], v8 offset:4096
    v_exp_f32 v223, v223
    ds_read_b64_tr_b16 v[184:185], v9 offset:0
    v_mfma_f32_16x16x32_bf16 v[208:211], v[160:163], v[112:115], v[208:211]
    ds_read_b64_tr_b16 v[186:187], v9 offset:4096
    v_cvt_pk_bf16_f32 v236, v220, v221
    v_exp_f32 v224, v224
    ds_read_b64_tr_b16 v[188:189], v10 offset:0
    v_mfma_f32_16x16x32_bf16 v[204:207], v[148:151], v[116:119], v[204:207]
    ds_read_b64_tr_b16 v[190:191], v10 offset:4096
    v_exp_f32 v225, v225
    ds_read_b64_tr_b16 v[192:193], v11 offset:0
    ds_read_b64_tr_b16 v[194:195], v11 offset:4096
    v_mfma_f32_16x16x32_bf16 v[208:211], v[164:167], v[116:119], v[208:211]
    v_cvt_pk_bf16_f32 v237, v222, v223
    v_exp_f32 v226, v226
    ds_read_b64_tr_b16 v[196:197], v12 offset:0
    v_mfma_f32_16x16x32_bf16 v[204:207], v[152:155], v[120:123], v[204:207]
    ds_read_b64_tr_b16 v[198:199], v12 offset:4096
    v_exp_f32 v227, v227
    ds_read_b64_tr_b16 v[200:201], v13 offset:0
    ds_read_b64_tr_b16 v[202:203], v13 offset:4096
    v_mfma_f32_16x16x32_bf16 v[208:211], v[168:171], v[120:123], v[208:211]
    v_cvt_pk_bf16_f32 v238, v224, v225
    s_nop 0
    v_cvt_pk_bf16_f32 v239, v226, v227
    s_waitcnt lgkmcnt(0) vmcnt(0)
    s_barrier
    s_cmp_eq_u32 s49, 15
    s_cselect_b32 s29, 0x7f800000, s29
    v_mfma_f32_16x16x32_bf16 v[28:31], v[172:175], v[236:239], v[28:31]
    ds_read_b128 v[140:143], v2 offset:0
    ds_read_b128 v[156:159], v2 offset:4096
    ds_read_b128 v[144:147], v3 offset:0
    ds_read_b128 v[160:163], v3 offset:4096
    v_mfma_f32_16x16x32_bf16 v[32:35], v[176:179], v[236:239], v[32:35]
    ds_read_b128 v[148:151], v4 offset:0
    ds_read_b128 v[164:167], v4 offset:4096
    ds_read_b128 v[152:155], v5 offset:0
    ds_read_b128 v[168:171], v5 offset:4096
    v_mfma_f32_16x16x32_bf16 v[36:39], v[180:183], v[236:239], v[36:39]
    s_cmp_eq_u32 s76, 4
    s_cselect_b32 s78, s81, s80
    s_add_u32 s76, s76, 1
    s_cmp_eq_u32 s76, 5
    v_mfma_f32_16x16x32_bf16 v[40:43], v[184:187], v[236:239], v[40:43]
    s_cselect_b32 s76, 0, s76
    v_add_u32 v6, s78, v6
    v_add_u32 v7, s78, v7
    v_add_u32 v8, s78, v8
    v_mfma_f32_16x16x32_bf16 v[92:95], v[24:27], v[236:239], v[92:95]
    v_add_u32 v9, s78, v9
    v_add_u32 v10, s78, v10
    v_add_u32 v11, s78, v11
    v_mfma_f32_16x16x32_bf16 v[44:47], v[188:191], v[236:239], v[44:47]
    v_add_u32 v12, s78, v12
    v_add_u32 v13, s78, v13
    s_cmp_eq_u32 s77, 4
    s_cselect_b32 s79, s81, s80
    v_mfma_f32_16x16x32_bf16 v[48:51], v[192:195], v[236:239], v[48:51]
    s_add_u32 s77, s77, 1
    s_cmp_eq_u32 s77, 5
    s_cselect_b32 s77, 0, s77
    v_add_u32 v2, s79, v2
    v_mfma_f32_16x16x32_bf16 v[52:55], v[196:199], v[236:239], v[52:55]
    v_add_u32 v3, s79, v3
    v_add_u32 v4, s79, v4
    v_add_u32 v5, s79, v5
    v_max3_f32 v22, v204, v205, v206
    v_mfma_f32_16x16x32_bf16 v[56:59], v[200:203], v[236:239], v[56:59]
    v_max3_f32 v22, v22, v207, v208
    v_max3_f32 v22, v22, v209, v210
    v_max_f32 v22, v22, v211
    v_cmp_lt_f32 vcc, s29, v22
    s_cbranch_vccnz L_rare_46
L_back_47:
    s_add_u32 s49, s49, 1
    s_cmp_lt_u32 s49, 16
    s_cbranch_scc1 L_attn_loop_43
    v_lshrrev_b32 v14, 4, v1
    v_and_b32 v15, 15, v1
    v_and_b32 v16, 1, v14
    v_lshlrev_b32 v16, 5, v16
    v_lshrrev_b32 v14, 1, v14
    v_lshl_add_u32 v16, v14, 4, v16
    v_lshl_add_u32 v15, v15, 13, v16
    s_mul_i32 s44, s53, 131072
    v_rcp_f32 v22, v92
    s_nop 0
    v_mul_f32 v28, v28, v22
    v_mul_f32 v29, v29, v22
    v_mul_f32 v30, v30, v22
    v_mul_f32 v31, v31, v22
    v_mul_f32 v32, v32, v22
    v_mul_f32 v33, v33, v22
    v_mul_f32 v34, v34, v22
    v_mul_f32 v35, v35, v22
    v_cvt_pk_bf16_f32 v28, v28, v29
    v_cvt_pk_bf16_f32 v29, v30, v31
    v_cvt_pk_bf16_f32 v30, v32, v33
    v_cvt_pk_bf16_f32 v31, v34, v35
    s_nop 1
    v_permlane16_swap_b32 v28, v30
    v_permlane16_swap_b32 v29, v31
    buffer_store_dwordx4 v[28:31], v15, s[20:23], s44 offen offset:0 sc1
    v_mul_f32 v36, v36, v22
    v_mul_f32 v37, v37, v22
    v_mul_f32 v38, v38, v22
    v_mul_f32 v39, v39, v22
    v_mul_f32 v40, v40, v22
    v_mul_f32 v41, v41, v22
    v_mul_f32 v42, v42, v22
    v_mul_f32 v43, v43, v22
    v_cvt_pk_bf16_f32 v36, v36, v37
    v_cvt_pk_bf16_f32 v37, v38, v39
    v_cvt_pk_bf16_f32 v38, v40, v41
    v_cvt_pk_bf16_f32 v39, v42, v43
    s_nop 1
    v_permlane16_swap_b32 v36, v38
    v_permlane16_swap_b32 v37, v39
    buffer_store_dwordx4 v[36:39], v15, s[20:23], s44 offen offset:64 sc1
    v_mul_f32 v44, v44, v22
    v_mul_f32 v45, v45, v22
    v_mul_f32 v46, v46, v22
    v_mul_f32 v47, v47, v22
    v_mul_f32 v48, v48, v22
    v_mul_f32 v49, v49, v22
    v_mul_f32 v50, v50, v22
    v_mul_f32 v51, v51, v22
    v_cvt_pk_bf16_f32 v44, v44, v45
    v_cvt_pk_bf16_f32 v45, v46, v47
    v_cvt_pk_bf16_f32 v46, v48, v49
    v_cvt_pk_bf16_f32 v47, v50, v51
    s_nop 1
    v_permlane16_swap_b32 v44, v46
    v_permlane16_swap_b32 v45, v47
    buffer_store_dwordx4 v[44:47], v15, s[20:23], s44 offen offset:128 sc1
    v_mul_f32 v52, v52, v22
    v_mul_f32 v53, v53, v22
    v_mul_f32 v54, v54, v22
    v_mul_f32 v55, v55, v22
    v_mul_f32 v56, v56, v22
    v_mul_f32 v57, v57, v22
    v_mul_f32 v58, v58, v22
    v_mul_f32 v59, v59, v22
    v_cvt_pk_bf16_f32 v52, v52, v53
    v_cvt_pk_bf16_f32 v53, v54, v55
    v_cvt_pk_bf16_f32 v54, v56, v57
    v_cvt_pk_bf16_f32 v55, v58, v59
    s_nop 1
    v_permlane16_swap_b32 v52, v54
    v_permlane16_swap_b32 v53, v55
    buffer_store_dwordx4 v[52:55], v15, s[20:23], s44 offen offset:192 sc1
    s_nop 0
    v_readfirstlane_b32 s91, v20
    s_nop 3
    s_mov_b32 s76, s24
    s_mov_b32 s77, s25
    s_and_b32 s44, s2, 7
    s_lshr_b32 s45, s2, 3
    s_lshr_b32 s24, s44, 2
    s_lshr_b32 s27, s44, 1
    s_and_b32 s27, s27, 1
    s_and_b32 s51, s44, 1
    s_lshl_b32 s51, s51, 2
    s_and_b32 s25, s45, 3
    s_add_u32 s25, s25, s51
    s_lshr_b32 s26, s45, 2
    s_mov_b32 s31, 0
    s_mov_b32 s32, s96
    s_mov_b32 s33, s97
    s_mul_i32 s44, s24, 9437184
    s_mul_i32 s45, s25, 1179648
    s_add_u32 s44, s44, s45
    s_lshl_b32 s45, s27, 12
    s_add_u32 s44, s44, s45
    s_add_u32 s4, s40, s44
    s_addc_u32 s5, s41, 0
    s_mov_b32 s6, 1175552
    s_mov_b32 s7, 0x20000
    s_mov_b32 s51, 9
    v_lshrrev_b32 v14, 3, v1
    v_and_b32 v15, 7, v1
    v_lshrrev_b32 v16, 1, v14
    s_lshl_b32 s45, s51, 2
    v_add_u32 v16, s45, v16
    v_and_b32 v16, 7, v16
    v_xor_b32 v16, v16, v15
    v_lshlrev_b32 v16, 4, v16
    v_mul_u32_u24 v17, 8192, v14
    v_add_u32 v2, v16, v17
    v_xor_b32 v3, 64, v2
    s_mul_i32 s46, s51, 65536
    s_lshl_b32 s47, s51, 10
    s_barrier
    s_mov_b32 s43, 2
    s_lshl_b32 s42, s43, 7
    s_add_u32 s42, s42, s46
    s_add_u32 m0, s47, 69632
    s_add_u32 s44, s42, 0
    buffer_load_dwordx4 v2, s[4:7], s44 offen sc1 lds
    s_add_u32 m0, s47, 70656
    s_add_u32 s44, s42, 65536
    buffer_load_dwordx4 v3, s[4:7], s44 offen sc1 lds
    s_add_u32 m0, s47, 71680
    s_add_u32 s44, s42, 131072
    buffer_load_dwordx4 v2, s[4:7], s44 offen sc1 lds
    s_add_u32 m0, s47, 72704
    s_add_u32 s44, s42, 196608
    buffer_load_dwordx4 v3, s[4:7], s44 offen sc1 lds
    s_add_u32 m0, s47, 73728
    s_add_u32 s44, s42, 262144
    buffer_load_dwordx4 v2, s[4:7], s44 offen sc1 lds
    s_add_u32 m0, s47, 74752
    s_add_u32 s44, s42, 327680
    buffer_load_dwordx4 v3, s[4:7], s44 offen sc1 lds
    s_add_u32 m0, s47, 75776
    s_add_u32 s44, s42, 393216
    buffer_load_dwordx4 v2, s[4:7], s44 offen sc1 lds
    s_add_u32 m0, s47, 76800
    s_add_u32 s44, s42, 458752
    buffer_load_dwordx4 v3, s[4:7], s44 offen sc1 lds
    s_add_u32 m0, s47, 77824
    s_add_u32 s44, s42, 524288
    buffer_load_dwordx4 v2, s[4:7], s44 offen sc1 lds
    s_add_u32 s43, s43, 1
    s_and_b32 s43, s43, 31
    s_mov_b32 s43, 3
    s_lshl_b32 s42, s43, 7
    s_add_u32 s42, s42, s46
    s_add_u32 m0, s47, 104448
    s_add_u32 s44, s42, 0
    buffer_load_dwordx4 v2, s[4:7], s44 offen sc1 lds
    s_add_u32 m0, s47, 105472
    s_add_u32 s44, s42, 65536
    buffer_load_dwordx4 v3, s[4:7], s44 offen sc1 lds
    s_add_u32 m0, s47, 106496
    s_add_u32 s44, s42, 131072
    buffer_load_dwordx4 v2, s[4:7], s44 offen sc1 lds
    s_add_u32 m0, s47, 107520
    s_add_u32 s44, s42, 196608
    buffer_load_dwordx4 v3, s[4:7], s44 offen sc1 lds
    s_add_u32 m0, s47, 108544
    s_add_u32 s44, s42, 262144
    buffer_load_dwordx4 v2, s[4:7], s44 offen sc1 lds
    s_add_u32 m0, s47, 109568
    s_add_u32 s44, s42, 327680
    buffer_load_dwordx4 v3, s[4:7], s44 offen sc1 lds
    s_add_u32 m0, s47, 110592
    s_add_u32 s44, s42, 393216
    buffer_load_dwordx4 v2, s[4:7], s44 offen sc1 lds
    s_add_u32 m0, s47, 111616
    s_add_u32 s44, s42, 458752
    buffer_load_dwordx4 v3, s[4:7], s44 offen sc1 lds
    s_add_u32 m0, s47, 112640
    s_add_u32 s44, s42, 524288
    buffer_load_dwordx4 v2, s[4:7], s44 offen sc1 lds
    s_add_u32 s43, s43, 1
    s_and_b32 s43, s43, 31
    s_waitcnt vmcnt(18)
    s_barrier
    s_mov_b32 s43, 4
    s_lshl_b32 s42, s43, 7
    s_add_u32 s42, s42, s46
    s_add_u32 m0, s47, 0
    s_add_u32 s44, s42, 0
    buffer_load_dwordx4 v2, s[4:7], s44 offen sc1 lds
    s_add_u32 m0, s47, 1024
    s_add_u32 s44, s42, 65536
    buffer_load_dwordx4 v3, s[4:7], s44 offen sc1 lds
    s_add_u32 m0, s47, 2048
    s_add_u32 s44, s42, 131072
    buffer_load_dwordx4 v2, s[4:7], s44 offen sc1 lds
    s_add_u32 m0, s47, 3072
    s_add_u32 s44, s42, 196608
    buffer_load_dwordx4 v3, s[4:7], s44 offen sc1 lds
    s_add_u32 m0, s47, 4096
    s_add_u32 s44, s42, 262144
    buffer_load_dwordx4 v2, s[4:7], s44 offen sc1 lds
    s_add_u32 m0, s47, 5120
    s_add_u32 s44, s42, 327680
    buffer_load_dwordx4 v3, s[4:7], s44 offen sc1 lds
    s_add_u32 m0, s47, 6144
    s_add_u32 s44, s42, 393216
    buffer_load_dwordx4 v2, s[4:7], s44 offen sc1 lds
    s_add_u32 m0, s47, 7168
    s_add_u32 s44, s42, 458752
    buffer_load_dwordx4 v3, s[4:7], s44 offen sc1 lds
    s_add_u32 m0, s47, 8192
    s_add_u32 s44, s42, 524288
    buffer_load_dwordx4 v2, s[4:7], s44 offen sc1 lds
    s_add_u32 s43, s43, 1
    s_and_b32 s43, s43, 31
    s_mov_b32 s78, s24
    s_mov_b32 s79, s25
    s_mov_b32 s24, s76
    s_mov_b32 s25, s77
    s_add_u32 s64, s40, 50339840
    s_addc_u32 s65, s41, 0
    s_mov_b32 s66, 2048
    s_mov_b32 s67, 0x20000
    s_lshl_b32 s44, s24, 3
    s_add_u32 s44, s44, s25
    s_lshl_b32 s44, s44, 1
    s_lshr_b32 s45, s2, 1
    s_and_b32 s45, s45, 1
    s_add_u32 s44, s44, s45
    s_lshl_b32 s44, s44, 6
    s_and_b32 s45, s2, 1
    s_lshl_b32 s45, s45, 4
    s_add_u32 s44, s44, s45
    s_lshr_b32 s45, s2, 6
    s_lshl_b32 s45, s45, 2
    s_add_u32 s44, s44, s45
    s_add_u32 s44, s44, 0
    v_mov_b32 v14, 0
    v_mov_b32 v15, s91
    s_mov_b64 exec, 1
    buffer_store_dword v15, v14, s[64:67], s44 offen sc1
    s_mov_b64 exec, -1
    s_mov_b32 s24, s78
    s_mov_b32 s25, s79
    s_waitcnt vmcnt(19)
    s_barrier
    s_mov_b32 s43, 5
    s_lshl_b32 s42, s43, 7
    s_add_u32 s42, s42, s46
    s_add_u32 m0, s47, 34816
    s_add_u32 s44, s42, 0
    buffer_load_dwordx4 v2, s[4:7], s44 offen sc1 lds
    s_add_u32 m0, s47, 35840
    s_add_u32 s44, s42, 65536
    buffer_load_dwordx4 v3, s[4:7], s44 offen sc1 lds
    s_add_u32 m0, s47, 36864
    s_add_u32 s44, s42, 131072
    buffer_load_dwordx4 v2, s[4:7], s44 offen sc1 lds
    s_add_u32 m0, s47, 37888
    s_add_u32 s44, s42, 196608
    buffer_load_dwordx4 v3, s[4:7], s44 offen sc1 lds
    s_add_u32 m0, s47, 38912
    s_add_u32 s44, s42, 262144
    buffer_load_dwordx4 v2, s[4:7], s44 offen sc1 lds
    s_add_u32 m0, s47, 39936
    s_add_u32 s44, s42, 327680
    buffer_load_dwordx4 v3, s[4:7], s44 offen sc1 lds
    s_add_u32 m0, s47, 40960
    s_add_u32 s44, s42, 393216
    buffer_load_dwordx4 v2, s[4:7], s44 offen sc1 lds
    s_add_u32 m0, s47, 41984
    s_add_u32 s44, s42, 458752
    buffer_load_dwordx4 v3, s[4:7], s44 offen sc1 lds
    s_add_u32 m0, s47, 43008
    s_add_u32 s44, s42, 524288
    buffer_load_dwordx4 v2, s[4:7], s44 offen sc1 lds
    s_add_u32 s43, s43, 1
    s_and_b32 s43, s43, 31
    s_waitcnt vmcnt(19)
    s_barrier
    s_mov_b32 s43, 6
    s_lshl_b32 s42, s43, 7
    s_add_u32 s42, s42, s46
    s_add_u32 m0, s47, 69632
    s_add_u32 s44, s42, 0
    buffer_load_dwordx4 v2, s[4:7], s44 offen sc1 lds
    s_add_u32 m0, s47, 70656
    s_add_u32 s44, s42, 65536
    buffer_load_dwordx4 v3, s[4:7], s44 offen sc1 lds
    s_add_u32 m0, s47, 71680
    s_add_u32 s44, s42, 131072
    buffer_load_dwordx4 v2, s[4:7], s44 offen sc1 lds
    s_add_u32 m0, s47, 72704
    s_add_u32 s44, s42, 196608
    buffer_load_dwordx4 v3, s[4:7], s44 offen sc1 lds
    s_add_u32 m0, s47, 73728
    s_add_u32 s44, s42, 262144
    buffer_load_dwordx4 v2, s[4:7], s44 offen sc1 lds
    s_add_u32 m0, s47, 74752
    s_add_u32 s44, s42, 327680
    buffer_load_dwordx4 v3, s[4:7], s44 offen sc1 lds
    s_add_u32 m0, s47, 75776
    s_add_u32 s44, s42, 393216
    buffer_load_dwordx4 v2, s[4:7], s44 offen sc1 lds
    s_add_u32 m0, s47, 76800
    s_add_u32 s44, s42, 458752
    buffer_load_dwordx4 v3, s[4:7], s44 offen sc1 lds
    s_add_u32 m0, s47, 77824
    s_add_u32 s44, s42, 524288
    buffer_load_dwordx4 v2, s[4:7], s44 offen sc1 lds
    s_add_u32 s43, s43, 1
    s_and_b32 s43, s43, 31
    s_waitcnt vmcnt(19)
    s_barrier
    s_mov_b32 s43, 7
    s_lshl_b32 s42, s43, 7
    s_add_u32 s42, s42, s46
    s_add_u32 m0, s47, 104448
    s_add_u32 s44, s42, 0
    buffer_load_dwordx4 v2, s[4:7], s44 offen sc1 lds
    s_add_u32 m0, s47, 105472
    s_add_u32 s44, s42, 65536
    buffer_load_dwordx4 v3, s[4:7], s44 offen sc1 lds
    s_add_u32 m0, s47, 106496
    s_add_u32 s44, s42, 131072
    buffer_load_dwordx4 v2, s[4:7], s44 offen sc1 lds
    s_add_u32 m0, s47, 107520
    s_add_u32 s44, s42, 196608
    buffer_load_dwordx4 v3, s[4:7], s44 offen sc1 lds
    s_add_u32 m0, s47, 108544
    s_add_u32 s44, s42, 262144
    buffer_load_dwordx4 v2, s[4:7], s44 offen sc1 lds
    s_add_u32 m0, s47, 109568
    s_add_u32 s44, s42, 327680
    buffer_load_dwordx4 v3, s[4:7], s44 offen sc1 lds
    s_add_u32 m0, s47, 110592
    s_add_u32 s44, s42, 393216
    buffer_load_dwordx4 v2, s[4:7], s44 offen sc1 lds
    s_add_u32 m0, s47, 111616
    s_add_u32 s44, s42, 458752
    buffer_load_dwordx4 v3, s[4:7], s44 offen sc1 lds
    s_add_u32 m0, s47, 112640
    s_add_u32 s44, s42, 524288
    buffer_load_dwordx4 v2, s[4:7], s44 offen sc1 lds
    s_add_u32 s43, s43, 1
    s_and_b32 s43, s43, 31
    s_waitcnt vmcnt(18)
    s_barrier
    s_mov_b32 s43, 16
    s_lshl_b32 s42, s43, 7
    s_add_u32 s42, s42, s46
    s_add_u32 m0, s47, 0
    s_add_u32 s44, s42, 0
    buffer_load_dwordx4 v2, s[4:7], s44 offen sc1 lds
    s_add_u32 m0, s47, 1024
    s_add_u32 s44, s42, 65536
    buffer_load_dwordx4 v3, s[4:7], s44 offen sc1 lds
    s_add_u32 m0, s47, 2048
    s_add_u32 s44, s42, 131072
    buffer_load_dwordx4 v2, s[4:7], s44 offen sc1 lds
    s_add_u32 m0, s47, 3072
    s_add_u32 s44, s42, 196608
    buffer_load_dwordx4 v3, s[4:7], s44 offen sc1 lds
    s_add_u32 m0, s47, 4096
    s_add_u32 s44, s42, 262144
    buffer_load_dwordx4 v2, s[4:7], s44 offen sc1 lds
    s_add_u32 m0, s47, 5120
    s_add_u32 s44, s42, 327680
    buffer_load_dwordx4 v3, s[4:7], s44 offen sc1 lds
    s_add_u32 m0, s47, 6144
    s_add_u32 s44, s42, 393216
    buffer_load_dwordx4 v2, s[4:7], s44 offen sc1 lds
    s_add_u32 m0, s47, 7168
    s_add_u32 s44, s42, 458752
    buffer_load_dwordx4 v3, s[4:7], s44 offen sc1 lds
    s_add_u32 m0, s47, 8192
    s_add_u32 s44, s42, 524288
    buffer_load_dwordx4 v2, s[4:7], s44 offen sc1 lds
    s_add_u32 s43, s43, 1
    s_and_b32 s43, s43, 31
    s_waitcnt vmcnt(18)
    s_barrier
    s_mov_b32 s43, 17
    s_lshl_b32 s42, s43, 7
    s_add_u32 s42, s42, s46
    s_add_u32 m0, s47, 34816
    s_add_u32 s44, s42, 0
    buffer_load_dwordx4 v2, s[4:7], s44 offen sc1 lds
    s_add_u32 m0, s47, 35840
    s_add_u32 s44, s42, 65536
    buffer_load_dwordx4 v3, s[4:7], s44 offen sc1 lds
    s_add_u32 m0, s47, 36864
    s_add_u32 s44, s42, 131072
    buffer_load_dwordx4 v2, s[4:7], s44 offen sc1 lds
    s_add_u32 m0, s47, 37888
    s_add_u32 s44, s42, 196608
    buffer_load_dwordx4 v3, s[4:7], s44 offen sc1 lds
    s_add_u32 m0, s47, 38912
    s_add_u32 s44, s42, 262144
    buffer_load_dwordx4 v2, s[4:7], s44 offen sc1 lds
    s_add_u32 m0, s47, 39936
    s_add_u32 s44, s42, 327680
    buffer_load_dwordx4 v3, s[4:7], s44 offen sc1 lds
    s_add_u32 m0, s47, 40960
    s_add_u32 s44, s42, 393216
    buffer_load_dwordx4 v2, s[4:7], s44 offen sc1 lds
    s_add_u32 m0, s47, 41984
    s_add_u32 s44, s42, 458752
    buffer_load_dwordx4 v3, s[4:7], s44 offen sc1 lds
    s_add_u32 m0, s47, 43008
    s_add_u32 s44, s42, 524288
    buffer_load_dwordx4 v2, s[4:7], s44 offen sc1 lds
    s_add_u32 s43, s43, 1
    s_and_b32 s43, s43, 31
    s_waitcnt vmcnt(18)
    s_barrier
    s_mov_b32 s43, 18
    s_lshl_b32 s42, s43, 7
    s_add_u32 s42, s42, s46
    s_add_u32 m0, s47, 69632
    s_add_u32 s44, s42, 0
    buffer_load_dwordx4 v2, s[4:7], s44 offen sc1 lds
    s_add_u32 m0, s47, 70656
    s_add_u32 s44, s42, 65536
    buffer_load_dwordx4 v3, s[4:7], s44 offen sc1 lds
    s_add_u32 m0, s47, 71680
    s_add_u32 s44, s42, 131072
    buffer_load_dwordx4 v2, s[4:7], s44 offen sc1 lds
    s_add_u32 m0, s47, 72704
    s_add_u32 s44, s42, 196608
    buffer_load_dwordx4 v3, s[4:7], s44 offen sc1 lds
    s_add_u32 m0, s47, 73728
    s_add_u32 s44, s42, 262144
    buffer_load_dwordx4 v2, s[4:7], s44 offen sc1 lds
    s_add_u32 m0, s47, 74752
    s_add_u32 s44, s42, 327680
    buffer_load_dwordx4 v3, s[4:7], s44 offen sc1 lds
    s_add_u32 m0, s47, 75776
    s_add_u32 s44, s42, 393216
    buffer_load_dwordx4 v2, s[4:7], s44 offen sc1 lds
    s_add_u32 m0, s47, 76800
    s_add_u32 s44, s42, 458752
    buffer_load_dwordx4 v3, s[4:7], s44 offen sc1 lds
    s_add_u32 m0, s47, 77824
    s_add_u32 s44, s42, 524288
    buffer_load_dwordx4 v2, s[4:7], s44 offen sc1 lds
    s_add_u32 s43, s43, 1
    s_and_b32 s43, s43, 31
    s_waitcnt vmcnt(18)
    s_barrier
    s_mov_b32 s43, 19
    s_lshl_b32 s42, s43, 7
    s_add_u32 s42, s42, s46
    s_add_u32 m0, s47, 104448
    s_add_u32 s44, s42, 0
    buffer_load_dwordx4 v2, s[4:7], s44 offen sc1 lds
    s_add_u32 m0, s47, 105472
    s_add_u32 s44, s42, 65536
    buffer_load_dwordx4 v3, s[4:7], s44 offen sc1 lds
    s_add_u32 m0, s47, 106496
    s_add_u32 s44, s42, 131072
    buffer_load_dwordx4 v2, s[4:7], s44 offen sc1 lds
    s_add_u32 m0, s47, 107520
    s_add_u32 s44, s42, 196608
    buffer_load_dwordx4 v3, s[4:7], s44 offen sc1 lds
    s_add_u32 m0, s47, 108544
    s_add_u32 s44, s42, 262144
    buffer_load_dwordx4 v2, s[4:7], s44 offen sc1 lds
    s_add_u32 m0, s47, 109568
    s_add_u32 s44, s42, 327680
    buffer_load_dwordx4 v3, s[4:7], s44 offen sc1 lds
    s_add_u32 m0, s47, 110592
    s_add_u32 s44, s42, 393216
    buffer_load_dwordx4 v2, s[4:7], s44 offen sc1 lds
    s_add_u32 m0, s47, 111616
    s_add_u32 s44, s42, 458752
    buffer_load_dwordx4 v3, s[4:7], s44 offen sc1 lds
    s_add_u32 m0, s47, 112640
    s_add_u32 s44, s42, 524288
    buffer_load_dwordx4 v2, s[4:7], s44 offen sc1 lds
    s_add_u32 s43, s43, 1
    s_and_b32 s43, s43, 31
    s_waitcnt vmcnt(18)
    s_barrier
    s_mov_b32 s43, 20
    s_lshl_b32 s42, s43, 7
    s_add_u32 s42, s42, s46
    s_add_u32 m0, s47, 0
    s_add_u32 s44, s42, 0
    buffer_load_dwordx4 v2, s[4:7], s44 offen sc1 lds
    s_add_u32 m0, s47, 1024
    s_add_u32 s44, s42, 65536
    buffer_load_dwordx4 v3, s[4:7], s44 offen sc1 lds
    s_add_u32 m0, s47, 2048
    s_add_u32 s44, s42, 131072
    buffer_load_dwordx4 v2, s[4:7], s44 offen sc1 lds
    s_add_u32 m0, s47, 3072
    s_add_u32 s44, s42, 196608
    buffer_load_dwordx4 v3, s[4:7], s44 offen sc1 lds
    s_add_u32 m0, s47, 4096
    s_add_u32 s44, s42, 262144
    buffer_load_dwordx4 v2, s[4:7], s44 offen sc1 lds
    s_add_u32 m0, s47, 5120
    s_add_u32 s44, s42, 327680
    buffer_load_dwordx4 v3, s[4:7], s44 offen sc1 lds
    s_add_u32 m0, s47, 6144
    s_add_u32 s44, s42, 393216
    buffer_load_dwordx4 v2, s[4:7], s44 offen sc1 lds
    s_add_u32 m0, s47, 7168
    s_add_u32 s44, s42, 458752
    buffer_load_dwordx4 v3, s[4:7], s44 offen sc1 lds
    s_add_u32 m0, s47, 8192
    s_add_u32 s44, s42, 524288
    buffer_load_dwordx4 v2, s[4:7], s44 offen sc1 lds
    s_add_u32 s43, s43, 1
    s_and_b32 s43, s43, 31
    s_waitcnt vmcnt(18)
    s_barrier
    s_mov_b32 s43, 21
    s_lshl_b32 s42, s43, 7
    s_add_u32 s42, s42, s46
    s_add_u32 m0, s47, 34816
    s_add_u32 s44, s42, 0
    buffer_load_dwordx4 v2, s[4:7], s44 offen sc1 lds
    s_add_u32 m0, s47, 35840
    s_add_u32 s44, s42, 65536
    buffer_load_dwordx4 v3, s[4:7], s44 offen sc1 lds
    s_add_u32 m0, s47, 36864
    s_add_u32 s44, s42, 131072
    buffer_load_dwordx4 v2, s[4:7], s44 offen sc1 lds
    s_add_u32 m0, s47, 37888
    s_add_u32 s44, s42, 196608
    buffer_load_dwordx4 v3, s[4:7], s44 offen sc1 lds
    s_add_u32 m0, s47, 38912
    s_add_u32 s44, s42, 262144
    buffer_load_dwordx4 v2, s[4:7], s44 offen sc1 lds
    s_add_u32 m0, s47, 39936
    s_add_u32 s44, s42, 327680
    buffer_load_dwordx4 v3, s[4:7], s44 offen sc1 lds
    s_add_u32 m0, s47, 40960
    s_add_u32 s44, s42, 393216
    buffer_load_dwordx4 v2, s[4:7], s44 offen sc1 lds
    s_add_u32 m0, s47, 41984
    s_add_u32 s44, s42, 458752
    buffer_load_dwordx4 v3, s[4:7], s44 offen sc1 lds
    s_add_u32 m0, s47, 43008
    s_add_u32 s44, s42, 524288
    buffer_load_dwordx4 v2, s[4:7], s44 offen sc1 lds
    s_add_u32 s43, s43, 1
    s_and_b32 s43, s43, 31
    s_waitcnt vmcnt(18)
    s_barrier
    s_mov_b32 s43, 22
    s_lshl_b32 s42, s43, 7
    s_add_u32 s42, s42, s46
    s_add_u32 m0, s47, 69632
    s_add_u32 s44, s42, 0
    buffer_load_dwordx4 v2, s[4:7], s44 offen sc1 lds
    s_add_u32 m0, s47, 70656
    s_add_u32 s44, s42, 65536
    buffer_load_dwordx4 v3, s[4:7], s44 offen sc1 lds
    s_add_u32 m0, s47, 71680
    s_add_u32 s44, s42, 131072
    buffer_load_dwordx4 v2, s[4:7], s44 offen sc1 lds
    s_add_u32 m0, s47, 72704
    s_add_u32 s44, s42, 196608
    buffer_load_dwordx4 v3, s[4:7], s44 offen sc1 lds
    s_add_u32 m0, s47, 73728
    s_add_u32 s44, s42, 262144
    buffer_load_dwordx4 v2, s[4:7], s44 offen sc1 lds
    s_add_u32 m0, s47, 74752
    s_add_u32 s44, s42, 327680
    buffer_load_dwordx4 v3, s[4:7], s44 offen sc1 lds
    s_add_u32 m0, s47, 75776
    s_add_u32 s44, s42, 393216
    buffer_load_dwordx4 v2, s[4:7], s44 offen sc1 lds
    s_add_u32 m0, s47, 76800
    s_add_u32 s44, s42, 458752
    buffer_load_dwordx4 v3, s[4:7], s44 offen sc1 lds
    s_add_u32 m0, s47, 77824
    s_add_u32 s44, s42, 524288
    buffer_load_dwordx4 v2, s[4:7], s44 offen sc1 lds
    s_add_u32 s43, s43, 1
    s_and_b32 s43, s43, 31
    s_waitcnt vmcnt(18)
    s_barrier
    s_mov_b32 s43, 23
    s_lshl_b32 s42, s43, 7
    s_add_u32 s42, s42, s46
    s_add_u32 m0, s47, 104448
    s_add_u32 s44, s42, 0
    buffer_load_dwordx4 v2, s[4:7], s44 offen sc1 lds
    s_add_u32 m0, s47, 105472
    s_add_u32 s44, s42, 65536
    buffer_load_dwordx4 v3, s[4:7], s44 offen sc1 lds
    s_add_u32 m0, s47, 106496
    s_add_u32 s44, s42, 131072
    buffer_load_dwordx4 v2, s[4:7], s44 offen sc1 lds
    s_add_u32 m0, s47, 107520
    s_add_u32 s44, s42, 196608
    buffer_load_dwordx4 v3, s[4:7], s44 offen sc1 lds
    s_add_u32 m0, s47, 108544
    s_add_u32 s44, s42, 262144
    buffer_load_dwordx4 v2, s[4:7], s44 offen sc1 lds
    s_add_u32 m0, s47, 109568
    s_add_u32 s44, s42, 327680
    buffer_load_dwordx4 v3, s[4:7], s44 offen sc1 lds
    s_add_u32 m0, s47, 110592
    s_add_u32 s44, s42, 393216
    buffer_load_dwordx4 v2, s[4:7], s44 offen sc1 lds
    s_add_u32 m0, s47, 111616
    s_add_u32 s44, s42, 458752
    buffer_load_dwordx4 v3, s[4:7], s44 offen sc1 lds
    s_add_u32 m0, s47, 112640
    s_add_u32 s44, s42, 524288
    buffer_load_dwordx4 v2, s[4:7], s44 offen sc1 lds
    s_add_u32 s43, s43, 1
    s_and_b32 s43, s43, 31
    s_waitcnt vmcnt(18)
    s_barrier
    s_add_u32 s64, s40, 50339840
    s_addc_u32 s65, s41, 0
    s_mov_b32 s66, 2048
    s_mov_b32 s67, 0x20000
    s_lshl_b32 s44, s24, 3
    s_add_u32 s44, s44, s25
    s_lshl_b32 s44, s44, 1
    s_add_u32 s44, s44, s27
    s_lshl_b32 s44, s44, 6
    s_add_u32 s44, s44, 0
    v_lshlrev_b32 v14, 2, v1
    s_mov_b32 s49, 0
    s_mov_b64 exec, 0xff
L_ppoll_48:
    buffer_load_dword v15, v14, s[64:67], s44 offen sc1
    s_waitcnt vmcnt(0)
    v_cmp_ne_u32 vcc, s91, v15
    s_add_u32 s49, s49, 1
    s_cbranch_vccz L_pgot_49
    s_sleep 4
    s_cmp_lt_u32 s49, 300000
    s_cbranch_scc1 L_ppoll_48
L_pgot_49:
    s_mov_b64 exec, -1
    s_mov_b32 s43, 8
    s_lshl_b32 s42, s43, 7
    s_add_u32 s42, s42, s46
    s_add_u32 m0, s47, 0
    s_add_u32 s44, s42, 0
    buffer_load_dwordx4 v2, s[4:7], s44 offen sc1 lds
    s_add_u32 m0, s47, 1024
    s_add_u32 s44, s42, 65536
    buffer_load_dwordx4 v3, s[4:7], s44 offen sc1 lds
    s_add_u32 m0, s47, 2048
    s_add_u32 s44, s42, 131072
    buffer_load_dwordx4 v2, s[4:7], s44 offen sc1 lds
    s_add_u32 m0, s47, 3072
    s_add_u32 s44, s42, 196608
    buffer_load_dwordx4 v3, s[4:7], s44 offen sc1 lds
    s_add_u32 m0, s47, 4096
    s_add_u32 s44, s42, 262144
    buffer_load_dwordx4 v2, s[4:7], s44 offen sc1 lds
    s_add_u32 m0, s47, 5120
    s_add_u32 s44, s42, 327680
    buffer_load_dwordx4 v3, s[4:7], s44 offen sc1 lds
    s_add_u32 m0, s47, 6144
    s_add_u32 s44, s42, 393216
    buffer_load_dwordx4 v2, s[4:7], s44 offen sc1 lds
    s_add_u32 m0, s47, 7168
    s_add_u32 s44, s42, 458752
    buffer_load_dwordx4 v3, s[4:7], s44 offen sc1 lds
    s_add_u32 m0, s47, 8192
    s_add_u32 s44, s42, 524288
    buffer_load_dwordx4 v2, s[4:7], s44 offen sc1 lds
    s_add_u32 s43, s43, 1
    s_and_b32 s43, s43, 31
    s_waitcnt vmcnt(18)
    s_barrier
    s_mov_b32 s43, 9
    s_lshl_b32 s42, s43, 7
    s_add_u32 s42, s42, s46
    s_add_u32 m0, s47, 34816
    s_add_u32 s44, s42, 0
    buffer_load_dwordx4 v2, s[4:7], s44 offen sc1 lds
    s_add_u32 m0, s47, 35840
    s_add_u32 s44, s42, 65536
    buffer_load_dwordx4 v3, s[4:7], s44 offen sc1 lds
    s_add_u32 m0, s47, 36864
    s_add_u32 s44, s42, 131072
    buffer_load_dwordx4 v2, s[4:7], s44 offen sc1 lds
    s_add_u32 m0, s47, 37888
    s_add_u32 s44, s42, 196608
    buffer_load_dwordx4 v3, s[4:7], s44 offen sc1 lds
    s_add_u32 m0, s47, 38912
    s_add_u32 s44, s42, 262144
    buffer_load_dwordx4 v2, s[4:7], s44 offen sc1 lds
    s_add_u32 m0, s47, 39936
    s_add_u32 s44, s42, 327680
    buffer_load_dwordx4 v3, s[4:7], s44 offen sc1 lds
    s_add_u32 m0, s47, 40960
    s_add_u32 s44, s42, 393216
    buffer_load_dwordx4 v2, s[4:7], s44 offen sc1 lds
    s_add_u32 m0, s47, 41984
    s_add_u32 s44, s42, 458752
    buffer_load_dwordx4 v3, s[4:7], s44 offen sc1 lds
    s_add_u32 m0, s47, 43008
    s_add_u32 s44, s42, 524288
    buffer_load_dwordx4 v2, s[4:7], s44 offen sc1 lds
    s_add_u32 s43, s43, 1
    s_and_b32 s43, s43, 31
    s_waitcnt vmcnt(18)
    s_barrier
    s_mov_b32 s43, 10
    s_lshl_b32 s42, s43, 7
    s_add_u32 s42, s42, s46
    s_add_u32 m0, s47, 69632
    s_add_u32 s44, s42, 0
    buffer_load_dwordx4 v2, s[4:7], s44 offen sc1 lds
    s_add_u32 m0, s47, 70656
    s_add_u32 s44, s42, 65536
    buffer_load_dwordx4 v3, s[4:7], s44 offen sc1 lds
    s_add_u32 m0, s47, 71680
    s_add_u32 s44, s42, 131072
    buffer_load_dwordx4 v2, s[4:7], s44 offen sc1 lds
    s_add_u32 m0, s47, 72704
    s_add_u32 s44, s42, 196608
    buffer_load_dwordx4 v3, s[4:7], s44 offen sc1 lds
    s_add_u32 m0, s47, 73728
    s_add_u32 s44, s42, 262144
    buffer_load_dwordx4 v2, s[4:7], s44 offen sc1 lds
    s_add_u32 m0, s47, 74752
    s_add_u32 s44, s42, 327680
    buffer_load_dwordx4 v3, s[4:7], s44 offen sc1 lds
    s_add_u32 m0, s47, 75776
    s_add_u32 s44, s42, 393216
    buffer_load_dwordx4 v2, s[4:7], s44 offen sc1 lds
    s_add_u32 m0, s47, 76800
    s_add_u32 s44, s42, 458752
    buffer_load_dwordx4 v3, s[4:7], s44 offen sc1 lds
    s_add_u32 m0, s47, 77824
    s_add_u32 s44, s42, 524288
    buffer_load_dwordx4 v2, s[4:7], s44 offen sc1 lds
    s_add_u32 s43, s43, 1
    s_and_b32 s43, s43, 31
    s_waitcnt vmcnt(18)
    s_barrier
    s_mov_b32 s43, 11
    s_lshl_b32 s42, s43, 7
    s_add_u32 s42, s42, s46
    s_add_u32 m0, s47, 104448
    s_add_u32 s44, s42, 0
    buffer_load_dwordx4 v2, s[4:7], s44 offen sc1 lds
    s_add_u32 m0, s47, 105472
    s_add_u32 s44, s42, 65536
    buffer_load_dwordx4 v3, s[4:7], s44 offen sc1 lds
    s_add_u32 m0, s47, 106496
    s_add_u32 s44, s42, 131072
    buffer_load_dwordx4 v2, s[4:7], s44 offen sc1 lds
    s_add_u32 m0, s47, 107520
    s_add_u32 s44, s42, 196608
    buffer_load_dwordx4 v3, s[4:7], s44 offen sc1 lds
    s_add_u32 m0, s47, 108544
    s_add_u32 s44, s42, 262144
    buffer_load_dwordx4 v2, s[4:7], s44 offen sc1 lds
    s_add_u32 m0, s47, 109568
    s_add_u32 s44, s42, 327680
    buffer_load_dwordx4 v3, s[4:7], s44 offen sc1 lds
    s_add_u32 m0, s47, 110592
    s_add_u32 s44, s42, 393216
    buffer_load_dwordx4 v2, s[4:7], s44 offen sc1 lds
    s_add_u32 m0, s47, 111616
    s_add_u32 s44, s42, 458752
    buffer_load_dwordx4 v3, s[4:7], s44 offen sc1 lds
    s_add_u32 m0, s47, 112640
    s_add_u32 s44, s42, 524288
    buffer_load_dwordx4 v2, s[4:7], s44 offen sc1 lds
    s_add_u32 s43, s43, 1
    s_and_b32 s43, s43, 31
    s_waitcnt vmcnt(18)
    s_barrier
    s_mov_b32 s43, 12
    s_lshl_b32 s42, s43, 7
    s_add_u32 s42, s42, s46
    s_add_u32 m0, s47, 0
    s_add_u32 s44, s42, 0
    buffer_load_dwordx4 v2, s[4:7], s44 offen sc1 lds
    s_add_u32 m0, s47, 1024
    s_add_u32 s44, s42, 65536
    buffer_load_dwordx4 v3, s[4:7], s44 offen sc1 lds
    s_add_u32 m0, s47, 2048
    s_add_u32 s44, s42, 131072
    buffer_load_dwordx4 v2, s[4:7], s44 offen sc1 lds
    s_add_u32 m0, s47, 3072
    s_add_u32 s44, s42, 196608
    buffer_load_dwordx4 v3, s[4:7], s44 offen sc1 lds
    s_add_u32 m0, s47, 4096
    s_add_u32 s44, s42, 262144
    buffer_load_dwordx4 v2, s[4:7], s44 offen sc1 lds
    s_add_u32 m0, s47, 5120
    s_add_u32 s44, s42, 327680
    buffer_load_dwordx4 v3, s[4:7], s44 offen sc1 lds
    s_add_u32 m0, s47, 6144
    s_add_u32 s44, s42, 393216
    buffer_load_dwordx4 v2, s[4:7], s44 offen sc1 lds
    s_add_u32 m0, s47, 7168
    s_add_u32 s44, s42, 458752
    buffer_load_dwordx4 v3, s[4:7], s44 offen sc1 lds
    s_add_u32 m0, s47, 8192
    s_add_u32 s44, s42, 524288
    buffer_load_dwordx4 v2, s[4:7], s44 offen sc1 lds
    s_add_u32 s43, s43, 1
    s_and_b32 s43, s43, 31
    s_waitcnt vmcnt(18)
    s_barrier
    s_mov_b32 s43, 13
    s_lshl_b32 s42, s43, 7
    s_add_u32 s42, s42, s46
    s_add_u32 m0, s47, 34816
    s_add_u32 s44, s42, 0
    buffer_load_dwordx4 v2, s[4:7], s44 offen sc1 lds
    s_add_u32 m0, s47, 35840
    s_add_u32 s44, s42, 65536
    buffer_load_dwordx4 v3, s[4:7], s44 offen sc1 lds
    s_add_u32 m0, s47, 36864
    s_add_u32 s44, s42, 131072
    buffer_load_dwordx4 v2, s[4:7], s44 offen sc1 lds
    s_add_u32 m0, s47, 37888
    s_add_u32 s44, s42, 196608
    buffer_load_dwordx4 v3, s[4:7], s44 offen sc1 lds
    s_add_u32 m0, s47, 38912
    s_add_u32 s44, s42, 262144
    buffer_load_dwordx4 v2, s[4:7], s44 offen sc1 lds
    s_add_u32 m0, s47, 39936
    s_add_u32 s44, s42, 327680
    buffer_load_dwordx4 v3, s[4:7], s44 offen sc1 lds
    s_add_u32 m0, s47, 40960
    s_add_u32 s44, s42, 393216
    buffer_load_dwordx4 v2, s[4:7], s44 offen sc1 lds
    s_add_u32 m0, s47, 41984
    s_add_u32 s44, s42, 458752
    buffer_load_dwordx4 v3, s[4:7], s44 offen sc1 lds
    s_add_u32 m0, s47, 43008
    s_add_u32 s44, s42, 524288
    buffer_load_dwordx4 v2, s[4:7], s44 offen sc1 lds
    s_add_u32 s43, s43, 1
    s_and_b32 s43, s43, 31
    s_waitcnt vmcnt(18)
    s_barrier
    s_mov_b32 s43, 14
    s_lshl_b32 s42, s43, 7
    s_add_u32 s42, s42, s46
    s_add_u32 m0, s47, 69632
    s_add_u32 s44, s42, 0
    buffer_load_dwordx4 v2, s[4:7], s44 offen sc1 lds
    s_add_u32 m0, s47, 70656
    s_add_u32 s44, s42, 65536
    buffer_load_dwordx4 v3, s[4:7], s44 offen sc1 lds
    s_add_u32 m0, s47, 71680
    s_add_u32 s44, s42, 131072
    buffer_load_dwordx4 v2, s[4:7], s44 offen sc1 lds
    s_add_u32 m0, s47, 72704
    s_add_u32 s44, s42, 196608
    buffer_load_dwordx4 v3, s[4:7], s44 offen sc1 lds
    s_add_u32 m0, s47, 73728
    s_add_u32 s44, s42, 262144
    buffer_load_dwordx4 v2, s[4:7], s44 offen sc1 lds
    s_add_u32 m0, s47, 74752
    s_add_u32 s44, s42, 327680
    buffer_load_dwordx4 v3, s[4:7], s44 offen sc1 lds
    s_add_u32 m0, s47, 75776
    s_add_u32 s44, s42, 393216
    buffer_load_dwordx4 v2, s[4:7], s44 offen sc1 lds
    s_add_u32 m0, s47, 76800
    s_add_u32 s44, s42, 458752
    buffer_load_dwordx4 v3, s[4:7], s44 offen sc1 lds
    s_add_u32 m0, s47, 77824
    s_add_u32 s44, s42, 524288
    buffer_load_dwordx4 v2, s[4:7], s44 offen sc1 lds
    s_add_u32 s43, s43, 1
    s_and_b32 s43, s43, 31
    s_waitcnt vmcnt(18)
    s_barrier
    s_mov_b32 s43, 15
    s_lshl_b32 s42, s43, 7
    s_add_u32 s42, s42, s46
    s_add_u32 m0, s47, 104448
    s_add_u32 s44, s42, 0
    buffer_load_dwordx4 v2, s[4:7], s44 offen sc1 lds
    s_add_u32 m0, s47, 105472
    s_add_u32 s44, s42, 65536
    buffer_load_dwordx4 v3, s[4:7], s44 offen sc1 lds
    s_add_u32 m0, s47, 106496
    s_add_u32 s44, s42, 131072
    buffer_load_dwordx4 v2, s[4:7], s44 offen sc1 lds
    s_add_u32 m0, s47, 107520
    s_add_u32 s44, s42, 196608
    buffer_load_dwordx4 v3, s[4:7], s44 offen sc1 lds
    s_add_u32 m0, s47, 108544
    s_add_u32 s44, s42, 262144
    buffer_load_dwordx4 v2, s[4:7], s44 offen sc1 lds
    s_add_u32 m0, s47, 109568
    s_add_u32 s44, s42, 327680
    buffer_load_dwordx4 v3, s[4:7], s44 offen sc1 lds
    s_add_u32 m0, s47, 110592
    s_add_u32 s44, s42, 393216
    buffer_load_dwordx4 v2, s[4:7], s44 offen sc1 lds
    s_add_u32 m0, s47, 111616
    s_add_u32 s44, s42, 458752
    buffer_load_dwordx4 v3, s[4:7], s44 offen sc1 lds
    s_add_u32 m0, s47, 112640
    s_add_u32 s44, s42, 524288
    buffer_load_dwordx4 v2, s[4:7], s44 offen sc1 lds
    s_add_u32 s43, s43, 1
    s_and_b32 s43, s43, 31
    s_waitcnt vmcnt(18)
    s_barrier
    s_mov_b32 s43, 24
    s_lshl_b32 s42, s43, 7
    s_add_u32 s42, s42, s46
    s_add_u32 m0, s47, 0
    s_add_u32 s44, s42, 0
    buffer_load_dwordx4 v2, s[4:7], s44 offen sc1 lds
    s_add_u32 m0, s47, 1024
    s_add_u32 s44, s42, 65536
    buffer_load_dwordx4 v3, s[4:7], s44 offen sc1 lds
    s_add_u32 m0, s47, 2048
    s_add_u32 s44, s42, 131072
    buffer_load_dwordx4 v2, s[4:7], s44 offen sc1 lds
    s_add_u32 m0, s47, 3072
    s_add_u32 s44, s42, 196608
    buffer_load_dwordx4 v3, s[4:7], s44 offen sc1 lds
    s_add_u32 m0, s47, 4096
    s_add_u32 s44, s42, 262144
    buffer_load_dwordx4 v2, s[4:7], s44 offen sc1 lds
    s_add_u32 m0, s47, 5120
    s_add_u32 s44, s42, 327680
    buffer_load_dwordx4 v3, s[4:7], s44 offen sc1 lds
    s_add_u32 m0, s47, 6144
    s_add_u32 s44, s42, 393216
    buffer_load_dwordx4 v2, s[4:7], s44 offen sc1 lds
    s_add_u32 m0, s47, 7168
    s_add_u32 s44, s42, 458752
    buffer_load_dwordx4 v3, s[4:7], s44 offen sc1 lds
    s_add_u32 m0, s47, 8192
    s_add_u32 s44, s42, 524288
    buffer_load_dwordx4 v2, s[4:7], s44 offen sc1 lds
    s_add_u32 s43, s43, 1
    s_and_b32 s43, s43, 31
    s_waitcnt vmcnt(18)
    s_barrier
    s_mov_b32 s43, 25
    s_lshl_b32 s42, s43, 7
    s_add_u32 s42, s42, s46
    s_add_u32 m0, s47, 34816
    s_add_u32 s44, s42, 0
    buffer_load_dwordx4 v2, s[4:7], s44 offen sc1 lds
    s_add_u32 m0, s47, 35840
    s_add_u32 s44, s42, 65536
    buffer_load_dwordx4 v3, s[4:7], s44 offen sc1 lds
    s_add_u32 m0, s47, 36864
    s_add_u32 s44, s42, 131072
    buffer_load_dwordx4 v2, s[4:7], s44 offen sc1 lds
    s_add_u32 m0, s47, 37888
    s_add_u32 s44, s42, 196608
    buffer_load_dwordx4 v3, s[4:7], s44 offen sc1 lds
    s_add_u32 m0, s47, 38912
    s_add_u32 s44, s42, 262144
    buffer_load_dwordx4 v2, s[4:7], s44 offen sc1 lds
    s_add_u32 m0, s47, 39936
    s_add_u32 s44, s42, 327680
    buffer_load_dwordx4 v3, s[4:7], s44 offen sc1 lds
    s_add_u32 m0, s47, 40960
    s_add_u32 s44, s42, 393216
    buffer_load_dwordx4 v2, s[4:7], s44 offen sc1 lds
    s_add_u32 m0, s47, 41984
    s_add_u32 s44, s42, 458752
    buffer_load_dwordx4 v3, s[4:7], s44 offen sc1 lds
    s_add_u32 m0, s47, 43008
    s_add_u32 s44, s42, 524288
    buffer_load_dwordx4 v2, s[4:7], s44 offen sc1 lds
    s_add_u32 s43, s43, 1
    s_and_b32 s43, s43, 31
    s_waitcnt vmcnt(18)
    s_barrier
    s_mov_b32 s43, 26
    s_lshl_b32 s42, s43, 7
    s_add_u32 s42, s42, s46
    s_add_u32 m0, s47, 69632
    s_add_u32 s44, s42, 0
    buffer_load_dwordx4 v2, s[4:7], s44 offen sc1 lds
    s_add_u32 m0, s47, 70656
    s_add_u32 s44, s42, 65536
    buffer_load_dwordx4 v3, s[4:7], s44 offen sc1 lds
    s_add_u32 m0, s47, 71680
    s_add_u32 s44, s42, 131072
    buffer_load_dwordx4 v2, s[4:7], s44 offen sc1 lds
    s_add_u32 m0, s47, 72704
    s_add_u32 s44, s42, 196608
    buffer_load_dwordx4 v3, s[4:7], s44 offen sc1 lds
    s_add_u32 m0, s47, 73728
    s_add_u32 s44, s42, 262144
    buffer_load_dwordx4 v2, s[4:7], s44 offen sc1 lds
    s_add_u32 m0, s47, 74752
    s_add_u32 s44, s42, 327680
    buffer_load_dwordx4 v3, s[4:7], s44 offen sc1 lds
    s_add_u32 m0, s47, 75776
    s_add_u32 s44, s42, 393216
    buffer_load_dwordx4 v2, s[4:7], s44 offen sc1 lds
    s_add_u32 m0, s47, 76800
    s_add_u32 s44, s42, 458752
    buffer_load_dwordx4 v3, s[4:7], s44 offen sc1 lds
    s_add_u32 m0, s47, 77824
    s_add_u32 s44, s42, 524288
    buffer_load_dwordx4 v2, s[4:7], s44 offen sc1 lds
    s_add_u32 s43, s43, 1
    s_and_b32 s43, s43, 31
    s_waitcnt vmcnt(18)
    s_barrier
    s_mov_b32 s43, 27
    s_lshl_b32 s42, s43, 7
    s_add_u32 s42, s42, s46
    s_add_u32 m0, s47, 104448
    s_add_u32 s44, s42, 0
    buffer_load_dwordx4 v2, s[4:7], s44 offen sc1 lds
    s_add_u32 m0, s47, 105472
    s_add_u32 s44, s42, 65536
    buffer_load_dwordx4 v3, s[4:7], s44 offen sc1 lds
    s_add_u32 m0, s47, 106496
    s_add_u32 s44, s42, 131072
    buffer_load_dwordx4 v2, s[4:7], s44 offen sc1 lds
    s_add_u32 m0, s47, 107520
    s_add_u32 s44, s42, 196608
    buffer_load_dwordx4 v3, s[4:7], s44 offen sc1 lds
    s_add_u32 m0, s47, 108544
    s_add_u32 s44, s42, 262144
    buffer_load_dwordx4 v2, s[4:7], s44 offen sc1 lds
    s_add_u32 m0, s47, 109568
    s_add_u32 s44, s42, 327680
    buffer_load_dwordx4 v3, s[4:7], s44 offen sc1 lds
    s_add_u32 m0, s47, 110592
    s_add_u32 s44, s42, 393216
    buffer_load_dwordx4 v2, s[4:7], s44 offen sc1 lds
    s_add_u32 m0, s47, 111616
    s_add_u32 s44, s42, 458752
    buffer_load_dwordx4 v3, s[4:7], s44 offen sc1 lds
    s_add_u32 m0, s47, 112640
    s_add_u32 s44, s42, 524288
    buffer_load_dwordx4 v2, s[4:7], s44 offen sc1 lds
    s_add_u32 s43, s43, 1
    s_and_b32 s43, s43, 31
    s_waitcnt vmcnt(18)
    s_barrier
    s_mov_b32 s43, 28
    s_lshl_b32 s42, s43, 7
    s_add_u32 s42, s42, s46
    s_add_u32 m0, s47, 0
    s_add_u32 s44, s42, 0
    buffer_load_dwordx4 v2, s[4:7], s44 offen sc1 lds
    s_add_u32 m0, s47, 1024
    s_add_u32 s44, s42, 65536
    buffer_load_dwordx4 v3, s[4:7], s44 offen sc1 lds
    s_add_u32 m0, s47, 2048
    s_add_u32 s44, s42, 131072
    buffer_load_dwordx4 v2, s[4:7], s44 offen sc1 lds
    s_add_u32 m0, s47, 3072
    s_add_u32 s44, s42, 196608
    buffer_load_dwordx4 v3, s[4:7], s44 offen sc1 lds
    s_add_u32 m0, s47, 4096
    s_add_u32 s44, s42, 262144
    buffer_load_dwordx4 v2, s[4:7], s44 offen sc1 lds
    s_add_u32 m0, s47, 5120
    s_add_u32 s44, s42, 327680
    buffer_load_dwordx4 v3, s[4:7], s44 offen sc1 lds
    s_add_u32 m0, s47, 6144
    s_add_u32 s44, s42, 393216
    buffer_load_dwordx4 v2, s[4:7], s44 offen sc1 lds
    s_add_u32 m0, s47, 7168
    s_add_u32 s44, s42, 458752
    buffer_load_dwordx4 v3, s[4:7], s44 offen sc1 lds
    s_add_u32 m0, s47, 8192
    s_add_u32 s44, s42, 524288
    buffer_load_dwordx4 v2, s[4:7], s44 offen sc1 lds
    s_add_u32 s43, s43, 1
    s_and_b32 s43, s43, 31
    s_waitcnt vmcnt(18)
    s_barrier
    s_mov_b32 s43, 29
    s_lshl_b32 s42, s43, 7
    s_add_u32 s42, s42, s46
    s_add_u32 m0, s47, 34816
    s_add_u32 s44, s42, 0
    buffer_load_dwordx4 v2, s[4:7], s44 offen sc1 lds
    s_add_u32 m0, s47, 35840
    s_add_u32 s44, s42, 65536
    buffer_load_dwordx4 v3, s[4:7], s44 offen sc1 lds
    s_add_u32 m0, s47, 36864
    s_add_u32 s44, s42, 131072
    buffer_load_dwordx4 v2, s[4:7], s44 offen sc1 lds
    s_add_u32 m0, s47, 37888
    s_add_u32 s44, s42, 196608
    buffer_load_dwordx4 v3, s[4:7], s44 offen sc1 lds
    s_add_u32 m0, s47, 38912
    s_add_u32 s44, s42, 262144
    buffer_load_dwordx4 v2, s[4:7], s44 offen sc1 lds
    s_add_u32 m0, s47, 39936
    s_add_u32 s44, s42, 327680
    buffer_load_dwordx4 v3, s[4:7], s44 offen sc1 lds
    s_add_u32 m0, s47, 40960
    s_add_u32 s44, s42, 393216
    buffer_load_dwordx4 v2, s[4:7], s44 offen sc1 lds
    s_add_u32 m0, s47, 41984
    s_add_u32 s44, s42, 458752
    buffer_load_dwordx4 v3, s[4:7], s44 offen sc1 lds
    s_add_u32 m0, s47, 43008
    s_add_u32 s44, s42, 524288
    buffer_load_dwordx4 v2, s[4:7], s44 offen sc1 lds
    s_add_u32 s43, s43, 1
    s_and_b32 s43, s43, 31
    s_waitcnt vmcnt(18)
    s_barrier
    s_mov_b32 s43, 30
    s_lshl_b32 s42, s43, 7
    s_add_u32 s42, s42, s46
    s_add_u32 m0, s47, 69632
    s_add_u32 s44, s42, 0
    buffer_load_dwordx4 v2, s[4:7], s44 offen sc1 lds
    s_add_u32 m0, s47, 70656
    s_add_u32 s44, s42, 65536
    buffer_load_dwordx4 v3, s[4:7], s44 offen sc1 lds
    s_add_u32 m0, s47, 71680
    s_add_u32 s44, s42, 131072
    buffer_load_dwordx4 v2, s[4:7], s44 offen sc1 lds
    s_add_u32 m0, s47, 72704
    s_add_u32 s44, s42, 196608
    buffer_load_dwordx4 v3, s[4:7], s44 offen sc1 lds
    s_add_u32 m0, s47, 73728
    s_add_u32 s44, s42, 262144
    buffer_load_dwordx4 v2, s[4:7], s44 offen sc1 lds
    s_add_u32 m0, s47, 74752
    s_add_u32 s44, s42, 327680
    buffer_load_dwordx4 v3, s[4:7], s44 offen sc1 lds
    s_add_u32 m0, s47, 75776
    s_add_u32 s44, s42, 393216
    buffer_load_dwordx4 v2, s[4:7], s44 offen sc1 lds
    s_add_u32 m0, s47, 76800
    s_add_u32 s44, s42, 458752
    buffer_load_dwordx4 v3, s[4:7], s44 offen sc1 lds
    s_add_u32 m0, s47, 77824
    s_add_u32 s44, s42, 524288
    buffer_load_dwordx4 v2, s[4:7], s44 offen sc1 lds
    s_add_u32 s43, s43, 1
    s_and_b32 s43, s43, 31
    s_waitcnt vmcnt(18)
    s_barrier
    s_mov_b32 s43, 31
    s_lshl_b32 s42, s43, 7
    s_add_u32 s42, s42, s46
    s_add_u32 m0, s47, 104448
    s_add_u32 s44, s42, 0
    buffer_load_dwordx4 v2, s[4:7], s44 offen sc1 lds
    s_add_u32 m0, s47, 105472
    s_add_u32 s44, s42, 65536
    buffer_load_dwordx4 v3, s[4:7], s44 offen sc1 lds
    s_add_u32 m0, s47, 106496
    s_add_u32 s44, s42, 131072
    buffer_load_dwordx4 v2, s[4:7], s44 offen sc1 lds
    s_add_u32 m0, s47, 107520
    s_add_u32 s44, s42, 196608
    buffer_load_dwordx4 v3, s[4:7], s44 offen sc1 lds
    s_add_u32 m0, s47, 108544
    s_add_u32 s44, s42, 262144
    buffer_load_dwordx4 v2, s[4:7], s44 offen sc1 lds
    s_add_u32 m0, s47, 109568
    s_add_u32 s44, s42, 327680
    buffer_load_dwordx4 v3, s[4:7], s44 offen sc1 lds
    s_add_u32 m0, s47, 110592
    s_add_u32 s44, s42, 393216
    buffer_load_dwordx4 v2, s[4:7], s44 offen sc1 lds
    s_add_u32 m0, s47, 111616
    s_add_u32 s44, s42, 458752
    buffer_load_dwordx4 v3, s[4:7], s44 offen sc1 lds
    s_add_u32 m0, s47, 112640
    s_add_u32 s44, s42, 524288
    buffer_load_dwordx4 v2, s[4:7], s44 offen sc1 lds
    s_add_u32 s43, s43, 1
    s_and_b32 s43, s43, 31
    s_waitcnt vmcnt(18)
    s_barrier
    s_waitcnt vmcnt(9)
    s_barrier
    s_waitcnt vmcnt(0)
    s_barrier
    s_endpgm
L_rare_39:
    s_call_b64 s[72:73], L_k1_rsubS_1
    s_branch L_back_40
L_rare_41:
    s_call_b64 s[72:73], L_k1_rsubS_0
    s_branch L_back_42
L_rare_44:
    s_call_b64 s[72:73], L_k1_rsubS_1
    s_branch L_back_45
L_rare_46:
    s_call_b64 s[72:73], L_k1_rsubS_0
    s_branch L_back_47
L_k1_rsubS_0:
    s_nop 7
    v_mov_b32 v14, v22
    s_nop 1
    v_permlane16_swap_b32 v22, v14
    s_nop 1
    v_max_f32 v22, v22, v14
    v_mov_b32 v14, v22
    s_nop 1
    v_permlane32_swap_b32 v22, v14
    s_nop 1
    v_max_f32 v22, v22, v14
    v_cmp_lt_f32 vcc, s30, v22
    s_nop 1
    v_cndmask_b32 v22, 0, v22, vcc
    v_sub_f32 v204, v204, v22
    v_sub_f32 v205, v205, v22
    v_sub_f32 v206, v206, v22
    v_sub_f32 v207, v207, v22
    v_sub_f32 v208, v208, v22
    v_sub_f32 v209, v209, v22
    v_sub_f32 v210, v210, v22
    v_sub_f32 v211, v211, v22
    v_sub_f32 v100, v100, v22
    v_sub_f32 v101, v101, v22
    v_sub_f32 v102, v102, v22
    v_sub_f32 v103, v103, v22
    v_sub_f32 v14, 0, v22
    v_exp_f32 v14, v14
    s_nop 0
    v_mul_f32 v92, v92, v14
    v_mul_f32 v93, v93, v14
    v_mul_f32 v94, v94, v14
    v_mul_f32 v95, v95, v14
    v_mul_f32 v28, v28, v14
    v_mul_f32 v29, v29, v14
    v_mul_f32 v30, v30, v14
    v_mul_f32 v31, v31, v14
    v_mul_f32 v32, v32, v14
    v_mul_f32 v33, v33, v14
    v_mul_f32 v34, v34, v14
    v_mul_f32 v35, v35, v14
    v_mul_f32 v36, v36, v14
    v_mul_f32 v37, v37, v14
    v_mul_f32 v38, v38, v14
    v_mul_f32 v39, v39, v14
    v_mul_f32 v40, v40, v14
    v_mul_f32 v41, v41, v14
    v_mul_f32 v42, v42, v14
    v_mul_f32 v43, v43, v14
    v_mul_f32 v44, v44, v14
    v_mul_f32 v45, v45, v14
    v_mul_f32 v46, v46, v14
    v_mul_f32 v47, v47, v14
    v_mul_f32 v48, v48, v14
    v_mul_f32 v49, v49, v14
    v_mul_f32 v50, v50, v14
    v_mul_f32 v51, v51, v14
    v_mul_f32 v52, v52, v14
    v_mul_f32 v53, v53, v14
    v_mul_f32 v54, v54, v14
    v_mul_f32 v55, v55, v14
    v_mul_f32 v56, v56, v14
    v_mul_f32 v57, v57, v14
    v_mul_f32 v58, v58, v14
    v_mul_f32 v59, v59, v14
    s_mov_b32 s29, 0x41000000
    s_mov_b32 s30, s29
    s_nop 1
    s_setpc_b64 s[72:73]
L_k1_rsubS_1:
    s_nop 7
    v_mov_b32 v14, v22
    s_nop 1
    v_permlane16_swap_b32 v22, v14
    s_nop 1
    v_max_f32 v22, v22, v14
    v_mov_b32 v14, v22
    s_nop 1
    v_permlane32_swap_b32 v22, v14
    s_nop 1
    v_max_f32 v22, v22, v14
    v_cmp_lt_f32 vcc, s30, v22
    s_nop 1
    v_cndmask_b32 v22, 0, v22, vcc
    v_sub_f32 v220, v220, v22
    v_sub_f32 v221, v221, v22
    v_sub_f32 v222, v222, v22
    v_sub_f32 v223, v223, v22
    v_sub_f32 v224, v224, v22
    v_sub_f32 v225, v225, v22
    v_sub_f32 v226, v226, v22
    v_sub_f32 v227, v227, v22
    v_sub_f32 v100, v100, v22
    v_sub_f32 v101, v101, v22
    v_sub_f32 v102, v102, v22
    v_sub_f32 v103, v103, v22
    v_sub_f32 v14, 0, v22
    v_exp_f32 v14, v14
    s_nop 0
    v_mul_f32 v92, v92, v14
    v_mul_f32 v93, v93, v14
    v_mul_f32 v94, v94, v14
    v_mul_f32 v95, v95, v14
    v_mul_f32 v28, v28, v14
    v_mul_f32 v29, v29, v14
    v_mul_f32 v30, v30, v14
    v_mul_f32 v31, v31, v14
    v_mul_f32 v32, v32, v14
    v_mul_f32 v33, v33, v14
    v_mul_f32 v34, v34, v14
    v_mul_f32 v35, v35, v14
    v_mul_f32 v36, v36, v14
    v_mul_f32 v37, v37, v14
    v_mul_f32 v38, v38, v14
    v_mul_f32 v39, v39, v14
    v_mul_f32 v40, v40, v14
    v_mul_f32 v41, v41, v14
    v_mul_f32 v42, v42, v14
    v_mul_f32 v43, v43, v14
    v_mul_f32 v44, v44, v14
    v_mul_f32 v45, v45, v14
    v_mul_f32 v46, v46, v14
    v_mul_f32 v47, v47, v14
    v_mul_f32 v48, v48, v14
    v_mul_f32 v49, v49, v14
    v_mul_f32 v50, v50, v14
    v_mul_f32 v51, v51, v14
    v_mul_f32 v52, v52, v14
    v_mul_f32 v53, v53, v14
    v_mul_f32 v54, v54, v14
    v_mul_f32 v55, v55, v14
    v_mul_f32 v56, v56, v14
    v_mul_f32 v57, v57, v14
    v_mul_f32 v58, v58, v14
    v_mul_f32 v59, v59, v14
    s_mov_b32 s29, 0x41000000
    s_mov_b32 s30, s29
    s_nop 1
    s_setpc_b64 s[72:73]
L_k1_rinitS:
    v_mov_b32 v14, v22
    s_nop 1
    v_permlane16_swap_b32 v22, v14
    s_nop 1
    v_max_f32 v22, v22, v14
    v_mov_b32 v14, v22
    s_nop 1
    v_permlane32_swap_b32 v22, v14
    s_nop 1
    v_max_f32 v22, v22, v14
    v_sub_f32 v204, v204, v22
    v_sub_f32 v205, v205, v22
    v_sub_f32 v206, v206, v22
    v_sub_f32 v207, v207, v22
    v_sub_f32 v208, v208, v22
    v_sub_f32 v209, v209, v22
    v_sub_f32 v210, v210, v22
    v_sub_f32 v211, v211, v22
    v_sub_f32 v100, v100, v22
    v_sub_f32 v101, v101, v22
    v_sub_f32 v102, v102, v22
    v_sub_f32 v103, v103, v22
    s_mov_b32 s29, 0x41000000
    s_mov_b32 s30, s29
    s_nop 1
    s_setpc_b64 s[72:73]
L_k1_done:
    s_endpgm
L_k1_end:
.section .rodata,"a"
.p2align 6
.amdhsa_kernel concat_heads__mha_block_cached__gqa_block_cached__near_ridge_kernel
  .amdhsa_next_free_vgpr 244
  .amdhsa_next_free_sgpr 102
  .amdhsa_accum_offset 244
  .amdhsa_group_segment_fixed_size 0
  .amdhsa_kernarg_size 104
  .amdhsa_user_sgpr_count 2
  .amdhsa_user_sgpr_kernarg_segment_ptr 1
  .amdhsa_system_sgpr_workgroup_id_x 1
.end_amdhsa_kernel
```
